```python
import torch

def _softmax(x, axis=-1):
    return torch.softmax(x, dim=axis)
def _gelu(x):
    return torch.nn.functional.gelu(x, approximate="tanh")
def _silu(x):
    return torch.nn.functional.silu(x)
def _sigmoid(x):
    return torch.sigmoid(x)
def _layernorm(x, axis=-1, eps=1e-5):
    m = x.mean(dim=axis, keepdim=True)
    v = x.var(dim=axis, keepdim=True, unbiased=False)
    return (x - m) / torch.sqrt(v + eps)
def _scatter_add(tgt, idx, src, axis=0):
    return tgt.clone().index_add_(axis, idx, src)
def _segment_sum(src, seg, n):
    out = torch.zeros((n,) + src.shape[1:], dtype=src.dtype)
    return out.index_add_(0, seg, src)
def _pad(x, pw):
    flat = tuple(v for pair in reversed(pw) for v in pair)
    return torch.nn.functional.pad(x, flat)

kernel_name = 'sequential_preLN__ssm_conv_s4d__glu_gated_reglu__prompt'

def setup_inputs():

    _w = (lambda a: (lambda t: t.to(torch.bfloat16) if t.is_floating_point() else t)(torch.as_tensor(a)))
    def _A_setup():
        Bsz, L, D, N = 1, 2048, 576, 128
        return {
            "u": _w((lambda *s: torch.randn(*s, dtype=torch.bfloat16) * 0.05)(Bsz, L, D)),
            "log_A_real": _w((lambda *s: torch.randn(*s, dtype=torch.bfloat16) * 6.4)(D, N) * 0.5),
            "A_imag": _w((lambda *s: torch.randn(*s, dtype=torch.bfloat16) * 0.05)(D, N) * 3.14),
            "C_real": _w((lambda *s: torch.randn(*s, dtype=torch.bfloat16) * 0.05)(D, N) / N ** 0.5),
            "C_imag": _w((lambda *s: torch.randn(*s, dtype=torch.bfloat16) * 0.05)(D, N) / N ** 0.5),
            "log_dt": _w((lambda *s: torch.randn(*s, dtype=torch.bfloat16) * 0.05)(D) * 0.5 - 4.0),
            "D_skip": _w((lambda *s: torch.randn(*s, dtype=torch.bfloat16) * 0.05)(D)),
        }
    _A_in = _A_setup()

    def _B_setup():
        B, S, D, F = 1, 2048, 576, 4608
        return {
            "x": _w((lambda *s: torch.randn(*s, dtype=torch.bfloat16) * 0.05)(B, S, D)),
            "W_gate": _w((lambda *s: torch.randn(*s, dtype=torch.bfloat16) * 0.4)(D, F) * (2.0 / D) ** 0.5),
            "W_up": _w((lambda *s: torch.randn(*s, dtype=torch.bfloat16) * 0.4)(D, F) * (2.0 / D) ** 0.5),
            "W_down": _w((lambda *s: torch.randn(*s, dtype=torch.bfloat16) * 0.4)(F, D) * (1.0 / F) ** 0.5),
        }
    _B_in = _B_setup()

    return {
        "A_u": _A_in["u"],
        "A_log_A_real": _A_in["log_A_real"],
        "A_A_imag": _A_in["A_imag"],
        "A_C_real": _A_in["C_real"],
        "A_C_imag": _A_in["C_imag"],
        "A_log_dt": _A_in["log_dt"],
        "A_D_skip": _A_in["D_skip"],
        "B_x": _B_in["x"],
        "B_W_gate": _B_in["W_gate"],
        "B_W_up": _B_in["W_up"],
        "B_W_down": _B_in["W_down"],
    }

def reference(A_u, A_log_A_real, A_A_imag, A_C_real, A_C_imag, A_log_dt, A_D_skip, B_x, B_W_gate, B_W_up, B_W_down):
    def _A_ref(u, log_A_real, A_imag, C_real, C_imag, log_dt, D_skip):
        L = u.shape[1]
        dt = torch.exp(log_dt)
        A = -torch.exp(log_A_real) + 1j * A_imag
        C = (C_real + 1j * C_imag) * dt[:, None]
        pos = (lambda x, dt: x.to(dt))(torch.arange(L), log_dt.dtype)
        P = torch.exp((A * dt[:, None])[:, :, None] * pos[None, None, :])
        K = 2.0 * torch.einsum("dn,dnl->dl", C, P).real
        L2 = 2 * L
        u_t = (lambda x, *d: x.permute(*d))(u, 0, 2, 1)
        Kf = (lambda x, *a, **k: torch.fft.rfft(x.float(), *a, **k))(K, L2)
        Uf = (lambda x, *a, **k: torch.fft.rfft(x.float(), *a, **k))(u_t, L2)
        y = (lambda x, *a, **k: torch.fft.irfft(x, *a, **k).to(torch.bfloat16))(Uf * Kf[None, :, :], L2)[:, :, :L]
        y = (lambda x, *d: x.permute(*d))(y, 0, 2, 1)
        return y + u * D_skip[None, None, :]

    def _B_ref(x, W_gate, W_up, W_down):
        gate = torch.einsum("bsd,df->bsf", x, W_gate)
        up = torch.einsum("bsd,df->bsf", x, W_up)
        gate = gate * (lambda x, dt: x.to(dt))(gate > 0, gate.dtype)
        h = gate * up
        return torch.einsum("bsf,fd->bsd", h, W_down)

    x = A_u
    h = x + _A_ref(_layernorm(x, axis=-1), A_log_A_real, A_A_imag, A_C_real, A_C_imag, A_log_dt, A_D_skip)
    h2 = h + _B_ref(_layernorm(h, axis=-1), B_W_gate, B_W_up, B_W_down)
    return h2
```

```asm
; @launch grid=(256,1,1) block=(512,1,1) lds=163840
.amdgcn_target "amdgcn-amd-amdhsa--gfx950"
.text
.globl sequential_preLN__ssm_conv_s4d__glu_gated_reglu__prompt_kernel
.p2align 8
.type sequential_preLN__ssm_conv_s4d__glu_gated_reglu__prompt_kernel,@function
sequential_preLN__ssm_conv_s4d__glu_gated_reglu__prompt_kernel:
    s_cmp_ge_u32 s2, 256
    s_cbranch_scc1 sequential_preLN__ssm_conv_s4d__glu_gated_reglu__prompt_kernel_end
    s_load_dwordx16 s[16:31], s[0:1], 0
    s_load_dwordx8 s[32:39], s[0:1], 64
    s_load_dwordx4 s[40:43], s[0:1], 96
    v_lshrrev_b32 v1, 6, v0
    s_nop 0
    v_readfirstlane_b32 s3, v1
    v_and_b32 v1, 63, v0
    s_cmp_eq_u32 s3, 7
    s_cbranch_scc0 sequential_preLN__ssm_conv_s4d__glu_gated_reglu__prompt_kernel_cpf1
    s_lshr_b32 s4, s2, 3
    s_lshl_b32 s4, s4, 11
    s_cmp_lt_u32 s4, sequential_preLN__ssm_conv_s4d__glu_gated_reglu__prompt_kernel_end-sequential_preLN__ssm_conv_s4d__glu_gated_reglu__prompt_kernel
    s_cbranch_scc0 sequential_preLN__ssm_conv_s4d__glu_gated_reglu__prompt_kernel_cpf1
    s_getpc_b64 s[6:7]
sequential_preLN__ssm_conv_s4d__glu_gated_reglu__prompt_kernel_pcref:
    s_sub_u32 s6, s6, sequential_preLN__ssm_conv_s4d__glu_gated_reglu__prompt_kernel_pcref-sequential_preLN__ssm_conv_s4d__glu_gated_reglu__prompt_kernel
    s_subb_u32 s7, s7, 0
    s_add_u32 s6, s6, s4
    s_addc_u32 s7, s7, 0
    v_lshlrev_b32 v240, 4, v1
    v_mov_b32 v241, 0
    v_add_co_u32 v240, vcc, s6, v240
    v_mov_b32 v242, s7
    s_nop 1
    v_addc_co_u32 v241, vcc, v242, v241, vcc
    v_lshlrev_b32 v243, 4, v1
    v_add_u32 v243, s4, v243
    s_mov_b32 s5, sequential_preLN__ssm_conv_s4d__glu_gated_reglu__prompt_kernel_end-sequential_preLN__ssm_conv_s4d__glu_gated_reglu__prompt_kernel-16
    v_cmp_ge_u32 vcc, s5, v243
    s_and_saveexec_b64 s[8:9], vcc
    global_load_dwordx4 v[244:247], v[240:241], off
    v_add_u32 v243, 1024, v243
    v_cmp_ge_u32 vcc, s5, v243
    s_and_b64 exec, exec, vcc
    s_cbranch_execz sequential_preLN__ssm_conv_s4d__glu_gated_reglu__prompt_kernel_cpf2
    global_load_dwordx4 v[248:251], v[240:241], off offset:1024
sequential_preLN__ssm_conv_s4d__glu_gated_reglu__prompt_kernel_cpf2:
    s_mov_b64 exec, -1
sequential_preLN__ssm_conv_s4d__glu_gated_reglu__prompt_kernel_cpf1:
    s_cmp_eq_u32 s3, 6
    s_cbranch_scc0 sequential_preLN__ssm_conv_s4d__glu_gated_reglu__prompt_kernel_tlb3
    s_waitcnt lgkmcnt(0)
    v_lshlrev_b32 v240, 21, v1
    v_add_u32 v240, 0, v240
    s_mov_b64 exec, 0x7ffffff
    global_load_dword v244, v240, s[42:43]
    s_mov_b64 exec, 3
    v_lshlrev_b32 v240, 21, v1
    global_load_dword v245, v240, s[38:39]
    s_mov_b64 exec, -1
sequential_preLN__ssm_conv_s4d__glu_gated_reglu__prompt_kernel_tlb3:
    s_waitcnt lgkmcnt(0)
    s_mov_b32 s5, 36864
    s_load_dword s31, s[42:43], s5
    s_cmp_lt_u32 s2, 144
    s_cbranch_scc0 sequential_preLN__ssm_conv_s4d__glu_gated_reglu__prompt_kernel_helper
    s_lshl_b32 s4, s2, 2
    s_mov_b32 s44, s18
    s_and_b32 s45, s19, 0xffff
    s_mov_b32 s46, 147456
    s_mov_b32 s47, 0x20000
    s_mov_b32 s48, s20
    s_and_b32 s49, s21, 0xffff
    s_mov_b32 s50, 147456
    s_mov_b32 s51, 0x20000
    s_mov_b32 s52, s22
    s_and_b32 s53, s23, 0xffff
    s_mov_b32 s54, 147456
    s_mov_b32 s55, 0x20000
    s_mov_b32 s56, s24
    s_and_b32 s57, s25, 0xffff
    s_mov_b32 s58, 147456
    s_mov_b32 s59, 0x20000
    s_mov_b32 s60, s26
    s_and_b32 s61, s27, 0xffff
    s_mov_b32 s62, 1152
    s_mov_b32 s63, 0x20000
    s_mov_b32 s68, s28
    s_and_b32 s69, s29, 0xffff
    s_mov_b32 s70, 1152
    s_mov_b32 s71, 0x20000
    v_lshrrev_b32 v2, 7, v0
    v_and_b32 v3, 127, v0
    v_add_u32 v4, s4, v2
    v_lshlrev_b32 v5, 1, v4
    v_lshlrev_b32 v4, 7, v4
    v_add_u32 v4, v4, v3
    v_lshlrev_b32 v4, 1, v4
    buffer_load_ushort v8, v4, s[44:47], 0 offen
    buffer_load_ushort v12, v5, s[60:63], 0 offen
    buffer_load_ushort v9, v4, s[48:51], 0 offen
    buffer_load_ushort v10, v4, s[52:55], 0 offen
    buffer_load_ushort v11, v4, s[56:59], 0 offen
    s_lshr_b32 s6, s3, 1
    s_add_u32 s6, s6, s4
    s_lshl_b32 s6, s6, 1
    v_mov_b32 v6, s6
    buffer_load_ushort v14, v6, s[68:71], 0 offen
    v_and_b32 v36, 255, v0
    v_lshlrev_b32 v37, 3, v36
    v_sub_u32 v37, 2048, v37
    v_subrev_u32 v38, 0, v37
    v_max_i32 v39, 0, v38
    v_cvt_f32_u32 v39, v39
    v_cvt_pk_bf16_f32 v39, v39, v39
    v_lshlrev_b32 v39, 16, v39
    v_cvt_u32_f32 v39, v39
    v_lshrrev_b32 v40, 7, v39
    v_and_b32 v41, 7, v39
    v_bfe_u32 v42, v39, 3, 4
    v_lshl_or_b32 v41, v40, 3, v41
    v_or_b32 v40, 1, v40
    v_ffbh_u32 v40, v40
    v_sub_u32 v40, 31, v40
    v_min_u32 v40, 3, v40
    v_lshrrev_b32 v41, v40, v41
    v_lshl_add_u32 v41, v40, 3, v41
    v_lshlrev_b32 v41, 1, v41
    v_mul_u32_u24 v42, 104, v42
    v_add_u32 v24, v42, v41
    v_subrev_u32 v38, 1, v37
    v_max_i32 v39, 0, v38
    v_cvt_f32_u32 v39, v39
    v_cvt_pk_bf16_f32 v39, v39, v39
    v_lshlrev_b32 v39, 16, v39
    v_cvt_u32_f32 v39, v39
    v_lshrrev_b32 v40, 7, v39
    v_and_b32 v41, 7, v39
    v_bfe_u32 v42, v39, 3, 4
    v_lshl_or_b32 v41, v40, 3, v41
    v_or_b32 v40, 1, v40
    v_ffbh_u32 v40, v40
    v_sub_u32 v40, 31, v40
    v_min_u32 v40, 3, v40
    v_lshrrev_b32 v41, v40, v41
    v_lshl_add_u32 v41, v40, 3, v41
    v_lshlrev_b32 v41, 1, v41
    v_mul_u32_u24 v42, 104, v42
    v_add_u32 v25, v42, v41
    v_subrev_u32 v38, 2, v37
    v_max_i32 v39, 0, v38
    v_cvt_f32_u32 v39, v39
    v_cvt_pk_bf16_f32 v39, v39, v39
    v_lshlrev_b32 v39, 16, v39
    v_cvt_u32_f32 v39, v39
    v_lshrrev_b32 v40, 7, v39
    v_and_b32 v41, 7, v39
    v_bfe_u32 v42, v39, 3, 4
    v_lshl_or_b32 v41, v40, 3, v41
    v_or_b32 v40, 1, v40
    v_ffbh_u32 v40, v40
    v_sub_u32 v40, 31, v40
    v_min_u32 v40, 3, v40
    v_lshrrev_b32 v41, v40, v41
    v_lshl_add_u32 v41, v40, 3, v41
    v_lshlrev_b32 v41, 1, v41
    v_mul_u32_u24 v42, 104, v42
    v_add_u32 v26, v42, v41
    v_subrev_u32 v38, 3, v37
    v_max_i32 v39, 0, v38
    v_cvt_f32_u32 v39, v39
    v_cvt_pk_bf16_f32 v39, v39, v39
    v_lshlrev_b32 v39, 16, v39
    v_cvt_u32_f32 v39, v39
    v_lshrrev_b32 v40, 7, v39
    v_and_b32 v41, 7, v39
    v_bfe_u32 v42, v39, 3, 4
    v_lshl_or_b32 v41, v40, 3, v41
    v_or_b32 v40, 1, v40
    v_ffbh_u32 v40, v40
    v_sub_u32 v40, 31, v40
    v_min_u32 v40, 3, v40
    v_lshrrev_b32 v41, v40, v41
    v_lshl_add_u32 v41, v40, 3, v41
    v_lshlrev_b32 v41, 1, v41
    v_mul_u32_u24 v42, 104, v42
    v_add_u32 v27, v42, v41
    v_subrev_u32 v38, 4, v37
    v_max_i32 v39, 0, v38
    v_cvt_f32_u32 v39, v39
    v_cvt_pk_bf16_f32 v39, v39, v39
    v_lshlrev_b32 v39, 16, v39
    v_cvt_u32_f32 v39, v39
    v_lshrrev_b32 v40, 7, v39
    v_and_b32 v41, 7, v39
    v_bfe_u32 v42, v39, 3, 4
    v_lshl_or_b32 v41, v40, 3, v41
    v_or_b32 v40, 1, v40
    v_ffbh_u32 v40, v40
    v_sub_u32 v40, 31, v40
    v_min_u32 v40, 3, v40
    v_lshrrev_b32 v41, v40, v41
    v_lshl_add_u32 v41, v40, 3, v41
    v_lshlrev_b32 v41, 1, v41
    v_mul_u32_u24 v42, 104, v42
    v_add_u32 v28, v42, v41
    v_subrev_u32 v38, 5, v37
    v_max_i32 v39, 0, v38
    v_cvt_f32_u32 v39, v39
    v_cvt_pk_bf16_f32 v39, v39, v39
    v_lshlrev_b32 v39, 16, v39
    v_cvt_u32_f32 v39, v39
    v_lshrrev_b32 v40, 7, v39
    v_and_b32 v41, 7, v39
    v_bfe_u32 v42, v39, 3, 4
    v_lshl_or_b32 v41, v40, 3, v41
    v_or_b32 v40, 1, v40
    v_ffbh_u32 v40, v40
    v_sub_u32 v40, 31, v40
    v_min_u32 v40, 3, v40
    v_lshrrev_b32 v41, v40, v41
    v_lshl_add_u32 v41, v40, 3, v41
    v_lshlrev_b32 v41, 1, v41
    v_mul_u32_u24 v42, 104, v42
    v_add_u32 v29, v42, v41
    v_subrev_u32 v38, 6, v37
    v_max_i32 v39, 0, v38
    v_cvt_f32_u32 v39, v39
    v_cvt_pk_bf16_f32 v39, v39, v39
    v_lshlrev_b32 v39, 16, v39
    v_cvt_u32_f32 v39, v39
    v_lshrrev_b32 v40, 7, v39
    v_and_b32 v41, 7, v39
    v_bfe_u32 v42, v39, 3, 4
    v_lshl_or_b32 v41, v40, 3, v41
    v_or_b32 v40, 1, v40
    v_ffbh_u32 v40, v40
    v_sub_u32 v40, 31, v40
    v_min_u32 v40, 3, v40
    v_lshrrev_b32 v41, v40, v41
    v_lshl_add_u32 v41, v40, 3, v41
    v_lshlrev_b32 v41, 1, v41
    v_mul_u32_u24 v42, 104, v42
    v_add_u32 v30, v42, v41
    v_subrev_u32 v38, 7, v37
    v_max_i32 v39, 0, v38
    v_cvt_f32_u32 v39, v39
    v_cvt_pk_bf16_f32 v39, v39, v39
    v_lshlrev_b32 v39, 16, v39
    v_cvt_u32_f32 v39, v39
    v_lshrrev_b32 v40, 7, v39
    v_and_b32 v41, 7, v39
    v_bfe_u32 v42, v39, 3, 4
    v_lshl_or_b32 v41, v40, 3, v41
    v_or_b32 v40, 1, v40
    v_ffbh_u32 v40, v40
    v_sub_u32 v40, 31, v40
    v_min_u32 v40, 3, v40
    v_lshrrev_b32 v41, v40, v41
    v_lshl_add_u32 v41, v40, 3, v41
    v_lshlrev_b32 v41, 1, v41
    v_mul_u32_u24 v42, 104, v42
    v_add_u32 v31, v42, v41
    v_subrev_u32 v38, 8, v37
    v_max_i32 v39, 0, v38
    v_cvt_f32_u32 v39, v39
    v_cvt_pk_bf16_f32 v39, v39, v39
    v_lshlrev_b32 v39, 16, v39
    v_cvt_u32_f32 v39, v39
    v_lshrrev_b32 v40, 7, v39
    v_and_b32 v41, 7, v39
    v_bfe_u32 v42, v39, 3, 4
    v_lshl_or_b32 v41, v40, 3, v41
    v_or_b32 v40, 1, v40
    v_ffbh_u32 v40, v40
    v_sub_u32 v40, 31, v40
    v_min_u32 v40, 3, v40
    v_lshrrev_b32 v41, v40, v41
    v_lshl_add_u32 v41, v40, 3, v41
    v_lshlrev_b32 v41, 1, v41
    v_mul_u32_u24 v42, 104, v42
    v_add_u32 v32, v42, v41
    v_subrev_u32 v38, 9, v37
    v_max_i32 v39, 0, v38
    v_cvt_f32_u32 v39, v39
    v_cvt_pk_bf16_f32 v39, v39, v39
    v_lshlrev_b32 v39, 16, v39
    v_cvt_u32_f32 v39, v39
    v_lshrrev_b32 v40, 7, v39
    v_and_b32 v41, 7, v39
    v_bfe_u32 v42, v39, 3, 4
    v_lshl_or_b32 v41, v40, 3, v41
    v_or_b32 v40, 1, v40
    v_ffbh_u32 v40, v40
    v_sub_u32 v40, 31, v40
    v_min_u32 v40, 3, v40
    v_lshrrev_b32 v41, v40, v41
    v_lshl_add_u32 v41, v40, 3, v41
    v_lshlrev_b32 v41, 1, v41
    v_mul_u32_u24 v42, 104, v42
    v_add_u32 v33, v42, v41
    v_cmp_gt_i32 vcc, 0, v38
    v_mov_b32 v43, 1664
    s_nop 0
    v_cndmask_b32 v33, v33, v43, vcc
    v_subrev_u32 v38, 10, v37
    v_max_i32 v39, 0, v38
    v_cvt_f32_u32 v39, v39
    v_cvt_pk_bf16_f32 v39, v39, v39
    v_lshlrev_b32 v39, 16, v39
    v_cvt_u32_f32 v39, v39
    v_lshrrev_b32 v40, 7, v39
    v_and_b32 v41, 7, v39
    v_bfe_u32 v42, v39, 3, 4
    v_lshl_or_b32 v41, v40, 3, v41
    v_or_b32 v40, 1, v40
    v_ffbh_u32 v40, v40
    v_sub_u32 v40, 31, v40
    v_min_u32 v40, 3, v40
    v_lshrrev_b32 v41, v40, v41
    v_lshl_add_u32 v41, v40, 3, v41
    v_lshlrev_b32 v41, 1, v41
    v_mul_u32_u24 v42, 104, v42
    v_add_u32 v34, v42, v41
    v_cmp_gt_i32 vcc, 0, v38
    v_mov_b32 v43, 1664
    s_nop 0
    v_cndmask_b32 v34, v34, v43, vcc
    s_waitcnt vmcnt(1) lgkmcnt(0)
    s_add_u32 s31, s31, 1
    s_mov_b32 s7, 0x3fb8aa3b
    v_lshlrev_b32 v8, 16, v8
    v_lshlrev_b32 v9, 16, v9
    v_lshlrev_b32 v10, 16, v10
    v_lshlrev_b32 v11, 16, v11
    v_lshlrev_b32 v12, 16, v12
    v_mul_f32 v8, s7, v8
    v_mul_f32 v12, s7, v12
    v_exp_f32 v8, v8
    v_exp_f32 v12, v12
    s_nop 0
    v_cvt_pk_bf16_f32 v8, v8, v8
    v_lshlrev_b32 v8, 16, v8
    v_cvt_pk_bf16_f32 v12, v12, v12
    v_lshlrev_b32 v12, 16, v12
    v_mul_f32 v8, v8, v12
    v_mul_f32 v8, s7, v8
    v_sub_f32 v8, 0, v8
    v_mul_f32 v9, v9, v12
    v_mul_f32 v9, 0.15915494, v9
    v_mul_f32 v10, v10, v12
    v_add_f32 v10, v10, v10
    v_mul_f32 v11, v11, v12
    v_add_f32 v11, v11, v11
    v_mul_f32 v40, 0x3f800000, v8
    v_mul_f32 v41, 0x3f800000, v9
    v_mul_f32 v42, 0x41000000, v8
    v_mul_f32 v43, 0x41000000, v9
    v_mul_f32 v44, 0x43000000, v8
    v_mul_f32 v45, 0x43000000, v9
    v_exp_f32 v40, v40
    v_fract_f32 v41, v41
    v_exp_f32 v42, v42
    v_fract_f32 v43, v43
    v_exp_f32 v44, v44
    v_fract_f32 v45, v45
    v_cos_f32 v46, v41
    v_sin_f32 v41, v41
    v_cos_f32 v47, v43
    v_sin_f32 v43, v43
    v_cos_f32 v48, v45
    v_sin_f32 v45, v45
    s_nop 0
    v_mul_f32 v41, v40, v41
    v_mul_f32 v40, v40, v46
    v_mul_f32 v43, v42, v43
    v_mul_f32 v42, v42, v47
    v_mul_f32 v45, v44, v45
    v_mul_f32 v44, v44, v48
    s_mov_b32 s7, 33792
    v_mul_lo_u32 v7, v2, s7
    v_lshlrev_b32 v13, 2, v3
    v_add_u32 v7, v7, v13
    v_mov_b32 v50, 1.0
    v_mov_b32 v51, 0
    v_mov_b32 v52, v40
    v_mov_b32 v53, v41
    v_mul_f32 v80, v53, v41
    v_mov_b32 v72, v10
    v_mul_f32 v81, v53, v40
    v_mov_b32 v73, v11
    v_fma_f32 v54, v52, v40, -v80
    v_cvt_pk_bf16_f32 v88, v72, v73
    v_fma_f32 v55, v52, v41, v81
    ds_write_b32 v7, v88 offset:25344
    v_mul_f32 v80, v55, v41
    v_mul_f32 v84, v73, v43
    v_mul_f32 v81, v55, v40
    v_mul_f32 v85, v73, v42
    v_fma_f32 v56, v54, v40, -v80
    v_fma_f32 v86, v72, v42, -v84
    v_fma_f32 v57, v54, v41, v81
    v_fma_f32 v73, v72, v43, v85
    v_mul_f32 v80, v57, v41
    v_mov_b32 v72, v86
    v_mul_f32 v81, v57, v40
    v_cvt_pk_bf16_f32 v89, v72, v73
    v_fma_f32 v58, v56, v40, -v80
    ds_write_b32 v7, v89 offset:25872
    v_fma_f32 v59, v56, v41, v81
    v_mul_f32 v84, v73, v43
    v_mul_f32 v80, v59, v41
    v_mul_f32 v85, v73, v42
    v_mul_f32 v81, v59, v40
    v_fma_f32 v86, v72, v42, -v84
    v_fma_f32 v60, v58, v40, -v80
    v_fma_f32 v73, v72, v43, v85
    v_fma_f32 v61, v58, v41, v81
    v_mov_b32 v72, v86
    v_mul_f32 v80, v61, v41
    v_cvt_pk_bf16_f32 v88, v72, v73
    v_mul_f32 v81, v61, v40
    ds_write_b32 v7, v88 offset:26400
    v_fma_f32 v62, v60, v40, -v80
    v_mul_f32 v84, v73, v43
    v_fma_f32 v63, v60, v41, v81
    v_mul_f32 v85, v73, v42
    v_mul_f32 v80, v63, v41
    v_fma_f32 v86, v72, v42, -v84
    v_mul_f32 v81, v63, v40
    v_fma_f32 v73, v72, v43, v85
    v_fma_f32 v64, v62, v40, -v80
    v_mov_b32 v72, v86
    v_fma_f32 v65, v62, v41, v81
    v_cvt_pk_bf16_f32 v89, v72, v73
    v_cvt_pk_bf16_f32 v90, v50, -v51
    ds_write_b32 v7, v89 offset:26928
    ds_write_b32 v7, v90 offset:0
    v_mul_f32 v84, v73, v43
    v_cvt_pk_bf16_f32 v91, v52, -v53
    v_mul_f32 v85, v73, v42
    ds_write_b32 v7, v91 offset:528
    v_fma_f32 v86, v72, v42, -v84
    v_cvt_pk_bf16_f32 v90, v54, -v55
    v_fma_f32 v73, v72, v43, v85
    ds_write_b32 v7, v90 offset:1056
    v_mov_b32 v72, v86
    v_cvt_pk_bf16_f32 v91, v56, -v57
    v_cvt_pk_bf16_f32 v88, v72, v73
    ds_write_b32 v7, v91 offset:1584
    ds_write_b32 v7, v88 offset:27456
    v_cvt_pk_bf16_f32 v90, v58, -v59
    v_mul_f32 v84, v73, v43
    ds_write_b32 v7, v90 offset:2112
    v_mul_f32 v85, v73, v42
    v_cvt_pk_bf16_f32 v91, v60, -v61
    v_fma_f32 v86, v72, v42, -v84
    ds_write_b32 v7, v91 offset:2640
    v_fma_f32 v73, v72, v43, v85
    v_cvt_pk_bf16_f32 v90, v62, -v63
    v_mov_b32 v72, v86
    ds_write_b32 v7, v90 offset:3168
    v_cvt_pk_bf16_f32 v89, v72, v73
    v_cvt_pk_bf16_f32 v91, v64, -v65
    ds_write_b32 v7, v89 offset:27984
    ds_write_b32 v7, v91 offset:3696
    v_mul_f32 v84, v73, v43
    v_mov_b32 v70, v44
    v_mul_f32 v85, v73, v42
    v_mov_b32 v71, v45
    v_fma_f32 v86, v72, v42, -v84
    v_cvt_pk_bf16_f32 v92, v70, -v71
    v_fma_f32 v73, v72, v43, v85
    ds_write_b32 v7, v92 offset:4224
    v_mov_b32 v72, v86
    v_mul_f32 v76, v71, v53
    v_cvt_pk_bf16_f32 v88, v72, v73
    v_mul_f32 v77, v71, v52
    ds_write_b32 v7, v88 offset:28512
    v_fma_f32 v74, v70, v52, -v76
    v_mul_f32 v84, v73, v43
    v_fma_f32 v75, v70, v53, v77
    v_mul_f32 v85, v73, v42
    v_cvt_pk_bf16_f32 v93, v74, -v75
    v_fma_f32 v86, v72, v42, -v84
    ds_write_b32 v7, v93 offset:4752
    v_fma_f32 v73, v72, v43, v85
    v_mul_f32 v76, v71, v55
    v_mov_b32 v72, v86
    v_mul_f32 v77, v71, v54
    v_cvt_pk_bf16_f32 v89, v72, v73
    v_fma_f32 v74, v70, v54, -v76
    ds_write_b32 v7, v89 offset:29040
    v_fma_f32 v75, v70, v55, v77
    v_mul_f32 v84, v73, v43
    v_cvt_pk_bf16_f32 v92, v74, -v75
    v_mul_f32 v85, v73, v42
    ds_write_b32 v7, v92 offset:5280
    v_fma_f32 v86, v72, v42, -v84
    v_mul_f32 v76, v71, v57
    v_fma_f32 v73, v72, v43, v85
    v_mul_f32 v77, v71, v56
    v_mov_b32 v72, v86
    v_fma_f32 v74, v70, v56, -v76
    v_cvt_pk_bf16_f32 v88, v72, v73
    v_fma_f32 v75, v70, v57, v77
    ds_write_b32 v7, v88 offset:29568
    v_cvt_pk_bf16_f32 v93, v74, -v75
    v_mul_f32 v84, v73, v43
    ds_write_b32 v7, v93 offset:5808
    v_mul_f32 v85, v73, v42
    v_mul_f32 v76, v71, v59
    v_fma_f32 v86, v72, v42, -v84
    v_mul_f32 v77, v71, v58
    v_fma_f32 v73, v72, v43, v85
    v_fma_f32 v74, v70, v58, -v76
    v_mov_b32 v72, v86
    v_fma_f32 v75, v70, v59, v77
    v_cvt_pk_bf16_f32 v89, v72, v73
    v_cvt_pk_bf16_f32 v92, v74, -v75
    ds_write_b32 v7, v89 offset:30096
    ds_write_b32 v7, v92 offset:6336
    v_mul_f32 v84, v73, v43
    v_mul_f32 v76, v71, v61
    v_mul_f32 v85, v73, v42
    v_mul_f32 v77, v71, v60
    v_fma_f32 v86, v72, v42, -v84
    v_fma_f32 v74, v70, v60, -v76
    v_fma_f32 v73, v72, v43, v85
    v_fma_f32 v75, v70, v61, v77
    v_mov_b32 v72, v86
    v_cvt_pk_bf16_f32 v93, v74, -v75
    v_cvt_pk_bf16_f32 v88, v72, v73
    ds_write_b32 v7, v93 offset:6864
    ds_write_b32 v7, v88 offset:30624
    v_mul_f32 v76, v71, v63
    v_mul_f32 v84, v73, v43
    v_mul_f32 v77, v71, v62
    v_mul_f32 v85, v73, v42
    v_fma_f32 v74, v70, v62, -v76
    v_fma_f32 v86, v72, v42, -v84
    v_fma_f32 v75, v70, v63, v77
    v_fma_f32 v73, v72, v43, v85
    v_cvt_pk_bf16_f32 v92, v74, -v75
    v_mov_b32 v72, v86
    ds_write_b32 v7, v92 offset:7392
    v_cvt_pk_bf16_f32 v89, v72, v73
    v_mul_f32 v76, v71, v65
    ds_write_b32 v7, v89 offset:31152
    v_mul_f32 v77, v71, v64
    v_mul_f32 v84, v73, v43
    v_fma_f32 v74, v70, v64, -v76
    v_mul_f32 v85, v73, v42
    v_fma_f32 v75, v70, v65, v77
    v_fma_f32 v86, v72, v42, -v84
    v_cvt_pk_bf16_f32 v93, v74, -v75
    v_fma_f32 v73, v72, v43, v85
    ds_write_b32 v7, v93 offset:7920
    v_mov_b32 v72, v86
    v_mul_f32 v80, v71, v45
    v_cvt_pk_bf16_f32 v88, v72, v73
    v_mul_f32 v81, v71, v44
    ds_write_b32 v7, v88 offset:31680
    v_fma_f32 v82, v70, v44, -v80
    v_mul_f32 v84, v73, v43
    v_fma_f32 v71, v70, v45, v81
    v_mul_f32 v85, v73, v42
    v_mov_b32 v70, v82
    v_fma_f32 v86, v72, v42, -v84
    v_cvt_pk_bf16_f32 v92, v70, -v71
    v_fma_f32 v73, v72, v43, v85
    ds_write_b32 v7, v92 offset:8448
    v_mov_b32 v72, v86
    v_mul_f32 v76, v71, v55
    v_cvt_pk_bf16_f32 v89, v72, v73
    v_mul_f32 v77, v71, v54
    ds_write_b32 v7, v89 offset:32208
    v_fma_f32 v74, v70, v54, -v76
    v_mul_f32 v84, v73, v43
    v_fma_f32 v75, v70, v55, v77
    v_mul_f32 v85, v73, v42
    v_cvt_pk_bf16_f32 v93, v74, -v75
    v_fma_f32 v86, v72, v42, -v84
    ds_write_b32 v7, v93 offset:8976
    v_fma_f32 v73, v72, v43, v85
    v_mul_f32 v76, v71, v59
    v_mov_b32 v72, v86
    v_mul_f32 v77, v71, v58
    v_cvt_pk_bf16_f32 v88, v72, v73
    v_fma_f32 v74, v70, v58, -v76
    ds_write_b32 v7, v88 offset:32736
    v_fma_f32 v75, v70, v59, v77
    v_mul_f32 v84, v73, v43
    v_cvt_pk_bf16_f32 v92, v74, -v75
    v_mul_f32 v85, v73, v42
    ds_write_b32 v7, v92 offset:9504
    v_fma_f32 v86, v72, v42, -v84
    v_mul_f32 v76, v71, v63
    v_fma_f32 v73, v72, v43, v85
    v_mul_f32 v77, v71, v62
    v_mov_b32 v72, v86
    v_fma_f32 v74, v70, v62, -v76
    v_cvt_pk_bf16_f32 v89, v72, v73
    v_fma_f32 v75, v70, v63, v77
    ds_write_b32 v7, v89 offset:33264
    v_cvt_pk_bf16_f32 v93, v74, -v75
    ds_write_b32 v7, v93 offset:10032
    v_mul_f32 v80, v71, v45
    v_mul_f32 v81, v71, v44
    v_fma_f32 v82, v70, v44, -v80
    v_fma_f32 v71, v70, v45, v81
    v_mov_b32 v70, v82
    v_cvt_pk_bf16_f32 v92, v70, -v71
    ds_write_b32 v7, v92 offset:10560
    v_mul_f32 v76, v71, v55
    v_mul_f32 v77, v71, v54
    v_fma_f32 v74, v70, v54, -v76
    v_fma_f32 v75, v70, v55, v77
    v_cvt_pk_bf16_f32 v93, v74, -v75
    ds_write_b32 v7, v93 offset:11088
    v_mul_f32 v76, v71, v59
    v_mul_f32 v77, v71, v58
    v_fma_f32 v74, v70, v58, -v76
    v_fma_f32 v75, v70, v59, v77
    v_cvt_pk_bf16_f32 v92, v74, -v75
    ds_write_b32 v7, v92 offset:11616
    v_mul_f32 v76, v71, v63
    v_mul_f32 v77, v71, v62
    v_fma_f32 v74, v70, v62, -v76
    v_fma_f32 v75, v70, v63, v77
    v_cvt_pk_bf16_f32 v93, v74, -v75
    ds_write_b32 v7, v93 offset:12144
    v_mul_f32 v80, v71, v45
    v_mul_f32 v81, v71, v44
    v_fma_f32 v82, v70, v44, -v80
    v_fma_f32 v71, v70, v45, v81
    v_mov_b32 v70, v82
    v_cvt_pk_bf16_f32 v92, v70, -v71
    ds_write_b32 v7, v92 offset:12672
    v_mul_f32 v76, v71, v59
    v_mul_f32 v77, v71, v58
    v_fma_f32 v74, v70, v58, -v76
    v_fma_f32 v75, v70, v59, v77
    v_cvt_pk_bf16_f32 v93, v74, -v75
    ds_write_b32 v7, v93 offset:13200
    v_mul_f32 v80, v71, v45
    v_mul_f32 v81, v71, v44
    v_fma_f32 v82, v70, v44, -v80
    v_fma_f32 v71, v70, v45, v81
    v_mov_b32 v70, v82
    v_cvt_pk_bf16_f32 v92, v70, -v71
    ds_write_b32 v7, v92 offset:13728
    v_mul_f32 v76, v71, v59
    v_mul_f32 v77, v71, v58
    v_fma_f32 v74, v70, v58, -v76
    v_fma_f32 v75, v70, v59, v77
    v_cvt_pk_bf16_f32 v93, v74, -v75
    ds_write_b32 v7, v93 offset:14256
    v_mul_f32 v80, v71, v45
    v_mul_f32 v81, v71, v44
    v_fma_f32 v82, v70, v44, -v80
    v_fma_f32 v71, v70, v45, v81
    v_mov_b32 v70, v82
    v_cvt_pk_bf16_f32 v92, v70, -v71
    ds_write_b32 v7, v92 offset:14784
    v_mul_f32 v76, v71, v59
    v_mul_f32 v77, v71, v58
    v_fma_f32 v74, v70, v58, -v76
    v_fma_f32 v75, v70, v59, v77
    v_cvt_pk_bf16_f32 v93, v74, -v75
    ds_write_b32 v7, v93 offset:15312
    v_mul_f32 v80, v71, v45
    v_mul_f32 v81, v71, v44
    v_fma_f32 v82, v70, v44, -v80
    v_fma_f32 v71, v70, v45, v81
    v_mov_b32 v70, v82
    v_cvt_pk_bf16_f32 v92, v70, -v71
    ds_write_b32 v7, v92 offset:15840
    v_mul_f32 v76, v71, v59
    v_mul_f32 v77, v71, v58
    v_fma_f32 v74, v70, v58, -v76
    v_fma_f32 v75, v70, v59, v77
    v_cvt_pk_bf16_f32 v93, v74, -v75
    ds_write_b32 v7, v93 offset:16368
    v_mul_f32 v80, v71, v45
    v_mul_f32 v81, v71, v44
    v_fma_f32 v82, v70, v44, -v80
    v_fma_f32 v71, v70, v45, v81
    v_mov_b32 v70, v82
    v_cvt_pk_bf16_f32 v92, v70, -v71
    ds_write_b32 v7, v92 offset:16896
    v_mul_f32 v80, v71, v45
    v_mul_f32 v81, v71, v44
    v_fma_f32 v82, v70, v44, -v80
    v_fma_f32 v71, v70, v45, v81
    v_mov_b32 v70, v82
    v_cvt_pk_bf16_f32 v93, v70, -v71
    ds_write_b32 v7, v93 offset:17424
    v_mul_f32 v80, v71, v45
    v_mul_f32 v81, v71, v44
    v_fma_f32 v82, v70, v44, -v80
    v_fma_f32 v71, v70, v45, v81
    v_mov_b32 v70, v82
    v_cvt_pk_bf16_f32 v92, v70, -v71
    ds_write_b32 v7, v92 offset:17952
    v_mul_f32 v80, v71, v45
    v_mul_f32 v81, v71, v44
    v_fma_f32 v82, v70, v44, -v80
    v_fma_f32 v71, v70, v45, v81
    v_mov_b32 v70, v82
    v_cvt_pk_bf16_f32 v93, v70, -v71
    ds_write_b32 v7, v93 offset:18480
    v_mul_f32 v80, v71, v45
    v_mul_f32 v81, v71, v44
    v_fma_f32 v82, v70, v44, -v80
    v_fma_f32 v71, v70, v45, v81
    v_mov_b32 v70, v82
    v_cvt_pk_bf16_f32 v92, v70, -v71
    ds_write_b32 v7, v92 offset:19008
    v_mul_f32 v80, v71, v45
    v_mul_f32 v81, v71, v44
    v_fma_f32 v82, v70, v44, -v80
    v_fma_f32 v71, v70, v45, v81
    v_mov_b32 v70, v82
    v_cvt_pk_bf16_f32 v93, v70, -v71
    ds_write_b32 v7, v93 offset:19536
    v_mul_f32 v80, v71, v45
    v_mul_f32 v81, v71, v44
    v_fma_f32 v82, v70, v44, -v80
    v_fma_f32 v71, v70, v45, v81
    v_mov_b32 v70, v82
    v_cvt_pk_bf16_f32 v92, v70, -v71
    ds_write_b32 v7, v92 offset:20064
    v_mul_f32 v80, v71, v45
    v_mul_f32 v81, v71, v44
    v_fma_f32 v82, v70, v44, -v80
    v_fma_f32 v71, v70, v45, v81
    v_mov_b32 v70, v82
    v_cvt_pk_bf16_f32 v93, v70, -v71
    ds_write_b32 v7, v93 offset:20592
    v_mul_f32 v80, v71, v45
    v_mul_f32 v81, v71, v44
    v_fma_f32 v82, v70, v44, -v80
    v_fma_f32 v71, v70, v45, v81
    v_mov_b32 v70, v82
    v_cvt_pk_bf16_f32 v92, v70, -v71
    ds_write_b32 v7, v92 offset:21120
    s_waitcnt lgkmcnt(0)
    s_barrier
    s_cmp_lt_u32 s3, 4
    s_cbranch_scc0 sequential_preLN__ssm_conv_s4d__glu_gated_reglu__prompt_kernel_nokm
    v_and_b32 v40, 15, v1
    v_lshrrev_b32 v41, 4, v1
    v_mul_u32_u24 v42, 528, v40
    v_lshl_add_u32 v42, v41, 4, v42
    s_mul_i32 s7, s3, 33792
    v_add_u32 v42, s7, v42
    v_mov_b32 v44, 0
    v_mov_b32 v45, 0
    v_mov_b32 v46, 0
    v_mov_b32 v47, 0
    v_mov_b32 v48, 0
    v_mov_b32 v49, 0
    v_mov_b32 v50, 0
    v_mov_b32 v51, 0
    v_mov_b32 v52, 0
    v_mov_b32 v53, 0
    v_mov_b32 v54, 0
    v_mov_b32 v55, 0
    ds_read_b128 v[64:67], v42 offset:25344
    ds_read_b128 v[68:71], v42 offset:0
    ds_read_b128 v[72:75], v42 offset:8448
    ds_read_b128 v[76:79], v42 offset:16896
    ds_read_b128 v[80:83], v42 offset:25408
    ds_read_b128 v[84:87], v42 offset:64
    ds_read_b128 v[88:91], v42 offset:8512
    ds_read_b128 v[92:95], v42 offset:16960
    ds_read_b128 v[96:99], v42 offset:25472
    ds_read_b128 v[100:103], v42 offset:128
    ds_read_b128 v[104:107], v42 offset:8576
    ds_read_b128 v[108:111], v42 offset:17024
    s_waitcnt lgkmcnt(8)
    ds_read_b128 v[112:115], v42 offset:25536
    ds_read_b128 v[116:119], v42 offset:192
    ds_read_b128 v[120:123], v42 offset:8640
    ds_read_b128 v[124:127], v42 offset:17088
    v_mfma_f32_16x16x32_bf16 v[44:47], v[68:71], v[64:67], v[44:47]
    v_mfma_f32_16x16x32_bf16 v[48:51], v[72:75], v[64:67], v[48:51]
    v_mfma_f32_16x16x32_bf16 v[52:55], v[76:79], v[64:67], v[52:55]
    s_waitcnt lgkmcnt(8)
    ds_read_b128 v[128:131], v42 offset:25600
    ds_read_b128 v[132:135], v42 offset:256
    ds_read_b128 v[136:139], v42 offset:8704
    ds_read_b128 v[140:143], v42 offset:17152
    v_mfma_f32_16x16x32_bf16 v[44:47], v[84:87], v[80:83], v[44:47]
    v_mfma_f32_16x16x32_bf16 v[48:51], v[88:91], v[80:83], v[48:51]
    v_mfma_f32_16x16x32_bf16 v[52:55], v[92:95], v[80:83], v[52:55]
    s_waitcnt lgkmcnt(8)
    ds_read_b128 v[144:147], v42 offset:25664
    ds_read_b128 v[148:151], v42 offset:320
    ds_read_b128 v[152:155], v42 offset:8768
    ds_read_b128 v[156:159], v42 offset:17216
    v_mfma_f32_16x16x32_bf16 v[44:47], v[100:103], v[96:99], v[44:47]
    v_mfma_f32_16x16x32_bf16 v[48:51], v[104:107], v[96:99], v[48:51]
    v_mfma_f32_16x16x32_bf16 v[52:55], v[108:111], v[96:99], v[52:55]
    s_waitcnt lgkmcnt(8)
    ds_read_b128 v[160:163], v42 offset:25728
    ds_read_b128 v[164:167], v42 offset:384
    ds_read_b128 v[168:171], v42 offset:8832
    ds_read_b128 v[172:175], v42 offset:17280
    v_mfma_f32_16x16x32_bf16 v[44:47], v[116:119], v[112:115], v[44:47]
    v_mfma_f32_16x16x32_bf16 v[48:51], v[120:123], v[112:115], v[48:51]
    v_mfma_f32_16x16x32_bf16 v[52:55], v[124:127], v[112:115], v[52:55]
    s_waitcnt lgkmcnt(8)
    ds_read_b128 v[176:179], v42 offset:25792
    ds_read_b128 v[180:183], v42 offset:448
    ds_read_b128 v[184:187], v42 offset:8896
    ds_read_b128 v[188:191], v42 offset:17344
    v_mfma_f32_16x16x32_bf16 v[44:47], v[132:135], v[128:131], v[44:47]
    v_mfma_f32_16x16x32_bf16 v[48:51], v[136:139], v[128:131], v[48:51]
    v_mfma_f32_16x16x32_bf16 v[52:55], v[140:143], v[128:131], v[52:55]
    s_waitcnt lgkmcnt(8)
    v_mfma_f32_16x16x32_bf16 v[44:47], v[148:151], v[144:147], v[44:47]
    v_mfma_f32_16x16x32_bf16 v[48:51], v[152:155], v[144:147], v[48:51]
    v_mfma_f32_16x16x32_bf16 v[52:55], v[156:159], v[144:147], v[52:55]
    s_waitcnt lgkmcnt(4)
    v_mfma_f32_16x16x32_bf16 v[44:47], v[164:167], v[160:163], v[44:47]
    v_mfma_f32_16x16x32_bf16 v[48:51], v[168:171], v[160:163], v[48:51]
    v_mfma_f32_16x16x32_bf16 v[52:55], v[172:175], v[160:163], v[52:55]
    s_waitcnt lgkmcnt(0)
    v_mfma_f32_16x16x32_bf16 v[44:47], v[180:183], v[176:179], v[44:47]
    v_mfma_f32_16x16x32_bf16 v[48:51], v[184:187], v[176:179], v[48:51]
    v_mfma_f32_16x16x32_bf16 v[52:55], v[188:191], v[176:179], v[52:55]
    v_mul_u32_u24 v42, 104, v40
    v_lshl_add_u32 v42, v41, 3, v42
    s_mul_i32 s7, s3, 1680
    s_add_u32 s7, s7, 135168
    v_add_u32 v42, s7, v42
    s_nop 5
    v_cvt_pk_bf16_f32 v56, v44, v45
    v_cvt_pk_bf16_f32 v57, v46, v47
    ds_write_b64 v42, v[56:57] offset:0
    v_cvt_pk_bf16_f32 v58, v48, v49
    v_cvt_pk_bf16_f32 v59, v50, v51
    ds_write_b64 v42, v[58:59] offset:32
    v_cvt_pk_bf16_f32 v60, v52, v53
    v_cvt_pk_bf16_f32 v61, v54, v55
    ds_write_b64 v42, v[60:61] offset:64
    v_mov_b32 v43, 0
    s_add_u32 s7, s7, 1664
    v_lshlrev_b32 v42, 2, v1
    v_add_u32 v42, s7, v42
    s_mov_b64 exec, 0xf
    ds_write_b32 v42, v43
    s_mov_b64 exec, -1
sequential_preLN__ssm_conv_s4d__glu_gated_reglu__prompt_kernel_nokm:
    s_waitcnt lgkmcnt(0)
    s_barrier
    v_lshrrev_b32 v41, 8, v0
    v_mul_u32_u24 v42, 1680, v41
    v_add_u32 v42, 135168, v42
    v_add_u32 v24, v42, v24
    v_add_u32 v25, v42, v25
    v_add_u32 v26, v42, v26
    v_add_u32 v27, v42, v27
    v_add_u32 v28, v42, v28
    v_add_u32 v29, v42, v29
    v_add_u32 v30, v42, v30
    v_add_u32 v31, v42, v31
    v_add_u32 v32, v42, v32
    v_add_u32 v33, v42, v33
    v_add_u32 v34, v42, v34
    ds_read_u16 v48, v24 offset:0
    ds_read_u16 v49, v25 offset:0
    ds_read_u16 v50, v26 offset:0
    ds_read_u16 v51, v27 offset:0
    ds_read_u16 v52, v28 offset:0
    ds_read_u16 v53, v29 offset:0
    ds_read_u16 v54, v30 offset:0
    ds_read_u16 v55, v31 offset:0
    ds_read_u16 v56, v32 offset:0
    ds_read_u16 v57, v33 offset:0
    ds_read_u16 v58, v34 offset:0
    ds_read_u16 v59, v42 offset:0
    ds_read_u16 v60, v24 offset:3360
    ds_read_u16 v61, v25 offset:3360
    ds_read_u16 v62, v26 offset:3360
    ds_read_u16 v63, v27 offset:3360
    ds_read_u16 v64, v28 offset:3360
    ds_read_u16 v65, v29 offset:3360
    ds_read_u16 v66, v30 offset:3360
    ds_read_u16 v67, v31 offset:3360
    ds_read_u16 v68, v32 offset:3360
    ds_read_u16 v69, v33 offset:3360
    ds_read_u16 v70, v34 offset:3360
    ds_read_u16 v71, v42 offset:3360
    v_mul_u32_u24 v44, 16640, v41
    v_lshl_add_u32 v44, v36, 4, v44
    s_waitcnt lgkmcnt(12)
    v_lshl_or_b32 v176, v49, 16, v48
    v_lshl_or_b32 v177, v51, 16, v50
    v_lshl_or_b32 v178, v53, 16, v52
    v_lshl_or_b32 v179, v55, 16, v54
    v_lshl_or_b32 v180, v50, 16, v49
    v_lshl_or_b32 v181, v52, 16, v51
    v_lshl_or_b32 v182, v54, 16, v53
    v_lshl_or_b32 v183, v56, 16, v55
    v_lshl_or_b32 v184, v51, 16, v50
    v_lshl_or_b32 v185, v53, 16, v52
    v_lshl_or_b32 v186, v55, 16, v54
    v_lshl_or_b32 v187, v57, 16, v56
    v_lshl_or_b32 v188, v52, 16, v51
    v_lshl_or_b32 v189, v54, 16, v53
    v_lshl_or_b32 v190, v56, 16, v55
    v_lshl_or_b32 v191, v58, 16, v57
    ds_write_b128 v44, v[176:179] offset:0
    ds_write_b128 v44, v[180:183] offset:4160
    ds_write_b128 v44, v[184:187] offset:8320
    ds_write_b128 v44, v[188:191] offset:12480
    s_waitcnt lgkmcnt(4)
    v_lshl_or_b32 v192, v61, 16, v60
    v_lshl_or_b32 v193, v63, 16, v62
    v_lshl_or_b32 v194, v65, 16, v64
    v_lshl_or_b32 v195, v67, 16, v66
    v_lshl_or_b32 v196, v62, 16, v61
    v_lshl_or_b32 v197, v64, 16, v63
    v_lshl_or_b32 v198, v66, 16, v65
    v_lshl_or_b32 v199, v68, 16, v67
    v_lshl_or_b32 v200, v63, 16, v62
    v_lshl_or_b32 v201, v65, 16, v64
    v_lshl_or_b32 v202, v67, 16, v66
    v_lshl_or_b32 v203, v69, 16, v68
    v_lshl_or_b32 v204, v64, 16, v63
    v_lshl_or_b32 v205, v66, 16, v65
    v_lshl_or_b32 v206, v68, 16, v67
    v_lshl_or_b32 v207, v70, 16, v69
    ds_write_b128 v44, v[192:195] offset:33280
    ds_write_b128 v44, v[196:199] offset:37440
    ds_write_b128 v44, v[200:203] offset:41600
    ds_write_b128 v44, v[204:207] offset:45760
    v_cmp_gt_u32 vcc, 2, v36
    s_and_saveexec_b64 s[8:9], vcc
    s_cbranch_execz sequential_preLN__ssm_conv_s4d__glu_gated_reglu__prompt_kernel_tl4
    v_cmp_eq_u32 vcc, 0, v36
    v_mov_b32 v113, 0
    v_mov_b32 v114, 0
    v_mov_b32 v115, 0
    v_mov_b32 v116, 0
    v_mov_b32 v117, 0
    v_mov_b32 v118, 0
    v_mov_b32 v119, 0
    v_cndmask_b32 v112, 0, v59, vcc
    ds_write_b128 v44, v[112:115] offset:4096
    ds_write_b128 v44, v[116:119] offset:8256
    ds_write_b128 v44, v[116:119] offset:12416
    ds_write_b128 v44, v[116:119] offset:16576
    s_nop 1
    v_cndmask_b32 v112, 0, v71, vcc
    ds_write_b128 v44, v[112:115] offset:37376
    ds_write_b128 v44, v[116:119] offset:41536
    ds_write_b128 v44, v[116:119] offset:45696
    ds_write_b128 v44, v[116:119] offset:49856
    s_nop 1
sequential_preLN__ssm_conv_s4d__glu_gated_reglu__prompt_kernel_tl4:
    s_mov_b64 exec, s[8:9]
    v_cmp_gt_u32 vcc, 120, v0
    s_and_saveexec_b64 s[8:9], vcc
    s_cbranch_execz sequential_preLN__ssm_conv_s4d__glu_gated_reglu__prompt_kernel_zp5
    s_mov_b32 s7, 0x08888889
    v_mul_hi_u32 v42, v0, s7
    v_mul_u32_u24 v43, 30, v42
    v_sub_u32 v43, v0, v43
    v_mul_u32_u24 v42, 4608, v42
    v_lshl_add_u32 v42, v43, 4, v42
    v_mov_b32 v80, 0
    v_mov_b32 v81, 0
    v_mov_b32 v82, 0
    v_mov_b32 v83, 0
    v_add_u32 v42, 66560, v42
    ds_write_b128 v42, v[80:83]
sequential_preLN__ssm_conv_s4d__glu_gated_reglu__prompt_kernel_zp5:
    s_mov_b64 exec, s[8:9]
    s_cmp_eq_u32 s3, 4
    s_cbranch_scc0 sequential_preLN__ssm_conv_s4d__glu_gated_reglu__prompt_kernel_kmd
    s_cmp_ge_u32 s4, 288
    s_cselect_b32 s7, 128, 0
    s_add_u32 s7, s7, 40960
    v_lshl_add_u32 v40, v1, 8, s7
    s_mov_b32 exec_hi, 0
    s_mov_b32 s60, 0
sequential_preLN__ssm_conv_s4d__glu_gated_reglu__prompt_kernel_fl6:
    global_load_dword v41, v40, s[42:43] sc1
    s_add_u32 s60, s60, 1
    s_waitcnt vmcnt(0)
    v_cmp_ne_u32 vcc, s31, v41
    s_cmp_eq_u64 vcc, 0
    s_cbranch_scc1 sequential_preLN__ssm_conv_s4d__glu_gated_reglu__prompt_kernel_fld7
    s_cmp_ge_u32 s60, 0x200000
    s_cbranch_scc1 sequential_preLN__ssm_conv_s4d__glu_gated_reglu__prompt_kernel_fld7
    s_sleep 1
    s_branch sequential_preLN__ssm_conv_s4d__glu_gated_reglu__prompt_kernel_fl6
sequential_preLN__ssm_conv_s4d__glu_gated_reglu__prompt_kernel_fld7:
    s_mov_b64 exec, -1
sequential_preLN__ssm_conv_s4d__glu_gated_reglu__prompt_kernel_kmd:
    s_barrier
    s_lshr_b32 s6, s3, 1
    s_and_b32 s7, s3, 1
    s_cmp_eq_u32 s7, 0
    s_mov_b32 s9, 45613056
    s_cselect_b32 s8, s9, 42991616
    s_add_u32 s44, s42, s8
    s_addc_u32 s45, s43, 0
    s_and_b32 s45, s45, 0xffff
    s_mov_b32 s46, 2359296
    s_mov_b32 s47, 0x20000
    s_mul_i32 s8, s6, 4608
    s_add_u32 s8, s8, 67040
    s_lshl_b32 s9, s6, 12
    s_add_u32 s9, s9, 84992
    s_cmp_eq_u32 s7, 0
    s_cselect_b32 m0, s8, s9
    s_add_u32 s8, s6, s4
    s_lshl_b32 s8, s8, 12
    v_lshlrev_b32 v40, 4, v1
    buffer_load_dwordx4 v40, s[44:47], s8 offen offset:0 sc1 lds
    buffer_load_dwordx4 v40, s[44:47], s8 offen offset:1024 sc1 lds
    buffer_load_dwordx4 v40, s[44:47], s8 offen offset:2048 sc1 lds
    buffer_load_dwordx4 v40, s[44:47], s8 offen offset:3072 sc1 lds
    s_lshr_b32 s6, s3, 1
    s_and_b32 s7, s3, 1
    v_and_b32 v7, 15, v1
    v_lshrrev_b32 v8, 4, v1
    v_and_b32 v11, 3, v7
    v_sub_u32 v12, 4, v11
    v_and_b32 v12, 3, v12
    v_add_u32 v13, v7, v12
    v_mul_u32_u24 v12, 4160, v12
    v_lshlrev_b32 v13, 1, v13
    v_sub_u32 v12, v12, v13
    v_lshlrev_b32 v13, 4, v8
    v_add_u32 v12, v12, v13
    s_mul_i32 s8, s6, 16640
    s_xor_b32 s9, s7, 1
    s_lshl_b32 s9, s9, 8
    s_add_u32 s8, s8, s9
    s_add_u32 s8, s8, 32
    v_add_u32 v12, s8, v12
    v_lshlrev_b32 v15, 5, v7
    v_add_u32 v15, v15, v13
    s_mul_i32 s8, s6, 4608
    s_add_u32 s8, s8, s9
    s_add_u32 s8, s8, 66560
    v_add_u32 v15, s8, v15
    s_waitcnt vmcnt(0) lgkmcnt(0)
    s_barrier
    ds_read_b128 v[64:67], v15 offset:192
    ds_read_b128 v[68:71], v15 offset:704
    ds_read_b128 v[72:75], v15 offset:1216
    ds_read_b128 v[76:79], v15 offset:1728
    ds_read_b128 v[80:83], v15 offset:2240
    ds_read_b128 v[84:87], v15 offset:2752
    ds_read_b128 v[88:91], v15 offset:3264
    ds_read_b128 v[92:95], v15 offset:3776
    ds_read_b64 v[128:129], v12 offset:3776
    ds_read_b64 v[130:131], v12 offset:3784
    ds_read_b64 v[132:133], v12 offset:3264
    ds_read_b64 v[134:135], v12 offset:3272
    ds_read_b64 v[136:137], v12 offset:2752
    ds_read_b64 v[138:139], v12 offset:2760
    ds_read_b64 v[140:141], v12 offset:2240
    ds_read_b64 v[142:143], v12 offset:2248
    ds_read_b64 v[144:145], v12 offset:1728
    ds_read_b64 v[146:147], v12 offset:1736
    ds_read_b64 v[148:149], v12 offset:1216
    ds_read_b64 v[150:151], v12 offset:1224
    ds_read_b64 v[152:153], v12 offset:704
    ds_read_b64 v[154:155], v12 offset:712
    ds_read_b64 v[156:157], v12 offset:192
    ds_read_b64 v[158:159], v12 offset:200
    s_waitcnt lgkmcnt(0)
    v_mfma_f32_16x16x32_bf16 v[32:35], v[128:131], v[64:67], 0
    ds_read_b128 v[96:99], v15 offset:128
    v_mfma_f32_16x16x32_bf16 v[36:39], v[128:131], v[68:71], 0
    ds_read_b128 v[100:103], v15 offset:640
    v_mfma_f32_16x16x32_bf16 v[40:43], v[128:131], v[72:75], 0
    ds_read_b128 v[104:107], v15 offset:1152
    v_mfma_f32_16x16x32_bf16 v[44:47], v[128:131], v[76:79], 0
    ds_read_b128 v[108:111], v15 offset:1664
    v_mfma_f32_16x16x32_bf16 v[48:51], v[128:131], v[80:83], 0
    ds_read_b128 v[112:115], v15 offset:2176
    v_mfma_f32_16x16x32_bf16 v[52:55], v[128:131], v[84:87], 0
    ds_read_b128 v[116:119], v15 offset:2688
    v_mfma_f32_16x16x32_bf16 v[56:59], v[128:131], v[88:91], 0
    ds_read_b128 v[120:123], v15 offset:3200
    v_mfma_f32_16x16x32_bf16 v[60:63], v[128:131], v[92:95], 0
    ds_read_b128 v[124:127], v15 offset:3712
    v_mfma_f32_16x16x32_bf16 v[36:39], v[132:135], v[64:67], v[36:39]
    ds_read_b64 v[160:161], v12 offset:3712
    v_mfma_f32_16x16x32_bf16 v[40:43], v[132:135], v[68:71], v[40:43]
    ds_read_b64 v[162:163], v12 offset:3720
    v_mfma_f32_16x16x32_bf16 v[44:47], v[132:135], v[72:75], v[44:47]
    ds_read_b64 v[164:165], v12 offset:3200
    v_mfma_f32_16x16x32_bf16 v[48:51], v[132:135], v[76:79], v[48:51]
    ds_read_b64 v[166:167], v12 offset:3208
    v_mfma_f32_16x16x32_bf16 v[52:55], v[132:135], v[80:83], v[52:55]
    ds_read_b64 v[168:169], v12 offset:2688
    v_mfma_f32_16x16x32_bf16 v[56:59], v[132:135], v[84:87], v[56:59]
    ds_read_b64 v[170:171], v12 offset:2696
    v_mfma_f32_16x16x32_bf16 v[60:63], v[132:135], v[88:91], v[60:63]
    ds_read_b64 v[172:173], v12 offset:2176
    v_mfma_f32_16x16x32_bf16 v[40:43], v[136:139], v[64:67], v[40:43]
    ds_read_b64 v[174:175], v12 offset:2184
    v_mfma_f32_16x16x32_bf16 v[44:47], v[136:139], v[68:71], v[44:47]
    ds_read_b64 v[176:177], v12 offset:1664
    v_mfma_f32_16x16x32_bf16 v[48:51], v[136:139], v[72:75], v[48:51]
    ds_read_b64 v[178:179], v12 offset:1672
    v_mfma_f32_16x16x32_bf16 v[52:55], v[136:139], v[76:79], v[52:55]
    ds_read_b64 v[180:181], v12 offset:1152
    v_mfma_f32_16x16x32_bf16 v[56:59], v[136:139], v[80:83], v[56:59]
    ds_read_b64 v[182:183], v12 offset:1160
    v_mfma_f32_16x16x32_bf16 v[60:63], v[136:139], v[84:87], v[60:63]
    ds_read_b64 v[184:185], v12 offset:640
    v_mfma_f32_16x16x32_bf16 v[44:47], v[140:143], v[64:67], v[44:47]
    ds_read_b64 v[186:187], v12 offset:648
    v_mfma_f32_16x16x32_bf16 v[48:51], v[140:143], v[68:71], v[48:51]
    ds_read_b64 v[188:189], v12 offset:128
    v_mfma_f32_16x16x32_bf16 v[52:55], v[140:143], v[72:75], v[52:55]
    ds_read_b64 v[190:191], v12 offset:136
    v_mfma_f32_16x16x32_bf16 v[56:59], v[140:143], v[76:79], v[56:59]
    v_mfma_f32_16x16x32_bf16 v[60:63], v[140:143], v[80:83], v[60:63]
    v_mfma_f32_16x16x32_bf16 v[48:51], v[144:147], v[64:67], v[48:51]
    v_mfma_f32_16x16x32_bf16 v[52:55], v[144:147], v[68:71], v[52:55]
    v_mfma_f32_16x16x32_bf16 v[56:59], v[144:147], v[72:75], v[56:59]
    v_mfma_f32_16x16x32_bf16 v[60:63], v[144:147], v[76:79], v[60:63]
    v_mfma_f32_16x16x32_bf16 v[52:55], v[148:151], v[64:67], v[52:55]
    v_mfma_f32_16x16x32_bf16 v[56:59], v[148:151], v[68:71], v[56:59]
    v_mfma_f32_16x16x32_bf16 v[60:63], v[148:151], v[72:75], v[60:63]
    v_mfma_f32_16x16x32_bf16 v[56:59], v[152:155], v[64:67], v[56:59]
    v_mfma_f32_16x16x32_bf16 v[60:63], v[152:155], v[68:71], v[60:63]
    v_mfma_f32_16x16x32_bf16 v[60:63], v[156:159], v[64:67], v[60:63]
    s_waitcnt lgkmcnt(0)
    v_mfma_f32_16x16x32_bf16 v[32:35], v[160:163], v[96:99], v[32:35]
    ds_read_b128 v[64:67], v15 offset:64
    v_mfma_f32_16x16x32_bf16 v[36:39], v[160:163], v[100:103], v[36:39]
    ds_read_b128 v[68:71], v15 offset:576
    v_mfma_f32_16x16x32_bf16 v[40:43], v[160:163], v[104:107], v[40:43]
    ds_read_b128 v[72:75], v15 offset:1088
    v_mfma_f32_16x16x32_bf16 v[44:47], v[160:163], v[108:111], v[44:47]
    ds_read_b128 v[76:79], v15 offset:1600
    v_mfma_f32_16x16x32_bf16 v[48:51], v[160:163], v[112:115], v[48:51]
    ds_read_b128 v[80:83], v15 offset:2112
    v_mfma_f32_16x16x32_bf16 v[52:55], v[160:163], v[116:119], v[52:55]
    ds_read_b128 v[84:87], v15 offset:2624
    v_mfma_f32_16x16x32_bf16 v[56:59], v[160:163], v[120:123], v[56:59]
    ds_read_b128 v[88:91], v15 offset:3136
    v_mfma_f32_16x16x32_bf16 v[60:63], v[160:163], v[124:127], v[60:63]
    ds_read_b128 v[92:95], v15 offset:3648
    v_mfma_f32_16x16x32_bf16 v[36:39], v[164:167], v[96:99], v[36:39]
    ds_read_b64 v[128:129], v12 offset:3648
    v_mfma_f32_16x16x32_bf16 v[40:43], v[164:167], v[100:103], v[40:43]
    ds_read_b64 v[130:131], v12 offset:3656
    v_mfma_f32_16x16x32_bf16 v[44:47], v[164:167], v[104:107], v[44:47]
    ds_read_b64 v[132:133], v12 offset:3136
    v_mfma_f32_16x16x32_bf16 v[48:51], v[164:167], v[108:111], v[48:51]
    ds_read_b64 v[134:135], v12 offset:3144
    v_mfma_f32_16x16x32_bf16 v[52:55], v[164:167], v[112:115], v[52:55]
    ds_read_b64 v[136:137], v12 offset:2624
    v_mfma_f32_16x16x32_bf16 v[56:59], v[164:167], v[116:119], v[56:59]
    ds_read_b64 v[138:139], v12 offset:2632
    v_mfma_f32_16x16x32_bf16 v[60:63], v[164:167], v[120:123], v[60:63]
    ds_read_b64 v[140:141], v12 offset:2112
    v_mfma_f32_16x16x32_bf16 v[40:43], v[168:171], v[96:99], v[40:43]
    ds_read_b64 v[142:143], v12 offset:2120
    v_mfma_f32_16x16x32_bf16 v[44:47], v[168:171], v[100:103], v[44:47]
    ds_read_b64 v[144:145], v12 offset:1600
    v_mfma_f32_16x16x32_bf16 v[48:51], v[168:171], v[104:107], v[48:51]
    ds_read_b64 v[146:147], v12 offset:1608
    v_mfma_f32_16x16x32_bf16 v[52:55], v[168:171], v[108:111], v[52:55]
    ds_read_b64 v[148:149], v12 offset:1088
    v_mfma_f32_16x16x32_bf16 v[56:59], v[168:171], v[112:115], v[56:59]
    ds_read_b64 v[150:151], v12 offset:1096
    v_mfma_f32_16x16x32_bf16 v[60:63], v[168:171], v[116:119], v[60:63]
    ds_read_b64 v[152:153], v12 offset:576
    v_mfma_f32_16x16x32_bf16 v[44:47], v[172:175], v[96:99], v[44:47]
    ds_read_b64 v[154:155], v12 offset:584
    v_mfma_f32_16x16x32_bf16 v[48:51], v[172:175], v[100:103], v[48:51]
    ds_read_b64 v[156:157], v12 offset:64
    v_mfma_f32_16x16x32_bf16 v[52:55], v[172:175], v[104:107], v[52:55]
    ds_read_b64 v[158:159], v12 offset:72
    v_mfma_f32_16x16x32_bf16 v[56:59], v[172:175], v[108:111], v[56:59]
    v_mfma_f32_16x16x32_bf16 v[60:63], v[172:175], v[112:115], v[60:63]
    v_mfma_f32_16x16x32_bf16 v[48:51], v[176:179], v[96:99], v[48:51]
    v_mfma_f32_16x16x32_bf16 v[52:55], v[176:179], v[100:103], v[52:55]
    v_mfma_f32_16x16x32_bf16 v[56:59], v[176:179], v[104:107], v[56:59]
    v_mfma_f32_16x16x32_bf16 v[60:63], v[176:179], v[108:111], v[60:63]
    v_mfma_f32_16x16x32_bf16 v[52:55], v[180:183], v[96:99], v[52:55]
    v_mfma_f32_16x16x32_bf16 v[56:59], v[180:183], v[100:103], v[56:59]
    v_mfma_f32_16x16x32_bf16 v[60:63], v[180:183], v[104:107], v[60:63]
    v_mfma_f32_16x16x32_bf16 v[56:59], v[184:187], v[96:99], v[56:59]
    v_mfma_f32_16x16x32_bf16 v[60:63], v[184:187], v[100:103], v[60:63]
    v_mfma_f32_16x16x32_bf16 v[60:63], v[188:191], v[96:99], v[60:63]
    s_waitcnt lgkmcnt(0)
    v_mfma_f32_16x16x32_bf16 v[32:35], v[128:131], v[64:67], v[32:35]
    ds_read_b128 v[96:99], v15 offset:0
    v_mfma_f32_16x16x32_bf16 v[36:39], v[128:131], v[68:71], v[36:39]
    ds_read_b128 v[100:103], v15 offset:512
    v_mfma_f32_16x16x32_bf16 v[40:43], v[128:131], v[72:75], v[40:43]
    ds_read_b128 v[104:107], v15 offset:1024
    v_mfma_f32_16x16x32_bf16 v[44:47], v[128:131], v[76:79], v[44:47]
    ds_read_b128 v[108:111], v15 offset:1536
    v_mfma_f32_16x16x32_bf16 v[48:51], v[128:131], v[80:83], v[48:51]
    ds_read_b128 v[112:115], v15 offset:2048
    v_mfma_f32_16x16x32_bf16 v[52:55], v[128:131], v[84:87], v[52:55]
    ds_read_b128 v[116:119], v15 offset:2560
    v_mfma_f32_16x16x32_bf16 v[56:59], v[128:131], v[88:91], v[56:59]
    ds_read_b128 v[120:123], v15 offset:3072
    v_mfma_f32_16x16x32_bf16 v[60:63], v[128:131], v[92:95], v[60:63]
    ds_read_b128 v[124:127], v15 offset:3584
    v_mfma_f32_16x16x32_bf16 v[36:39], v[132:135], v[64:67], v[36:39]
    ds_read_b64 v[160:161], v12 offset:3584
    v_mfma_f32_16x16x32_bf16 v[40:43], v[132:135], v[68:71], v[40:43]
    ds_read_b64 v[162:163], v12 offset:3592
    v_mfma_f32_16x16x32_bf16 v[44:47], v[132:135], v[72:75], v[44:47]
    ds_read_b64 v[164:165], v12 offset:3072
    v_mfma_f32_16x16x32_bf16 v[48:51], v[132:135], v[76:79], v[48:51]
    ds_read_b64 v[166:167], v12 offset:3080
    v_mfma_f32_16x16x32_bf16 v[52:55], v[132:135], v[80:83], v[52:55]
    ds_read_b64 v[168:169], v12 offset:2560
    v_mfma_f32_16x16x32_bf16 v[56:59], v[132:135], v[84:87], v[56:59]
    ds_read_b64 v[170:171], v12 offset:2568
    v_mfma_f32_16x16x32_bf16 v[60:63], v[132:135], v[88:91], v[60:63]
    ds_read_b64 v[172:173], v12 offset:2048
    v_mfma_f32_16x16x32_bf16 v[40:43], v[136:139], v[64:67], v[40:43]
    ds_read_b64 v[174:175], v12 offset:2056
    v_mfma_f32_16x16x32_bf16 v[44:47], v[136:139], v[68:71], v[44:47]
    ds_read_b64 v[176:177], v12 offset:1536
    v_mfma_f32_16x16x32_bf16 v[48:51], v[136:139], v[72:75], v[48:51]
    ds_read_b64 v[178:179], v12 offset:1544
    v_mfma_f32_16x16x32_bf16 v[52:55], v[136:139], v[76:79], v[52:55]
    ds_read_b64 v[180:181], v12 offset:1024
    v_mfma_f32_16x16x32_bf16 v[56:59], v[136:139], v[80:83], v[56:59]
    ds_read_b64 v[182:183], v12 offset:1032
    v_mfma_f32_16x16x32_bf16 v[60:63], v[136:139], v[84:87], v[60:63]
    ds_read_b64 v[184:185], v12 offset:512
    v_mfma_f32_16x16x32_bf16 v[44:47], v[140:143], v[64:67], v[44:47]
    ds_read_b64 v[186:187], v12 offset:520
    v_mfma_f32_16x16x32_bf16 v[48:51], v[140:143], v[68:71], v[48:51]
    ds_read_b64 v[188:189], v12 offset:0
    v_mfma_f32_16x16x32_bf16 v[52:55], v[140:143], v[72:75], v[52:55]
    ds_read_b64 v[190:191], v12 offset:8
    v_mfma_f32_16x16x32_bf16 v[56:59], v[140:143], v[76:79], v[56:59]
    v_mfma_f32_16x16x32_bf16 v[60:63], v[140:143], v[80:83], v[60:63]
    v_mfma_f32_16x16x32_bf16 v[48:51], v[144:147], v[64:67], v[48:51]
    v_mfma_f32_16x16x32_bf16 v[52:55], v[144:147], v[68:71], v[52:55]
    v_mfma_f32_16x16x32_bf16 v[56:59], v[144:147], v[72:75], v[56:59]
    v_mfma_f32_16x16x32_bf16 v[60:63], v[144:147], v[76:79], v[60:63]
    v_mfma_f32_16x16x32_bf16 v[52:55], v[148:151], v[64:67], v[52:55]
    v_mfma_f32_16x16x32_bf16 v[56:59], v[148:151], v[68:71], v[56:59]
    v_mfma_f32_16x16x32_bf16 v[60:63], v[148:151], v[72:75], v[60:63]
    v_mfma_f32_16x16x32_bf16 v[56:59], v[152:155], v[64:67], v[56:59]
    v_mfma_f32_16x16x32_bf16 v[60:63], v[152:155], v[68:71], v[60:63]
    v_mfma_f32_16x16x32_bf16 v[60:63], v[156:159], v[64:67], v[60:63]
    s_waitcnt lgkmcnt(0)
    v_mfma_f32_16x16x32_bf16 v[32:35], v[160:163], v[96:99], v[32:35]
    v_mfma_f32_16x16x32_bf16 v[36:39], v[160:163], v[100:103], v[36:39]
    v_mfma_f32_16x16x32_bf16 v[40:43], v[160:163], v[104:107], v[40:43]
    v_mfma_f32_16x16x32_bf16 v[44:47], v[160:163], v[108:111], v[44:47]
    v_mfma_f32_16x16x32_bf16 v[48:51], v[160:163], v[112:115], v[48:51]
    v_mfma_f32_16x16x32_bf16 v[52:55], v[160:163], v[116:119], v[52:55]
    v_mfma_f32_16x16x32_bf16 v[56:59], v[160:163], v[120:123], v[56:59]
    v_mfma_f32_16x16x32_bf16 v[60:63], v[160:163], v[124:127], v[60:63]
    v_mfma_f32_16x16x32_bf16 v[36:39], v[164:167], v[96:99], v[36:39]
    v_mfma_f32_16x16x32_bf16 v[40:43], v[164:167], v[100:103], v[40:43]
    v_mfma_f32_16x16x32_bf16 v[44:47], v[164:167], v[104:107], v[44:47]
    v_mfma_f32_16x16x32_bf16 v[48:51], v[164:167], v[108:111], v[48:51]
    v_mfma_f32_16x16x32_bf16 v[52:55], v[164:167], v[112:115], v[52:55]
    v_mfma_f32_16x16x32_bf16 v[56:59], v[164:167], v[116:119], v[56:59]
    v_mfma_f32_16x16x32_bf16 v[60:63], v[164:167], v[120:123], v[60:63]
    v_mfma_f32_16x16x32_bf16 v[40:43], v[168:171], v[96:99], v[40:43]
    v_mfma_f32_16x16x32_bf16 v[44:47], v[168:171], v[100:103], v[44:47]
    v_mfma_f32_16x16x32_bf16 v[48:51], v[168:171], v[104:107], v[48:51]
    v_mfma_f32_16x16x32_bf16 v[52:55], v[168:171], v[108:111], v[52:55]
    v_mfma_f32_16x16x32_bf16 v[56:59], v[168:171], v[112:115], v[56:59]
    v_mfma_f32_16x16x32_bf16 v[60:63], v[168:171], v[116:119], v[60:63]
    v_mfma_f32_16x16x32_bf16 v[44:47], v[172:175], v[96:99], v[44:47]
    v_mfma_f32_16x16x32_bf16 v[48:51], v[172:175], v[100:103], v[48:51]
    v_mfma_f32_16x16x32_bf16 v[52:55], v[172:175], v[104:107], v[52:55]
    v_mfma_f32_16x16x32_bf16 v[56:59], v[172:175], v[108:111], v[56:59]
    v_mfma_f32_16x16x32_bf16 v[60:63], v[172:175], v[112:115], v[60:63]
    v_mfma_f32_16x16x32_bf16 v[48:51], v[176:179], v[96:99], v[48:51]
    v_mfma_f32_16x16x32_bf16 v[52:55], v[176:179], v[100:103], v[52:55]
    v_mfma_f32_16x16x32_bf16 v[56:59], v[176:179], v[104:107], v[56:59]
    v_mfma_f32_16x16x32_bf16 v[60:63], v[176:179], v[108:111], v[60:63]
    v_mfma_f32_16x16x32_bf16 v[52:55], v[180:183], v[96:99], v[52:55]
    v_mfma_f32_16x16x32_bf16 v[56:59], v[180:183], v[100:103], v[56:59]
    v_mfma_f32_16x16x32_bf16 v[60:63], v[180:183], v[104:107], v[60:63]
    v_mfma_f32_16x16x32_bf16 v[56:59], v[184:187], v[96:99], v[56:59]
    v_mfma_f32_16x16x32_bf16 v[60:63], v[184:187], v[100:103], v[60:63]
    v_mfma_f32_16x16x32_bf16 v[60:63], v[188:191], v[96:99], v[60:63]
    v_lshlrev_b32 v9, 4, v1
    s_lshl_b32 s8, s3, 12
    s_add_u32 s8, s8, 101376
    v_add_u32 v10, s8, v9
    s_xor_b32 s8, s3, 1
    s_lshl_b32 s8, s8, 12
    s_add_u32 s8, s8, 101376
    v_add_u32 v17, s8, v9
    v_lshlrev_b32 v11, 5, v7
    v_lshl_add_u32 v11, v8, 3, v11
    s_lshl_b32 s9, s7, 11
    v_add_u32 v11, s9, v11
    s_mul_i32 s8, s6, 4608
    s_add_u32 s8, s8, 67040
    v_add_u32 v12, s8, v11
    s_lshl_b32 s8, s6, 12
    s_add_u32 s8, s8, 84992
    v_add_u32 v13, s8, v11
    s_cmp_eq_u32 s7, 0
    s_cbranch_scc1 sequential_preLN__ssm_conv_s4d__glu_gated_reglu__prompt_kernel_sw8
    v_swap_b32 v32, v48
    v_swap_b32 v33, v49
    v_swap_b32 v34, v50
    v_swap_b32 v35, v51
    v_swap_b32 v36, v52
    v_swap_b32 v37, v53
    v_swap_b32 v38, v54
    v_swap_b32 v39, v55
    v_swap_b32 v40, v56
    v_swap_b32 v41, v57
    v_swap_b32 v42, v58
    v_swap_b32 v43, v59
    v_swap_b32 v44, v60
    v_swap_b32 v45, v61
    v_swap_b32 v46, v62
    v_swap_b32 v47, v63
sequential_preLN__ssm_conv_s4d__glu_gated_reglu__prompt_kernel_sw8:
    ds_write_b128 v10, v[48:51] offset:0
    ds_write_b128 v10, v[52:55] offset:1024
    ds_write_b128 v10, v[56:59] offset:2048
    ds_write_b128 v10, v[60:63] offset:3072
    ds_read_b64 v[64:65], v12 offset:0
    ds_read_b64 v[72:73], v13 offset:0
    ds_read_b64 v[66:67], v12 offset:512
    ds_read_b64 v[74:75], v13 offset:512
    ds_read_b64 v[68:69], v12 offset:1024
    ds_read_b64 v[76:77], v13 offset:1024
    ds_read_b64 v[70:71], v12 offset:1536
    ds_read_b64 v[78:79], v13 offset:1536
    s_add_u32 s8, s6, s4
    s_lshl_b32 s8, s8, 12
    v_and_b32 v9, 1, v8
    v_lshlrev_b32 v9, 9, v9
    v_lshl_add_u32 v9, v7, 5, v9
    v_lshrrev_b32 v16, 1, v8
    v_lshl_add_u32 v9, v16, 4, v9
    s_add_u32 s8, s8, s9
    v_add_u32 v9, s8, v9
    s_add_u32 s44, s42, 262144
    s_addc_u32 s45, s43, 0
    s_and_b32 s45, s45, 0xffff
    s_mov_b32 s46, 2359296
    s_mov_b32 s47, 0x20000
    v_lshlrev_b32 v14, 16, v14
    s_waitcnt lgkmcnt(0)
    s_barrier
    ds_read_b128 v[80:83], v17 offset:0
    ds_read_b128 v[84:87], v17 offset:1024
    ds_read_b128 v[88:91], v17 offset:2048
    ds_read_b128 v[92:95], v17 offset:3072
    s_mov_b32 s7, 0xffff0000
    v_lshlrev_b32 v112, 16, v64
    v_and_b32 v113, s7, v64
    v_lshlrev_b32 v114, 16, v65
    v_and_b32 v115, s7, v65
    v_mul_f32 v112, v14, v112
    v_mul_f32 v113, v14, v113
    v_mul_f32 v114, v14, v114
    v_mul_f32 v115, v14, v115
    v_cvt_pk_bf16_f32 v96, v112, v113
    v_cvt_pk_bf16_f32 v97, v114, v115
    v_lshlrev_b32 v112, 16, v96
    v_and_b32 v113, s7, v96
    v_lshlrev_b32 v114, 16, v97
    v_and_b32 v115, s7, v97
    v_lshlrev_b32 v116, 16, v66
    v_and_b32 v117, s7, v66
    v_lshlrev_b32 v118, 16, v67
    v_and_b32 v119, s7, v67
    v_mul_f32 v116, v14, v116
    v_mul_f32 v117, v14, v117
    v_mul_f32 v118, v14, v118
    v_mul_f32 v119, v14, v119
    v_cvt_pk_bf16_f32 v96, v116, v117
    v_cvt_pk_bf16_f32 v97, v118, v119
    v_lshlrev_b32 v116, 16, v96
    v_and_b32 v117, s7, v96
    v_lshlrev_b32 v118, 16, v97
    v_and_b32 v119, s7, v97
    v_lshlrev_b32 v120, 16, v68
    v_and_b32 v121, s7, v68
    v_lshlrev_b32 v122, 16, v69
    v_and_b32 v123, s7, v69
    v_mul_f32 v120, v14, v120
    v_mul_f32 v121, v14, v121
    v_mul_f32 v122, v14, v122
    v_mul_f32 v123, v14, v123
    v_cvt_pk_bf16_f32 v96, v120, v121
    v_cvt_pk_bf16_f32 v97, v122, v123
    v_lshlrev_b32 v120, 16, v96
    v_and_b32 v121, s7, v96
    v_lshlrev_b32 v122, 16, v97
    v_and_b32 v123, s7, v97
    v_lshlrev_b32 v124, 16, v70
    v_and_b32 v125, s7, v70
    v_lshlrev_b32 v126, 16, v71
    v_and_b32 v127, s7, v71
    v_mul_f32 v124, v14, v124
    v_mul_f32 v125, v14, v125
    v_mul_f32 v126, v14, v126
    v_mul_f32 v127, v14, v127
    v_cvt_pk_bf16_f32 v96, v124, v125
    v_cvt_pk_bf16_f32 v97, v126, v127
    v_lshlrev_b32 v124, 16, v96
    v_and_b32 v125, s7, v96
    v_lshlrev_b32 v126, 16, v97
    v_and_b32 v127, s7, v97
    s_waitcnt lgkmcnt(0)
    v_add_f32 v32, v32, v80
    v_add_f32 v33, v33, v81
    v_add_f32 v34, v34, v82
    v_add_f32 v35, v35, v83
    v_cvt_pk_bf16_f32 v96, v32, v33
    v_cvt_pk_bf16_f32 v97, v34, v35
    v_lshlrev_b32 v32, 16, v96
    v_and_b32 v33, s7, v96
    v_lshlrev_b32 v34, 16, v97
    v_and_b32 v35, s7, v97
    v_add_f32 v32, v32, v112
    v_add_f32 v33, v33, v113
    v_add_f32 v34, v34, v114
    v_add_f32 v35, v35, v115
    v_cvt_pk_bf16_f32 v96, v32, v33
    v_cvt_pk_bf16_f32 v97, v34, v35
    v_lshlrev_b32 v32, 16, v96
    v_and_b32 v33, s7, v96
    v_lshlrev_b32 v104, 16, v72
    v_and_b32 v105, s7, v72
    v_lshlrev_b32 v34, 16, v97
    v_and_b32 v35, s7, v97
    v_lshlrev_b32 v106, 16, v73
    v_and_b32 v107, s7, v73
    v_add_f32 v32, v32, v104
    v_add_f32 v33, v33, v105
    v_add_f32 v34, v34, v106
    v_add_f32 v35, v35, v107
    v_cvt_pk_bf16_f32 v128, v32, v33
    v_cvt_pk_bf16_f32 v129, v34, v35
    v_add_f32 v36, v36, v84
    v_add_f32 v37, v37, v85
    v_add_f32 v38, v38, v86
    v_add_f32 v39, v39, v87
    v_cvt_pk_bf16_f32 v96, v36, v37
    v_cvt_pk_bf16_f32 v97, v38, v39
    v_lshlrev_b32 v36, 16, v96
    v_and_b32 v37, s7, v96
    v_lshlrev_b32 v38, 16, v97
    v_and_b32 v39, s7, v97
    v_add_f32 v36, v36, v116
    v_add_f32 v37, v37, v117
    v_add_f32 v38, v38, v118
    v_add_f32 v39, v39, v119
    v_cvt_pk_bf16_f32 v96, v36, v37
    v_cvt_pk_bf16_f32 v97, v38, v39
    v_lshlrev_b32 v36, 16, v96
    v_and_b32 v37, s7, v96
    v_lshlrev_b32 v104, 16, v74
    v_and_b32 v105, s7, v74
    v_lshlrev_b32 v38, 16, v97
    v_and_b32 v39, s7, v97
    v_lshlrev_b32 v106, 16, v75
    v_and_b32 v107, s7, v75
    v_add_f32 v36, v36, v104
    v_add_f32 v37, v37, v105
    v_add_f32 v38, v38, v106
    v_add_f32 v39, v39, v107
    v_cvt_pk_bf16_f32 v130, v36, v37
    v_cvt_pk_bf16_f32 v131, v38, v39
    s_nop 1
    v_permlane16_swap_b32 v128, v130
    v_permlane16_swap_b32 v129, v131
    buffer_store_dwordx4 v[128:131], v9, s[44:47], 0 offen offset:0 sc1
    v_add_f32 v40, v40, v88
    v_add_f32 v41, v41, v89
    v_add_f32 v42, v42, v90
    v_add_f32 v43, v43, v91
    v_cvt_pk_bf16_f32 v96, v40, v41
    v_cvt_pk_bf16_f32 v97, v42, v43
    v_lshlrev_b32 v40, 16, v96
    v_and_b32 v41, s7, v96
    v_lshlrev_b32 v42, 16, v97
    v_and_b32 v43, s7, v97
    v_add_f32 v40, v40, v120
    v_add_f32 v41, v41, v121
    v_add_f32 v42, v42, v122
    v_add_f32 v43, v43, v123
    v_cvt_pk_bf16_f32 v96, v40, v41
    v_cvt_pk_bf16_f32 v97, v42, v43
    v_lshlrev_b32 v40, 16, v96
    v_and_b32 v41, s7, v96
    v_lshlrev_b32 v104, 16, v76
    v_and_b32 v105, s7, v76
    v_lshlrev_b32 v42, 16, v97
    v_and_b32 v43, s7, v97
    v_lshlrev_b32 v106, 16, v77
    v_and_b32 v107, s7, v77
    v_add_f32 v40, v40, v104
    v_add_f32 v41, v41, v105
    v_add_f32 v42, v42, v106
    v_add_f32 v43, v43, v107
    v_cvt_pk_bf16_f32 v132, v40, v41
    v_cvt_pk_bf16_f32 v133, v42, v43
    v_add_f32 v44, v44, v92
    v_add_f32 v45, v45, v93
    v_add_f32 v46, v46, v94
    v_add_f32 v47, v47, v95
    v_cvt_pk_bf16_f32 v96, v44, v45
    v_cvt_pk_bf16_f32 v97, v46, v47
    v_lshlrev_b32 v44, 16, v96
    v_and_b32 v45, s7, v96
    v_lshlrev_b32 v46, 16, v97
    v_and_b32 v47, s7, v97
    v_add_f32 v44, v44, v124
    v_add_f32 v45, v45, v125
    v_add_f32 v46, v46, v126
    v_add_f32 v47, v47, v127
    v_cvt_pk_bf16_f32 v96, v44, v45
    v_cvt_pk_bf16_f32 v97, v46, v47
    v_lshlrev_b32 v44, 16, v96
    v_and_b32 v45, s7, v96
    v_lshlrev_b32 v104, 16, v78
    v_and_b32 v105, s7, v78
    v_lshlrev_b32 v46, 16, v97
    v_and_b32 v47, s7, v97
    v_lshlrev_b32 v106, 16, v79
    v_and_b32 v107, s7, v79
    v_add_f32 v44, v44, v104
    v_add_f32 v45, v45, v105
    v_add_f32 v46, v46, v106
    v_add_f32 v47, v47, v107
    v_cvt_pk_bf16_f32 v134, v44, v45
    v_cvt_pk_bf16_f32 v135, v46, v47
    s_nop 1
    v_permlane16_swap_b32 v132, v134
    v_permlane16_swap_b32 v133, v135
    buffer_store_dwordx4 v[132:135], v9, s[44:47], 0 offen offset:1024 sc1
    s_branch sequential_preLN__ssm_conv_s4d__glu_gated_reglu__prompt_kernel_a_done
sequential_preLN__ssm_conv_s4d__glu_gated_reglu__prompt_kernel_helper:
    s_sub_u32 s4, s2, 144
    s_lshr_b32 s5, s4, 3
    s_and_b32 s6, s2, 7
    s_lshl_b32 s6, s6, 2
    s_and_b32 s7, s5, 3
    s_add_u32 s6, s6, s7
    s_lshr_b32 s5, s5, 2
    s_cmp_lt_u32 s4, 64
    s_cbranch_scc0 sequential_preLN__ssm_conv_s4d__glu_gated_reglu__prompt_kernel_not
    s_mov_b32 s72, s16
    s_and_b32 s73, s17, 0xffff
    s_mov_b32 s74, 2359296
    s_mov_b32 s75, 0x20000
    v_lshrrev_b32 v60, 3, v0
    v_and_b32 v61, 7, v0
    s_lshr_b32 s12, s4, 1
    s_lshl_b32 s12, s12, 6
    v_add_u32 v62, s12, v60
    v_mul_u32_u24 v62, 1152, v62
    v_lshl_add_u32 v62, v61, 4, v62
    buffer_load_dwordx4 v[64:67], v62, s[72:75], 0 offen offset:0
    buffer_load_dwordx4 v[68:71], v62, s[72:75], 0 offen offset:128
    buffer_load_dwordx4 v[72:75], v62, s[72:75], 0 offen offset:256
    buffer_load_dwordx4 v[76:79], v62, s[72:75], 0 offen offset:384
    buffer_load_dwordx4 v[80:83], v62, s[72:75], 0 offen offset:512
    buffer_load_dwordx4 v[84:87], v62, s[72:75], 0 offen offset:640
    buffer_load_dwordx4 v[88:91], v62, s[72:75], 0 offen offset:768
    buffer_load_dwordx4 v[92:95], v62, s[72:75], 0 offen offset:896
    buffer_load_dwordx4 v[96:99], v62, s[72:75], 0 offen offset:1024
    v_mul_u32_u24 v62, 1184, v60
    v_lshl_add_u32 v62, v61, 4, v62
    v_mov_b32 v100, 0
    v_mov_b32 v101, 0
    v_mov_b32 v102, 0
    v_mov_b32 v103, 0
    v_mov_b32 v104, 0x3f803f80
    s_waitcnt vmcnt(8)
    ds_write_b128 v62, v[64:67] offset:0
    v_dot2c_f32_bf16 v100, v64, v104
    v_dot2c_f32_bf16 v102, v64, v64
    v_dot2c_f32_bf16 v101, v65, v104
    v_dot2c_f32_bf16 v103, v65, v65
    v_dot2c_f32_bf16 v100, v66, v104
    v_dot2c_f32_bf16 v102, v66, v66
    v_dot2c_f32_bf16 v101, v67, v104
    v_dot2c_f32_bf16 v103, v67, v67
    s_waitcnt vmcnt(7)
    ds_write_b128 v62, v[68:71] offset:128
    v_dot2c_f32_bf16 v100, v68, v104
    v_dot2c_f32_bf16 v102, v68, v68
    v_dot2c_f32_bf16 v101, v69, v104
    v_dot2c_f32_bf16 v103, v69, v69
    v_dot2c_f32_bf16 v100, v70, v104
    v_dot2c_f32_bf16 v102, v70, v70
    v_dot2c_f32_bf16 v101, v71, v104
    v_dot2c_f32_bf16 v103, v71, v71
    s_waitcnt vmcnt(6)
    ds_write_b128 v62, v[72:75] offset:256
    v_dot2c_f32_bf16 v100, v72, v104
    v_dot2c_f32_bf16 v102, v72, v72
    v_dot2c_f32_bf16 v101, v73, v104
    v_dot2c_f32_bf16 v103, v73, v73
    v_dot2c_f32_bf16 v100, v74, v104
    v_dot2c_f32_bf16 v102, v74, v74
    v_dot2c_f32_bf16 v101, v75, v104
    v_dot2c_f32_bf16 v103, v75, v75
    s_waitcnt vmcnt(5)
    ds_write_b128 v62, v[76:79] offset:384
    v_dot2c_f32_bf16 v100, v76, v104
    v_dot2c_f32_bf16 v102, v76, v76
    v_dot2c_f32_bf16 v101, v77, v104
    v_dot2c_f32_bf16 v103, v77, v77
    v_dot2c_f32_bf16 v100, v78, v104
    v_dot2c_f32_bf16 v102, v78, v78
    v_dot2c_f32_bf16 v101, v79, v104
    v_dot2c_f32_bf16 v103, v79, v79
    s_waitcnt vmcnt(4)
    ds_write_b128 v62, v[80:83] offset:512
    v_dot2c_f32_bf16 v100, v80, v104
    v_dot2c_f32_bf16 v102, v80, v80
    v_dot2c_f32_bf16 v101, v81, v104
    v_dot2c_f32_bf16 v103, v81, v81
    v_dot2c_f32_bf16 v100, v82, v104
    v_dot2c_f32_bf16 v102, v82, v82
    v_dot2c_f32_bf16 v101, v83, v104
    v_dot2c_f32_bf16 v103, v83, v83
    s_waitcnt vmcnt(3)
    ds_write_b128 v62, v[84:87] offset:640
    v_dot2c_f32_bf16 v100, v84, v104
    v_dot2c_f32_bf16 v102, v84, v84
    v_dot2c_f32_bf16 v101, v85, v104
    v_dot2c_f32_bf16 v103, v85, v85
    v_dot2c_f32_bf16 v100, v86, v104
    v_dot2c_f32_bf16 v102, v86, v86
    v_dot2c_f32_bf16 v101, v87, v104
    v_dot2c_f32_bf16 v103, v87, v87
    s_waitcnt vmcnt(2)
    ds_write_b128 v62, v[88:91] offset:768
    v_dot2c_f32_bf16 v100, v88, v104
    v_dot2c_f32_bf16 v102, v88, v88
    v_dot2c_f32_bf16 v101, v89, v104
    v_dot2c_f32_bf16 v103, v89, v89
    v_dot2c_f32_bf16 v100, v90, v104
    v_dot2c_f32_bf16 v102, v90, v90
    v_dot2c_f32_bf16 v101, v91, v104
    v_dot2c_f32_bf16 v103, v91, v91
    s_waitcnt vmcnt(1)
    ds_write_b128 v62, v[92:95] offset:896
    v_dot2c_f32_bf16 v100, v92, v104
    v_dot2c_f32_bf16 v102, v92, v92
    v_dot2c_f32_bf16 v101, v93, v104
    v_dot2c_f32_bf16 v103, v93, v93
    v_dot2c_f32_bf16 v100, v94, v104
    v_dot2c_f32_bf16 v102, v94, v94
    v_dot2c_f32_bf16 v101, v95, v104
    v_dot2c_f32_bf16 v103, v95, v95
    s_waitcnt vmcnt(0)
    ds_write_b128 v62, v[96:99] offset:1024
    v_dot2c_f32_bf16 v100, v96, v104
    v_dot2c_f32_bf16 v102, v96, v96
    v_dot2c_f32_bf16 v101, v97, v104
    v_dot2c_f32_bf16 v103, v97, v97
    v_dot2c_f32_bf16 v100, v98, v104
    v_dot2c_f32_bf16 v102, v98, v98
    v_dot2c_f32_bf16 v101, v99, v104
    v_dot2c_f32_bf16 v103, v99, v99
    s_nop 2
    v_add_f32 v100, v100, v101
    v_add_f32 v102, v102, v103
    s_nop 1
    v_add_f32_dpp v100, v100, v100 quad_perm:[1,0,3,2] row_mask:0xf bank_mask:0xf
    v_add_f32_dpp v102, v102, v102 quad_perm:[1,0,3,2] row_mask:0xf bank_mask:0xf
    s_nop 1
    v_add_f32_dpp v100, v100, v100 quad_perm:[2,3,0,1] row_mask:0xf bank_mask:0xf
    v_add_f32_dpp v102, v102, v102 quad_perm:[2,3,0,1] row_mask:0xf bank_mask:0xf
    s_nop 1
    v_add_f32_dpp v100, v100, v100 row_half_mirror row_mask:0xf bank_mask:0xf
    v_add_f32_dpp v102, v102, v102 row_half_mirror row_mask:0xf bank_mask:0xf
    s_mov_b32 s12, 0x3ae38e39
    v_mul_f32 v100, s12, v100
    v_mul_f32 v102, s12, v102
    v_fma_f32 v102, -v100, v100, v102
    v_max_f32 v102, 0, v102
    v_cvt_pk_bf16_f32 v100, v100, v100
    v_lshlrev_b32 v100, 16, v100
    v_cvt_pk_bf16_f32 v102, v102, v102
    v_lshlrev_b32 v102, 16, v102
    v_add_f32 v102, 0x3727c5ac, v102
    v_cvt_pk_bf16_f32 v102, v102, v102
    v_lshlrev_b32 v102, 16, v102
    v_sqrt_f32 v102, v102
    s_nop 0
    v_cvt_pk_bf16_f32 v102, v102, v102
    v_lshlrev_b32 v102, 16, v102
    v_rcp_f32 v101, v102
    s_nop 0
    v_lshlrev_b32 v62, 3, v60
    v_add_u32 v62, 75776, v62
    v_cmp_eq_u32 vcc, 0, v61
    s_and_saveexec_b64 s[12:13], vcc
    ds_write_b64 v62, v[100:101]
    s_mov_b64 exec, s[12:13]
    s_add_u32 s72, s42, 42991616
    s_addc_u32 s73, s43, 0
    s_and_b32 s73, s73, 0xffff
    s_mov_b32 s74, 2359296
    s_mov_b32 s75, 0x20000
    s_add_u32 s76, s42, 45613056
    s_addc_u32 s77, s43, 0
    s_and_b32 s77, s77, 0xffff
    s_mov_b32 s78, 2359296
    s_mov_b32 s79, 0x20000
    v_lshrrev_b32 v60, 4, v1
    v_bfe_u32 v61, v1, 2, 2
    v_and_b32 v62, 3, v1
    v_lshrrev_b32 v63, 1, v62
    v_lshl_add_u32 v63, v60, 1, v63
    v_lshl_add_u32 v63, v63, 3, v61
    v_mul_u32_u24 v63, 1184, v63
    v_and_b32 v64, 1, v62
    v_lshl_add_u32 v63, v64, 3, v63
    s_and_b32 s12, s4, 1
    s_mul_i32 s12, s12, 576
    s_lshl_b32 s13, s3, 4
    s_add_u32 s12, s12, s13
    v_add_u32 v63, s12, v63
    v_bfe_u32 v64, v1, 3, 1
    v_lshl_add_u32 v64, v60, 1, v64
    v_lshlrev_b32 v64, 6, v64
    v_add_u32 v64, 75776, v64
    v_lshrrev_b32 v65, 3, v1
    v_and_b32 v66, 7, v1
    v_lshrrev_b32 v67, 1, v66
    v_lshlrev_b32 v67, 4, v67
    v_and_b32 v104, 1, v66
    v_lshl_add_u32 v67, v104, 3, v67
    v_lshrrev_b32 v104, 2, v65
    v_lshl_add_u32 v67, v104, 2, v67
    v_and_b32 v104, 3, v65
    v_add_u32 v67, v67, v104
    v_lshlrev_b32 v67, 2, v67
    v_lshlrev_b32 v65, 12, v65
    v_lshl_add_u32 v65, v66, 4, v65
    s_and_b32 s12, s4, 1
    s_mul_i32 s12, s12, 1179648
    s_lshl_b32 s13, s3, 15
    s_add_u32 s12, s12, s13
    s_lshr_b32 s13, s4, 1
    s_lshl_b32 s13, s13, 7
    s_add_u32 s12, s12, s13
    v_add_u32 v65, s12, v65
    s_waitcnt lgkmcnt(0)
    s_barrier
    ds_read_b128 v[68:71], v64 offset:0
    ds_read_b128 v[72:75], v64 offset:16
    ds_read_b128 v[76:79], v64 offset:32
    ds_read_b128 v[80:83], v64 offset:48
    s_mov_b32 s15, 0xffff0000
    s_mov_b32 s14, 0
    s_cmp_lt_u32 s3, 4
    s_cselect_b32 s13, 5, 4
    ds_read_b64_tr_b16 v[112:113], v63 offset:0
    ds_read_b64_tr_b16 v[114:115], v63 offset:4736
sequential_preLN__ssm_conv_s4d__glu_gated_reglu__prompt_kernel_tl9:
    s_waitcnt lgkmcnt(0)
    v_mov_b32 v116, v112
    v_mov_b32 v117, v113
    v_mov_b32 v118, v114
    v_mov_b32 v119, v115
    v_add_u32 v63, 128, v63
    ds_read_b64_tr_b16 v[112:113], v63 offset:0
    ds_read_b64_tr_b16 v[114:115], v63 offset:4736
    ds_bpermute_b32 v152, v67, v116
    ds_bpermute_b32 v153, v67, v117
    ds_bpermute_b32 v154, v67, v118
    ds_bpermute_b32 v155, v67, v119
    v_lshlrev_b32 v88, 16, v116
    v_and_b32 v89, s15, v116
    v_lshlrev_b32 v90, 16, v117
    v_and_b32 v91, s15, v117
    v_lshlrev_b32 v92, 16, v118
    v_and_b32 v93, s15, v118
    v_lshlrev_b32 v94, 16, v119
    v_and_b32 v95, s15, v119
    v_sub_f32 v88, v88, v68
    v_sub_f32 v89, v89, v70
    v_sub_f32 v90, v90, v72
    v_sub_f32 v91, v91, v74
    v_sub_f32 v92, v92, v76
    v_sub_f32 v93, v93, v78
    v_sub_f32 v94, v94, v80
    v_sub_f32 v95, v95, v82
    v_cvt_pk_bf16_f32 v96, v88, v89
    v_cvt_pk_bf16_f32 v97, v90, v91
    v_cvt_pk_bf16_f32 v98, v92, v93
    v_cvt_pk_bf16_f32 v99, v94, v95
    v_lshlrev_b32 v88, 16, v96
    v_and_b32 v89, s15, v96
    v_lshlrev_b32 v90, 16, v97
    v_and_b32 v91, s15, v97
    v_lshlrev_b32 v92, 16, v98
    v_and_b32 v93, s15, v98
    v_lshlrev_b32 v94, 16, v99
    v_and_b32 v95, s15, v99
    v_mul_f32 v88, v88, v69
    v_mul_f32 v89, v89, v71
    v_mul_f32 v90, v90, v73
    v_mul_f32 v91, v91, v75
    v_mul_f32 v92, v92, v77
    v_mul_f32 v93, v93, v79
    v_mul_f32 v94, v94, v81
    v_mul_f32 v95, v95, v83
    v_cvt_pk_bf16_f32 v132, v88, v89
    v_cvt_pk_bf16_f32 v133, v90, v91
    v_cvt_pk_bf16_f32 v134, v92, v93
    v_cvt_pk_bf16_f32 v135, v94, v95
    ds_bpermute_b32 v156, v67, v132
    ds_bpermute_b32 v157, v67, v133
    ds_bpermute_b32 v158, v67, v134
    ds_bpermute_b32 v159, v67, v135
    s_waitcnt lgkmcnt(4)
    buffer_store_dwordx4 v[152:155], v65, s[72:75], s14 offen sc1
    s_waitcnt lgkmcnt(0)
    buffer_store_dwordx4 v[156:159], v65, s[76:79], s14 offen sc1
    s_add_u32 s14, s14, 262144
    s_sub_u32 s13, s13, 1
    s_cmp_lg_u32 s13, 0
    s_cbranch_scc1 sequential_preLN__ssm_conv_s4d__glu_gated_reglu__prompt_kernel_tl9
    s_waitcnt vmcnt(0) lgkmcnt(0)
    s_add_u32 s31, s31, 1
    s_barrier
    s_cmp_eq_u32 s3, 0
    s_cbranch_scc0 sequential_preLN__ssm_conv_s4d__glu_gated_reglu__prompt_kernel_tp10
    s_lshl_b32 s12, s4, 7
    s_add_u32 s12, s12, 40960
    s_mov_b64 exec, 1
    v_mov_b32 v250, s12
    v_mov_b32 v251, s31
    global_store_dword v250, v251, s[42:43] sc1
    s_mov_b64 exec, -1
sequential_preLN__ssm_conv_s4d__glu_gated_reglu__prompt_kernel_tp10:
    s_branch sequential_preLN__ssm_conv_s4d__glu_gated_reglu__prompt_kernel_tdone
sequential_preLN__ssm_conv_s4d__glu_gated_reglu__prompt_kernel_not:
    s_waitcnt lgkmcnt(0)
    s_add_u32 s31, s31, 1
sequential_preLN__ssm_conv_s4d__glu_gated_reglu__prompt_kernel_tdone:
    s_cmp_eq_u32 s4, 64
    s_cbranch_scc0 sequential_preLN__ssm_conv_s4d__glu_gated_reglu__prompt_kernel_nz11
    s_add_u32 s44, s42, 0
    s_addc_u32 s45, s43, 0
    s_and_b32 s45, s45, 0xffff
    s_mov_b32 s46, 32768
    s_mov_b32 s47, 0x20000
    v_lshlrev_b32 v2, 4, v0
    v_mov_b32 v4, 0
    v_mov_b32 v5, 0
    v_mov_b32 v6, 0
    v_mov_b32 v7, 0
    s_mov_b32 s8, 0
    buffer_store_dwordx4 v[4:7], v2, s[44:47], s8 offen sc1
    s_mov_b32 s8, 8192
    buffer_store_dwordx4 v[4:7], v2, s[44:47], s8 offen sc1
    s_mov_b32 s8, 16384
    buffer_store_dwordx4 v[4:7], v2, s[44:47], s8 offen sc1
    s_mov_b32 s8, 24576
    buffer_store_dwordx4 v[4:7], v2, s[44:47], s8 offen sc1
    s_waitcnt vmcnt(0)
    s_barrier
    s_add_u32 s48, s42, 65536
    s_addc_u32 s49, s43, 0
    s_and_b32 s49, s49, 0xffff
    s_mov_b32 s50, 16392
    s_mov_b32 s51, 0x20000
    v_mov_b32 v2, 16384
    v_mov_b32 v5, s31
    s_mov_b64 exec, 1
    buffer_store_dwordx2 v[4:5], v2, s[48:51], 0 offen sc1
    s_mov_b64 exec, -1
sequential_preLN__ssm_conv_s4d__glu_gated_reglu__prompt_kernel_nz11:
    s_cmp_lt_u32 s4, 64
    s_cbranch_scc1 sequential_preLN__ssm_conv_s4d__glu_gated_reglu__prompt_kernel_nocs
    s_sub_u32 s5, s4, 64
    s_and_b32 s6, s5, 7
    s_lshr_b32 s5, s5, 3
    s_cmp_lt_u32 s6, 4
    s_cselect_b32 s44, s32, s34
    s_cselect_b32 s45, s33, s35
    s_and_b32 s45, s45, 0xffff
    s_mov_b32 s46, 5308416
    s_mov_b32 s47, 0x20000
    s_mov_b32 s7, 0x1c71c72
    v_mul_hi_u32 v2, v0, s7
    v_mul_u32_u24 v3, 144, v2
    v_sub_u32 v3, v0, v3
    v_mul_u32_u24 v4, 9216, v2
    v_lshl_add_u32 v4, v3, 4, v4
    s_mul_i32 s7, s5, 884736
    s_and_b32 s8, s6, 3
    s_mul_i32 s8, s8, 2304
    s_add_u32 s7, s7, s8
    v_add_u32 v4, s7, v4
    v_cmp_le_u32 vcc, 3, v2
    v_mov_b32 v5, 0x7fffffff
    s_nop 0
    v_cndmask_b32 v4, v4, v5, vcc
    v_mov_b32 v160, 0
    v_mov_b32 v161, 0
    v_mov_b32 v162, 0
    v_mov_b32 v163, 0
    v_mov_b32 v164, 0
    v_mov_b32 v165, 0
    v_mov_b32 v166, 0
    v_mov_b32 v167, 0
    s_mov_b32 s7, 0x00003f80
    s_mov_b32 s8, 0x3f800000
    v_mov_b32 v8, s7
    v_mov_b32 v9, s8
    s_mov_b32 s9, 0
    s_mov_b32 s10, 0
sequential_preLN__ssm_conv_s4d__glu_gated_reglu__prompt_kernel_csl12:
    s_add_u32 s7, s9, 0
    buffer_load_dwordx4 v[16:19], v4, s[44:47], s7 offen
    s_add_u32 s7, s9, 27648
    buffer_load_dwordx4 v[20:23], v4, s[44:47], s7 offen
    s_add_u32 s7, s9, 55296
    buffer_load_dwordx4 v[24:27], v4, s[44:47], s7 offen
    s_add_u32 s7, s9, 82944
    buffer_load_dwordx4 v[28:31], v4, s[44:47], s7 offen
    s_add_u32 s7, s9, 110592
    buffer_load_dwordx4 v[32:35], v4, s[44:47], s7 offen
    s_add_u32 s7, s9, 138240
    buffer_load_dwordx4 v[36:39], v4, s[44:47], s7 offen
    s_add_u32 s7, s9, 165888
    buffer_load_dwordx4 v[40:43], v4, s[44:47], s7 offen
    s_add_u32 s7, s9, 193536
    buffer_load_dwordx4 v[44:47], v4, s[44:47], s7 offen
    s_add_u32 s7, s9, 221184
    buffer_load_dwordx4 v[48:51], v4, s[44:47], s7 offen
    s_add_u32 s7, s9, 248832
    buffer_load_dwordx4 v[52:55], v4, s[44:47], s7 offen
    s_add_u32 s7, s9, 276480
    buffer_load_dwordx4 v[56:59], v4, s[44:47], s7 offen
    s_add_u32 s7, s9, 304128
    buffer_load_dwordx4 v[60:63], v4, s[44:47], s7 offen
    s_add_u32 s7, s9, 331776
    buffer_load_dwordx4 v[64:67], v4, s[44:47], s7 offen
    s_add_u32 s7, s9, 359424
    buffer_load_dwordx4 v[68:71], v4, s[44:47], s7 offen
    s_add_u32 s7, s9, 387072
    buffer_load_dwordx4 v[72:75], v4, s[44:47], s7 offen
    s_add_u32 s7, s9, 414720
    buffer_load_dwordx4 v[76:79], v4, s[44:47], s7 offen
    s_waitcnt vmcnt(15)
    v_dot2c_f32_bf16 v160, v16, v8
    v_dot2c_f32_bf16 v161, v16, v9
    v_dot2c_f32_bf16 v162, v17, v8
    v_dot2c_f32_bf16 v163, v17, v9
    v_dot2c_f32_bf16 v164, v18, v8
    v_dot2c_f32_bf16 v165, v18, v9
    v_dot2c_f32_bf16 v166, v19, v8
    v_dot2c_f32_bf16 v167, v19, v9
    s_waitcnt vmcnt(14)
    v_dot2c_f32_bf16 v160, v20, v8
    v_dot2c_f32_bf16 v161, v20, v9
    v_dot2c_f32_bf16 v162, v21, v8
    v_dot2c_f32_bf16 v163, v21, v9
    v_dot2c_f32_bf16 v164, v22, v8
    v_dot2c_f32_bf16 v165, v22, v9
    v_dot2c_f32_bf16 v166, v23, v8
    v_dot2c_f32_bf16 v167, v23, v9
    s_waitcnt vmcnt(13)
    v_dot2c_f32_bf16 v160, v24, v8
    v_dot2c_f32_bf16 v161, v24, v9
    v_dot2c_f32_bf16 v162, v25, v8
    v_dot2c_f32_bf16 v163, v25, v9
    v_dot2c_f32_bf16 v164, v26, v8
    v_dot2c_f32_bf16 v165, v26, v9
    v_dot2c_f32_bf16 v166, v27, v8
    v_dot2c_f32_bf16 v167, v27, v9
    s_waitcnt vmcnt(12)
    v_dot2c_f32_bf16 v160, v28, v8
    v_dot2c_f32_bf16 v161, v28, v9
    v_dot2c_f32_bf16 v162, v29, v8
    v_dot2c_f32_bf16 v163, v29, v9
    v_dot2c_f32_bf16 v164, v30, v8
    v_dot2c_f32_bf16 v165, v30, v9
    v_dot2c_f32_bf16 v166, v31, v8
    v_dot2c_f32_bf16 v167, v31, v9
    s_waitcnt vmcnt(11)
    v_dot2c_f32_bf16 v160, v32, v8
    v_dot2c_f32_bf16 v161, v32, v9
    v_dot2c_f32_bf16 v162, v33, v8
    v_dot2c_f32_bf16 v163, v33, v9
    v_dot2c_f32_bf16 v164, v34, v8
    v_dot2c_f32_bf16 v165, v34, v9
    v_dot2c_f32_bf16 v166, v35, v8
    v_dot2c_f32_bf16 v167, v35, v9
    s_waitcnt vmcnt(10)
    v_dot2c_f32_bf16 v160, v36, v8
    v_dot2c_f32_bf16 v161, v36, v9
    v_dot2c_f32_bf16 v162, v37, v8
    v_dot2c_f32_bf16 v163, v37, v9
    v_dot2c_f32_bf16 v164, v38, v8
    v_dot2c_f32_bf16 v165, v38, v9
    v_dot2c_f32_bf16 v166, v39, v8
    v_dot2c_f32_bf16 v167, v39, v9
    s_waitcnt vmcnt(9)
    v_dot2c_f32_bf16 v160, v40, v8
    v_dot2c_f32_bf16 v161, v40, v9
    v_dot2c_f32_bf16 v162, v41, v8
    v_dot2c_f32_bf16 v163, v41, v9
    v_dot2c_f32_bf16 v164, v42, v8
    v_dot2c_f32_bf16 v165, v42, v9
    v_dot2c_f32_bf16 v166, v43, v8
    v_dot2c_f32_bf16 v167, v43, v9
    s_waitcnt vmcnt(8)
    v_dot2c_f32_bf16 v160, v44, v8
    v_dot2c_f32_bf16 v161, v44, v9
    v_dot2c_f32_bf16 v162, v45, v8
    v_dot2c_f32_bf16 v163, v45, v9
    v_dot2c_f32_bf16 v164, v46, v8
    v_dot2c_f32_bf16 v165, v46, v9
    v_dot2c_f32_bf16 v166, v47, v8
    v_dot2c_f32_bf16 v167, v47, v9
    s_waitcnt vmcnt(7)
    v_dot2c_f32_bf16 v160, v48, v8
    v_dot2c_f32_bf16 v161, v48, v9
    v_dot2c_f32_bf16 v162, v49, v8
    v_dot2c_f32_bf16 v163, v49, v9
    v_dot2c_f32_bf16 v164, v50, v8
    v_dot2c_f32_bf16 v165, v50, v9
    v_dot2c_f32_bf16 v166, v51, v8
    v_dot2c_f32_bf16 v167, v51, v9
    s_waitcnt vmcnt(6)
    v_dot2c_f32_bf16 v160, v52, v8
    v_dot2c_f32_bf16 v161, v52, v9
    v_dot2c_f32_bf16 v162, v53, v8
    v_dot2c_f32_bf16 v163, v53, v9
    v_dot2c_f32_bf16 v164, v54, v8
    v_dot2c_f32_bf16 v165, v54, v9
    v_dot2c_f32_bf16 v166, v55, v8
    v_dot2c_f32_bf16 v167, v55, v9
    s_waitcnt vmcnt(5)
    v_dot2c_f32_bf16 v160, v56, v8
    v_dot2c_f32_bf16 v161, v56, v9
    v_dot2c_f32_bf16 v162, v57, v8
    v_dot2c_f32_bf16 v163, v57, v9
    v_dot2c_f32_bf16 v164, v58, v8
    v_dot2c_f32_bf16 v165, v58, v9
    v_dot2c_f32_bf16 v166, v59, v8
    v_dot2c_f32_bf16 v167, v59, v9
    s_waitcnt vmcnt(4)
    v_dot2c_f32_bf16 v160, v60, v8
    v_dot2c_f32_bf16 v161, v60, v9
    v_dot2c_f32_bf16 v162, v61, v8
    v_dot2c_f32_bf16 v163, v61, v9
    v_dot2c_f32_bf16 v164, v62, v8
    v_dot2c_f32_bf16 v165, v62, v9
    v_dot2c_f32_bf16 v166, v63, v8
    v_dot2c_f32_bf16 v167, v63, v9
    s_waitcnt vmcnt(3)
    v_dot2c_f32_bf16 v160, v64, v8
    v_dot2c_f32_bf16 v161, v64, v9
    v_dot2c_f32_bf16 v162, v65, v8
    v_dot2c_f32_bf16 v163, v65, v9
    v_dot2c_f32_bf16 v164, v66, v8
    v_dot2c_f32_bf16 v165, v66, v9
    v_dot2c_f32_bf16 v166, v67, v8
    v_dot2c_f32_bf16 v167, v67, v9
    s_waitcnt vmcnt(2)
    v_dot2c_f32_bf16 v160, v68, v8
    v_dot2c_f32_bf16 v161, v68, v9
    v_dot2c_f32_bf16 v162, v69, v8
    v_dot2c_f32_bf16 v163, v69, v9
    v_dot2c_f32_bf16 v164, v70, v8
    v_dot2c_f32_bf16 v165, v70, v9
    v_dot2c_f32_bf16 v166, v71, v8
    v_dot2c_f32_bf16 v167, v71, v9
    s_waitcnt vmcnt(1)
    v_dot2c_f32_bf16 v160, v72, v8
    v_dot2c_f32_bf16 v161, v72, v9
    v_dot2c_f32_bf16 v162, v73, v8
    v_dot2c_f32_bf16 v163, v73, v9
    v_dot2c_f32_bf16 v164, v74, v8
    v_dot2c_f32_bf16 v165, v74, v9
    v_dot2c_f32_bf16 v166, v75, v8
    v_dot2c_f32_bf16 v167, v75, v9
    s_waitcnt vmcnt(0)
    v_dot2c_f32_bf16 v160, v76, v8
    v_dot2c_f32_bf16 v161, v76, v9
    v_dot2c_f32_bf16 v162, v77, v8
    v_dot2c_f32_bf16 v163, v77, v9
    v_dot2c_f32_bf16 v164, v78, v8
    v_dot2c_f32_bf16 v165, v78, v9
    v_dot2c_f32_bf16 v166, v79, v8
    v_dot2c_f32_bf16 v167, v79, v9
    s_add_u32 s9, s9, 442368
    s_add_u32 s10, s10, 1
    s_cmp_lt_u32 s10, 2
    s_cbranch_scc1 sequential_preLN__ssm_conv_s4d__glu_gated_reglu__prompt_kernel_csl12
    v_mul_u32_u24 v6, 4608, v2
    v_lshl_add_u32 v6, v3, 5, v6
    v_cmp_gt_u32 vcc, 3, v2
    s_and_saveexec_b64 s[8:9], vcc
    ds_write_b128 v6, v[160:163]
    ds_write_b128 v6, v[164:167] offset:16
    s_mov_b64 exec, s[8:9]
    s_waitcnt lgkmcnt(0)
    s_barrier
    v_cmp_gt_u32 vcc, 288, v0
    s_and_saveexec_b64 s[8:9], vcc
    s_cbranch_execz sequential_preLN__ssm_conv_s4d__glu_gated_reglu__prompt_kernel_cs13
    v_lshlrev_b32 v6, 4, v0
    ds_read_b128 v[16:19], v6 offset:0
    ds_read_b128 v[20:23], v6 offset:4608
    ds_read_b128 v[24:27], v6 offset:9216
    s_waitcnt lgkmcnt(0)
    v_add_f32 v16, v16, v20
    v_add_f32 v16, v16, v24
    v_add_f32 v17, v17, v21
    v_add_f32 v17, v17, v25
    v_add_f32 v18, v18, v22
    v_add_f32 v18, v18, v26
    v_add_f32 v19, v19, v23
    v_add_f32 v19, v19, v27
    s_add_u32 s48, s42, 52428800
    s_addc_u32 s49, s43, 0
    s_and_b32 s49, s49, 0xffff
    s_mov_b32 s50, 221184
    s_mov_b32 s51, 0x20000
    s_mul_i32 s7, s5, 36864
    s_mul_i32 s10, s6, 4608
    s_add_u32 s7, s7, s10
    buffer_store_dwordx4 v[16:19], v6, s[48:51], s7 offen sc1
sequential_preLN__ssm_conv_s4d__glu_gated_reglu__prompt_kernel_cs13:
    s_mov_b64 exec, s[8:9]
    s_branch sequential_preLN__ssm_conv_s4d__glu_gated_reglu__prompt_kernel_nopf
sequential_preLN__ssm_conv_s4d__glu_gated_reglu__prompt_kernel_nocs:
    s_mov_b32 s44, s36
    s_and_b32 s45, s37, 0xffff
    s_mov_b32 s46, 5308416
    s_mov_b32 s47, 0x20000
    s_mul_i32 s5, s4, 82944
    v_lshlrev_b32 v4, 4, v0
    s_add_u32 s6, s5, 0
    buffer_load_dwordx4 v[16:19], v4, s[44:47], s6 offen
    s_add_u32 s6, s5, 8192
    buffer_load_dwordx4 v[20:23], v4, s[44:47], s6 offen
    s_add_u32 s6, s5, 16384
    buffer_load_dwordx4 v[24:27], v4, s[44:47], s6 offen
    s_add_u32 s6, s5, 24576
    buffer_load_dwordx4 v[28:31], v4, s[44:47], s6 offen
    s_add_u32 s6, s5, 32768
    buffer_load_dwordx4 v[32:35], v4, s[44:47], s6 offen
    s_add_u32 s6, s5, 40960
    buffer_load_dwordx4 v[36:39], v4, s[44:47], s6 offen
    s_add_u32 s6, s5, 49152
    buffer_load_dwordx4 v[40:43], v4, s[44:47], s6 offen
    s_add_u32 s6, s5, 57344
    buffer_load_dwordx4 v[44:47], v4, s[44:47], s6 offen
    s_add_u32 s6, s5, 65536
    buffer_load_dwordx4 v[48:51], v4, s[44:47], s6 offen
    s_add_u32 s6, s5, 73728
    buffer_load_dwordx4 v[52:55], v4, s[44:47], s6 offen
    s_add_u32 s6, s5, 81920
    buffer_load_dwordx4 v[56:59], v4, s[44:47], s6 offen
sequential_preLN__ssm_conv_s4d__glu_gated_reglu__prompt_kernel_nopf:
sequential_preLN__ssm_conv_s4d__glu_gated_reglu__prompt_kernel_a_done:
    s_waitcnt vmcnt(0) lgkmcnt(0)
    s_barrier
    s_cmp_eq_u32 s3, 0
    s_cbranch_scc0 sequential_preLN__ssm_conv_s4d__glu_gated_reglu__prompt_kernel_b214
    s_mov_b32 s12, 81924
    s_mov_b64 exec, 1
    v_mov_b32 v250, s12
    s_mov_b32 s60, 0
sequential_preLN__ssm_conv_s4d__glu_gated_reglu__prompt_kernel_ptag15:
    global_load_dword v251, v250, s[42:43] sc1
    s_add_u32 s60, s60, 1
    s_waitcnt vmcnt(0)
    v_cmp_ne_u32 vcc, s31, v251
    s_cmp_eq_u64 vcc, 0
    s_cbranch_scc1 sequential_preLN__ssm_conv_s4d__glu_gated_reglu__prompt_kernel_ptagd16
    s_cmp_ge_u32 s60, 0x200000
    s_cbranch_scc1 sequential_preLN__ssm_conv_s4d__glu_gated_reglu__prompt_kernel_ptagd16
    s_sleep 1
    s_branch sequential_preLN__ssm_conv_s4d__glu_gated_reglu__prompt_kernel_ptag15
sequential_preLN__ssm_conv_s4d__glu_gated_reglu__prompt_kernel_ptagd16:
    s_mov_b64 exec, -1
    s_and_b32 s12, s2, 63
    s_lshl_b32 s12, s12, 7
    s_add_u32 s12, s12, 0
    s_mov_b64 exec, 1
    v_mov_b32 v250, s12
    v_mov_b32 v251, 1
    global_atomic_add v250, v251, s[42:43] sc1
    s_mov_b64 exec, -1
sequential_preLN__ssm_conv_s4d__glu_gated_reglu__prompt_kernel_b214:
    s_and_b32 s4, s2, 7
    s_lshr_b32 s6, s2, 3
    s_and_b32 s5, s6, 3
    s_lshr_b32 s6, s6, 2
    s_lshl_b32 s7, s4, 2
    s_add_u32 s7, s7, s5
    s_and_b32 s8, s3, 3
    s_lshr_b32 s9, s3, 2
    s_and_b32 s10, s7, 1
    s_lshl_b32 s11, s6, 8
    s_lshl_b32 s12, s7, 3
    s_add_u32 s11, s11, s12
    s_cmp_eq_u32 s9, 0
    s_cselect_b32 s44, s32, s34
    s_cselect_b32 s45, s33, s35
    s_and_b32 s45, s45, 0xffff
    s_mov_b32 s46, 5308416
    s_mov_b32 s47, 0x20000
    s_add_u32 s52, s42, 262144
    s_addc_u32 s53, s43, 0
    s_and_b32 s53, s53, 0xffff
    s_mov_b32 s54, 2359296
    s_mov_b32 s55, 0x20000
    s_add_u32 s56, s42, 3145728
    s_addc_u32 s57, s43, 0
    s_and_b32 s57, s57, 0xffff
    s_mov_b32 s58, 18874368
    s_mov_b32 s59, 0x20000
    s_add_u32 s12, s8, 0
    s_cmp_ge_u32 s12, 9
    s_cselect_b32 s13, 1, 0
    s_mul_i32 s14, s13, 9
    s_sub_u32 s12, s12, s14
    s_mul_i32 s14, s13, 34816
    s_mul_i32 s15, s9, 9216
    s_add_u32 s14, s14, s15
    s_lshl_b32 s15, s12, 10
    s_add_u32 s64, s14, s15
    s_lshl_b32 s12, s12, 6
    v_add_u32 v28, s12, v1
    s_mov_b32 s15, 0x0e38e38f
    v_mul_hi_u32 v29, v28, s15
    v_mul_u32_u24 v30, 18, v29
    v_sub_u32 v30, v28, v30
    v_mul_u32_u24 v29, 9216, v29
    v_lshl_add_u32 v16, v30, 4, v29
    s_mul_i32 s13, s13, 294912
    s_mul_i32 s15, s7, 288
    s_add_u32 s13, s13, s15
    v_add_u32 v16, s13, v16
    s_add_u32 s12, s8, 4
    s_cmp_ge_u32 s12, 9
    s_cselect_b32 s13, 1, 0
    s_mul_i32 s14, s13, 9
    s_sub_u32 s12, s12, s14
    s_mul_i32 s14, s13, 34816
    s_mul_i32 s15, s9, 9216
    s_add_u32 s14, s14, s15
    s_lshl_b32 s15, s12, 10
    s_add_u32 s65, s14, s15
    s_lshl_b32 s12, s12, 6
    v_add_u32 v28, s12, v1
    s_mov_b32 s15, 0x0e38e38f
    v_mul_hi_u32 v29, v28, s15
    v_mul_u32_u24 v30, 18, v29
    v_sub_u32 v30, v28, v30
    v_mul_u32_u24 v29, 9216, v29
    v_lshl_add_u32 v17, v30, 4, v29
    s_mul_i32 s13, s13, 294912
    s_mul_i32 s15, s7, 288
    s_add_u32 s13, s13, s15
    v_add_u32 v17, s13, v17
    s_add_u32 s12, s8, 8
    s_cmp_ge_u32 s12, 9
    s_cselect_b32 s13, 1, 0
    s_mul_i32 s14, s13, 9
    s_sub_u32 s12, s12, s14
    s_mul_i32 s14, s13, 34816
    s_mul_i32 s15, s9, 9216
    s_add_u32 s14, s14, s15
    s_lshl_b32 s15, s12, 10
    s_add_u32 s66, s14, s15
    s_lshl_b32 s12, s12, 6
    v_add_u32 v28, s12, v1
    s_mov_b32 s15, 0x0e38e38f
    v_mul_hi_u32 v29, v28, s15
    v_mul_u32_u24 v30, 18, v29
    v_sub_u32 v30, v28, v30
    v_mul_u32_u24 v29, 9216, v29
    v_lshl_add_u32 v18, v30, 4, v29
    s_mul_i32 s13, s13, 294912
    s_mul_i32 s15, s7, 288
    s_add_u32 s13, s13, s15
    v_add_u32 v18, s13, v18
    s_add_u32 s12, s8, 12
    s_cmp_ge_u32 s12, 9
    s_cselect_b32 s13, 1, 0
    s_mul_i32 s14, s13, 9
    s_sub_u32 s12, s12, s14
    s_mul_i32 s14, s13, 34816
    s_mul_i32 s15, s9, 9216
    s_add_u32 s14, s14, s15
    s_lshl_b32 s15, s12, 10
    s_add_u32 s67, s14, s15
    s_lshl_b32 s12, s12, 6
    v_add_u32 v28, s12, v1
    s_mov_b32 s15, 0x0e38e38f
    v_mul_hi_u32 v29, v28, s15
    v_mul_u32_u24 v30, 18, v29
    v_sub_u32 v30, v28, v30
    v_mul_u32_u24 v29, 9216, v29
    v_lshl_add_u32 v19, v30, 4, v29
    s_mul_i32 s13, s13, 294912
    s_mul_i32 s15, s7, 288
    s_add_u32 s13, s13, s15
    v_add_u32 v19, s13, v19
    s_lshr_b32 s12, s8, 1
    s_add_u32 s12, s12, 16
    s_cmp_ge_u32 s12, 9
    s_cselect_b32 s13, 1, 0
    s_mul_i32 s14, s13, 9
    s_sub_u32 s12, s12, s14
    s_mul_i32 s14, s13, 34816
    s_mul_i32 s15, s9, 9216
    s_add_u32 s14, s14, s15
    s_lshl_b32 s15, s12, 10
    s_add_u32 s68, s14, s15
    s_lshl_b32 s12, s12, 6
    s_and_b32 s15, s8, 1
    s_lshl_b32 s14, s15, 9
    s_add_u32 s68, s68, s14
    s_lshl_b32 s15, s15, 5
    s_add_u32 s12, s12, s15
    v_add_u32 v28, s12, v1
    s_mov_b32 s15, 0x0e38e38f
    v_mul_hi_u32 v29, v28, s15
    v_mul_u32_u24 v30, 18, v29
    v_sub_u32 v30, v28, v30
    v_mul_u32_u24 v29, 9216, v29
    v_lshl_add_u32 v20, v30, 4, v29
    s_mul_i32 s13, s13, 294912
    s_mul_i32 s15, s7, 288
    s_add_u32 s13, s13, s15
    v_add_u32 v20, s13, v20
    s_add_u32 m0, s64, 0
    s_mov_b32 s69, 0
    buffer_load_dwordx4 v16, s[44:47], s69 offen lds
    s_add_u32 m0, s65, 0
    s_mov_b32 s69, 0
    buffer_load_dwordx4 v17, s[44:47], s69 offen lds
    s_add_u32 m0, s66, 0
    s_mov_b32 s69, 0
    buffer_load_dwordx4 v18, s[44:47], s69 offen lds
    s_add_u32 m0, s67, 0
    s_mov_b32 s69, 0
    buffer_load_dwordx4 v19, s[44:47], s69 offen lds
    s_add_u32 m0, s68, 0
    s_mov_b32 exec_hi, 0
    buffer_load_dwordx4 v20, s[44:47], s69 offen lds
    s_mov_b32 exec_hi, -1
    s_add_u32 m0, s64, 69632
    s_mov_b32 s69, 589824
    buffer_load_dwordx4 v16, s[44:47], s69 offen lds
    s_add_u32 m0, s65, 69632
    s_mov_b32 s69, 589824
    buffer_load_dwordx4 v17, s[44:47], s69 offen lds
    s_add_u32 m0, s66, 69632
    s_mov_b32 s69, 589824
    buffer_load_dwordx4 v18, s[44:47], s69 offen lds
    s_add_u32 m0, s67, 69632
    s_mov_b32 s69, 589824
    buffer_load_dwordx4 v19, s[44:47], s69 offen lds
    s_add_u32 m0, s68, 69632
    s_mov_b32 exec_hi, 0
    buffer_load_dwordx4 v20, s[44:47], s69 offen lds
    s_mov_b32 exec_hi, -1
    v_lshrrev_b32 v28, 2, v1
    v_and_b32 v29, 3, v1
    v_mul_u32_u24 v4, 288, v28
    v_lshl_add_u32 v4, v29, 3, v4
    s_xor_b32 s13, s10, 1
    s_lshl_b32 s13, s13, 8
    v_add_u32 v6, s13, v4
    s_lshl_b32 s12, s10, 5
    v_add_u32 v4, s12, v4
    v_add_u32 v5, 69632, v4
    v_add_u32 v7, 69632, v6
    v_and_b32 v30, 7, v28
    v_lshlrev_b32 v31, 9, v28
    v_lshl_add_u32 v31, v29, 3, v31
    v_add_u32 v31, 18432, v31
    s_lshl_b32 s12, s3, 1
    s_add_u32 s12, s12, 0
    s_and_b32 s13, s12, 7
    s_and_b32 s12, s12, 8
    v_xor_b32 v22, s13, v30
    v_or_b32 v22, s12, v22
    v_lshl_add_u32 v8, v22, 5, v31
    v_add_u32 v10, 69632, v8
    s_lshl_b32 s12, s3, 1
    s_add_u32 s12, s12, 1
    s_and_b32 s13, s12, 7
    s_and_b32 s12, s12, 8
    v_xor_b32 v22, s13, v30
    v_or_b32 v22, s12, v22
    v_lshl_add_u32 v9, v22, 5, v31
    v_add_u32 v11, 69632, v9
    v_lshrrev_b32 v28, 5, v1
    s_lshl_b32 s12, s3, 1
    v_add_u32 v28, s12, v28
    v_and_b32 v29, 31, v1
    v_lshrrev_b32 v30, 1, v29
    v_and_b32 v31, 7, v28
    v_xor_b32 v30, v30, v31
    v_lshlrev_b32 v30, 5, v30
    v_and_b32 v29, 1, v29
    v_lshl_add_u32 v30, v29, 4, v30
    v_lshl_add_u32 v21, v28, 12, v30
    s_lshl_b32 s12, s6, 9
    v_add_u32 v21, s12, v21
    s_lshl_b32 s70, s3, 10
    s_mov_b32 s72, s36
    s_and_b32 s73, s37, 0xffff
    s_mov_b32 s74, 5308416
    s_mov_b32 s75, 0x20000
    s_mul_i32 s13, s5, 288
    s_mul_i32 s12, s4, 663552
    s_add_u32 s14, s13, s12
    s_lshl_b32 s12, s3, 6
    s_add_u32 s12, s12, 0
    v_add_u32 v29, s12, v1
    s_mov_b32 s13, 0x0e38e38f
    v_mul_hi_u32 v30, v29, s13
    v_mul_u32_u24 v31, 18, v30
    v_sub_u32 v31, v29, v31
    v_mul_u32_u24 v30, 1152, v30
    v_lshl_add_u32 v12, v31, 4, v30
    v_add_u32 v12, s14, v12
    s_lshl_b32 s12, s3, 6
    s_add_u32 s12, s12, 512
    v_add_u32 v29, s12, v1
    s_mov_b32 s13, 0x0e38e38f
    v_mul_hi_u32 v30, v29, s13
    v_mul_u32_u24 v31, 18, v30
    v_sub_u32 v31, v29, v31
    v_mul_u32_u24 v30, 1152, v30
    v_lshl_add_u32 v13, v31, 4, v30
    v_add_u32 v13, s14, v13
    s_lshl_b32 s12, s3, 4
    s_add_u32 s12, s12, 1024
    v_add_u32 v29, s12, v1
    s_mov_b32 s13, 0x0e38e38f
    v_mul_hi_u32 v30, v29, s13
    v_mul_u32_u24 v31, 18, v30
    v_sub_u32 v31, v29, v31
    v_mul_u32_u24 v30, 1152, v30
    v_lshl_add_u32 v14, v31, 4, v30
    v_add_u32 v14, s14, v14
    s_lshl_b32 s12, s3, 6
    s_add_u32 s12, s12, 512
    v_add_u32 v29, s12, v1
    v_cmp_le_u32 vcc, 576, v29
    v_mov_b32 v30, 294912
    s_nop 0
    v_cndmask_b32 v30, 0, v30, vcc
    v_add_u32 v15, v13, v30
    s_lshl_b32 s80, s3, 10
    s_lshl_b32 s83, s3, 8
    v_and_b32 v28, 15, v1
    v_lshrrev_b32 v29, 4, v1
    s_lshl_b32 s12, s6, 8
    s_lshl_b32 s13, s3, 5
    s_add_u32 s12, s12, s13
    v_add_u32 v2, s12, v28
    v_lshlrev_b32 v2, 6, v2
    v_lshl_add_u32 v2, v29, 4, v2
    s_cmp_eq_u32 s3, 0
    s_cbranch_scc0 sequential_preLN__ssm_conv_s4d__glu_gated_reglu__prompt_kernel_b2p17
    v_lshlrev_b32 v250, 7, v1
    v_add_u32 v250, 0, v250
    s_mov_b32 s60, 0
sequential_preLN__ssm_conv_s4d__glu_gated_reglu__prompt_kernel_b2l18:
    global_load_dword v251, v250, s[42:43] sc1
    s_add_u32 s60, s60, 1
    s_waitcnt vmcnt(0)
    v_cmp_gt_u32 vcc, 4, v251
    s_cmp_eq_u64 vcc, 0
    s_cbranch_scc1 sequential_preLN__ssm_conv_s4d__glu_gated_reglu__prompt_kernel_b2d19
    s_cmp_ge_u32 s60, 0x200000
    s_cbranch_scc1 sequential_preLN__ssm_conv_s4d__glu_gated_reglu__prompt_kernel_b2d19
    s_sleep 3
    s_branch sequential_preLN__ssm_conv_s4d__glu_gated_reglu__prompt_kernel_b2l18
sequential_preLN__ssm_conv_s4d__glu_gated_reglu__prompt_kernel_b2d19:
    s_mov_b64 exec, -1
    s_cmp_eq_u32 s2, 0
    s_cbranch_scc0 sequential_preLN__ssm_conv_s4d__glu_gated_reglu__prompt_kernel_gen20
    s_mov_b64 exec, 1
    v_mov_b32 v250, 36864
    v_mov_b32 v251, s31
    global_store_dword v250, v251, s[42:43] sc1
    s_mov_b64 exec, -1
sequential_preLN__ssm_conv_s4d__glu_gated_reglu__prompt_kernel_gen20:
sequential_preLN__ssm_conv_s4d__glu_gated_reglu__prompt_kernel_b2p17:
    s_barrier
    s_add_u32 m0, s70, 18432
    s_mov_b32 s71, 0
    buffer_load_dwordx4 v21, s[52:55], s71 offen sc1 lds
    s_add_u32 m0, s70, 26624
    s_mov_b32 s71, 65536
    buffer_load_dwordx4 v21, s[52:55], s71 offen sc1 lds
    s_add_u32 m0, s70, 53248
    s_mov_b32 s71, 131072
    buffer_load_dwordx4 v21, s[52:55], s71 offen sc1 lds
    s_add_u32 m0, s70, 61440
    s_mov_b32 s71, 196608
    buffer_load_dwordx4 v21, s[52:55], s71 offen sc1 lds
    s_add_u32 m0, s70, 88064
    s_mov_b32 s71, 262144
    buffer_load_dwordx4 v21, s[52:55], s71 offen sc1 lds
    s_add_u32 m0, s70, 96256
    s_mov_b32 s71, 327680
    buffer_load_dwordx4 v21, s[52:55], s71 offen sc1 lds
    s_add_u32 m0, s70, 122880
    s_mov_b32 s71, 393216
    buffer_load_dwordx4 v21, s[52:55], s71 offen sc1 lds
    s_add_u32 m0, s70, 131072
    s_mov_b32 s71, 458752
    buffer_load_dwordx4 v21, s[52:55], s71 offen sc1 lds
    v_lshlrev_b32 v3, 12, v0
    s_lshl_b32 s12, s11, 1
    v_add_u32 v3, s12, v3
    buffer_load_dwordx4 v[24:27], v3, s[52:55], 0 offen sc1
    s_mov_b32 s12, 2097152
    buffer_load_dwordx4 v[32:35], v3, s[52:55], s12 offen sc1
    s_add_u32 s60, s42, 52428800
    s_addc_u32 s61, s43, 0
    s_and_b32 s61, s61, 0xffff
    s_mov_b32 s62, 221184
    s_mov_b32 s63, 0x20000
    s_mul_i32 s12, s3, 1152
    s_add_u32 m0, s12, 139264
    s_mul_i32 s12, s3, 36864
    s_mul_i32 s13, s7, 576
    s_add_u32 s12, s12, s13
    v_lshlrev_b32 v3, 4, v1
    s_mov_b32 exec_hi, 0xf
    buffer_load_dwordx4 v3, s[60:63], s12 offen sc1 lds
    s_mul_i32 s13, s3, 1152
    s_add_u32 m0, s13, 139840
    s_add_u32 s12, s12, 18432
    buffer_load_dwordx4 v3, s[60:63], s12 offen sc1 lds
    s_mov_b32 exec_hi, -1
    s_waitcnt vmcnt(8)
    s_barrier
    ds_read_b64_tr_b16 v[96:97], v8 offset:0
    ds_read_b64_tr_b16 v[98:99], v8 offset:8192
    ds_read_b64_tr_b16 v[100:101], v9 offset:0
    ds_read_b64_tr_b16 v[102:103], v9 offset:8192
    ds_read_b64_tr_b16 v[44:45], v4 offset:0
    ds_read_b64_tr_b16 v[46:47], v4 offset:4608
    ds_read_b64_tr_b16 v[48:49], v4 offset:9216
    ds_read_b64_tr_b16 v[50:51], v4 offset:13824
    ds_read_b64_tr_b16 v[52:53], v4 offset:32
    ds_read_b64_tr_b16 v[54:55], v4 offset:4640
    ds_read_b64_tr_b16 v[56:57], v4 offset:9248
    ds_read_b64_tr_b16 v[58:59], v4 offset:13856
    ds_read_b64_tr_b16 v[60:61], v4 offset:64
    ds_read_b64_tr_b16 v[62:63], v4 offset:4672
    ds_read_b64_tr_b16 v[64:65], v4 offset:9280
    ds_read_b64_tr_b16 v[66:67], v4 offset:13888
    ds_read_b64_tr_b16 v[68:69], v4 offset:96
    ds_read_b64_tr_b16 v[70:71], v4 offset:4704
    ds_read_b64_tr_b16 v[72:73], v4 offset:9312
    ds_read_b64_tr_b16 v[74:75], v4 offset:13920
    s_waitcnt lgkmcnt(0)
    s_mov_b32 s61, 0
    v_mfma_f32_16x16x32_bf16 v[112:115], v[44:47], v[96:99], 0
    ds_read_b64_tr_b16 v[76:77], v4 offset:128
    v_mfma_f32_16x16x32_bf16 v[116:119], v[44:47], v[100:103], 0
    ds_read_b64_tr_b16 v[78:79], v4 offset:4736
    v_mfma_f32_16x16x32_bf16 v[120:123], v[48:51], v[96:99], 0
    ds_read_b64_tr_b16 v[44:45], v4 offset:9344
    v_mfma_f32_16x16x32_bf16 v[124:127], v[48:51], v[100:103], 0
    ds_read_b64_tr_b16 v[46:47], v4 offset:13952
    v_mfma_f32_16x16x32_bf16 v[128:131], v[52:55], v[96:99], 0
    ds_read_b64_tr_b16 v[48:49], v4 offset:160
    v_mfma_f32_16x16x32_bf16 v[132:135], v[52:55], v[100:103], 0
    ds_read_b64_tr_b16 v[50:51], v4 offset:4768
    v_mfma_f32_16x16x32_bf16 v[136:139], v[56:59], v[96:99], 0
    ds_read_b64_tr_b16 v[52:53], v4 offset:9376
    v_mfma_f32_16x16x32_bf16 v[140:143], v[56:59], v[100:103], 0
    ds_read_b64_tr_b16 v[54:55], v4 offset:13984
    v_mfma_f32_16x16x32_bf16 v[144:147], v[60:63], v[96:99], 0
    ds_read_b64_tr_b16 v[56:57], v4 offset:192
    v_mfma_f32_16x16x32_bf16 v[148:151], v[60:63], v[100:103], 0
    ds_read_b64_tr_b16 v[58:59], v4 offset:4800
    ds_read_b64_tr_b16 v[104:105], v8 offset:34816
    v_mfma_f32_16x16x32_bf16 v[152:155], v[64:67], v[96:99], 0
    ds_read_b64_tr_b16 v[60:61], v4 offset:9408
    v_mfma_f32_16x16x32_bf16 v[156:159], v[64:67], v[100:103], 0
    ds_read_b64_tr_b16 v[62:63], v4 offset:14016
    ds_read_b64_tr_b16 v[106:107], v8 offset:43008
    v_mfma_f32_16x16x32_bf16 v[160:163], v[68:71], v[96:99], 0
    ds_read_b64_tr_b16 v[64:65], v4 offset:224
    v_mfma_f32_16x16x32_bf16 v[164:167], v[68:71], v[100:103], 0
    ds_read_b64_tr_b16 v[66:67], v4 offset:4832
    ds_read_b64_tr_b16 v[108:109], v9 offset:34816
    v_mfma_f32_16x16x32_bf16 v[168:171], v[72:75], v[96:99], 0
    ds_read_b64_tr_b16 v[68:69], v4 offset:9440
    v_mfma_f32_16x16x32_bf16 v[172:175], v[72:75], v[100:103], 0
    ds_read_b64_tr_b16 v[70:71], v4 offset:14048
    ds_read_b64_tr_b16 v[110:111], v9 offset:43008
    s_waitcnt lgkmcnt(15)
    v_mfma_f32_16x16x32_bf16 v[176:179], v[76:79], v[96:99], 0
    ds_read_b64_tr_b16 v[72:73], v6 offset:0
    v_mfma_f32_16x16x32_bf16 v[180:183], v[76:79], v[100:103], 0
    ds_read_b64_tr_b16 v[74:75], v6 offset:4608
    v_mfma_f32_16x16x32_bf16 v[184:187], v[44:47], v[96:99], 0
    ds_read_b64_tr_b16 v[76:77], v6 offset:9216
    v_mfma_f32_16x16x32_bf16 v[188:191], v[44:47], v[100:103], 0
    ds_read_b64_tr_b16 v[78:79], v6 offset:13824
    s_waitcnt lgkmcnt(15)
    v_mfma_f32_16x16x32_bf16 v[192:195], v[48:51], v[96:99], 0
    ds_read_b64_tr_b16 v[44:45], v4 offset:34816
    v_mfma_f32_16x16x32_bf16 v[196:199], v[48:51], v[100:103], 0
    ds_read_b64_tr_b16 v[46:47], v4 offset:39424
    v_mfma_f32_16x16x32_bf16 v[200:203], v[52:55], v[96:99], 0
    ds_read_b64_tr_b16 v[48:49], v4 offset:44032
    v_mfma_f32_16x16x32_bf16 v[204:207], v[52:55], v[100:103], 0
    ds_read_b64_tr_b16 v[50:51], v4 offset:48640
    s_waitcnt lgkmcnt(15)
    v_mfma_f32_16x16x32_bf16 v[208:211], v[56:59], v[96:99], 0
    ds_read_b64_tr_b16 v[52:53], v4 offset:34848
    v_mfma_f32_16x16x32_bf16 v[212:215], v[56:59], v[100:103], 0
    ds_read_b64_tr_b16 v[54:55], v4 offset:39456
    v_mfma_f32_16x16x32_bf16 v[216:219], v[60:63], v[96:99], 0
    ds_read_b64_tr_b16 v[56:57], v4 offset:44064
    v_mfma_f32_16x16x32_bf16 v[220:223], v[60:63], v[100:103], 0
    ds_read_b64_tr_b16 v[58:59], v4 offset:48672
    s_waitcnt lgkmcnt(15)
    v_mfma_f32_16x16x32_bf16 v[224:227], v[64:67], v[96:99], 0
    ds_read_b64_tr_b16 v[60:61], v4 offset:34880
    v_mfma_f32_16x16x32_bf16 v[228:231], v[64:67], v[100:103], 0
    ds_read_b64_tr_b16 v[62:63], v4 offset:39488
    s_waitcnt lgkmcnt(15)
    v_mfma_f32_16x16x32_bf16 v[232:235], v[68:71], v[96:99], 0
    ds_read_b64_tr_b16 v[64:65], v4 offset:44096
    v_mfma_f32_16x16x32_bf16 v[236:239], v[68:71], v[100:103], 0
    ds_read_b64_tr_b16 v[66:67], v4 offset:48704
    s_waitcnt lgkmcnt(14)
    v_mfma_f32_16x16x32_bf16 v[240:243], v[72:75], v[96:99], 0
    ds_read_b64_tr_b16 v[68:69], v4 offset:34912
    v_mfma_f32_16x16x32_bf16 v[244:247], v[72:75], v[100:103], 0
    ds_read_b64_tr_b16 v[70:71], v4 offset:39520
    s_waitcnt lgkmcnt(14)
    v_mfma_f32_16x16x32_bf16 v[248:251], v[76:79], v[96:99], 0
    ds_read_b64_tr_b16 v[72:73], v4 offset:44128
    v_mfma_f32_16x16x32_bf16 v[252:255], v[76:79], v[100:103], 0
    ds_read_b64_tr_b16 v[74:75], v4 offset:48736
    s_waitcnt lgkmcnt(14)
    s_waitcnt vmcnt(0)
    v_mfma_f32_16x16x32_bf16 v[112:115], v[44:47], v[104:107], v[112:115]
    ds_read_b64_tr_b16 v[76:77], v4 offset:34944
    v_lshlrev_b32 v28, 4, v0
    v_mfma_f32_16x16x32_bf16 v[116:119], v[44:47], v[108:111], v[116:119]
    ds_read_b64_tr_b16 v[78:79], v4 offset:39552
    v_add_u32 v28, 149632, v28
    s_waitcnt lgkmcnt(14)
    v_mfma_f32_16x16x32_bf16 v[120:123], v[48:51], v[104:107], v[120:123]
    ds_read_b64_tr_b16 v[44:45], v4 offset:44160
    ds_write_b128 v28, v[24:27]
    v_mfma_f32_16x16x32_bf16 v[124:127], v[48:51], v[108:111], v[124:127]
    ds_read_b64_tr_b16 v[46:47], v4 offset:48768
    v_cmp_gt_u32 vcc, 64, v0
    s_and_saveexec_b64 s[12:13], vcc
    ds_write_b128 v28, v[32:35] offset:8192
    s_mov_b64 exec, s[12:13]
    s_waitcnt lgkmcnt(15)
    v_mfma_f32_16x16x32_bf16 v[128:131], v[52:55], v[104:107], v[128:131]
    ds_read_b64_tr_b16 v[48:49], v4 offset:34976
    s_mov_b32 s15, 0xffff0000
    v_mfma_f32_16x16x32_bf16 v[132:135], v[52:55], v[108:111], v[132:135]
    ds_read_b64_tr_b16 v[50:51], v4 offset:39584
    v_lshlrev_b32 v80, 16, v24
    s_waitcnt lgkmcnt(15)
    v_mfma_f32_16x16x32_bf16 v[136:139], v[56:59], v[104:107], v[136:139]
    ds_read_b64_tr_b16 v[52:53], v4 offset:44192
    v_and_b32 v81, s15, v24
    v_mfma_f32_16x16x32_bf16 v[140:143], v[56:59], v[108:111], v[140:143]
    ds_read_b64_tr_b16 v[54:55], v4 offset:48800
    v_lshlrev_b32 v88, 16, v32
    s_waitcnt lgkmcnt(15)
    v_mfma_f32_16x16x32_bf16 v[144:147], v[60:63], v[104:107], v[144:147]
    ds_read_b64_tr_b16 v[56:57], v4 offset:35008
    v_and_b32 v89, s15, v32
    v_mfma_f32_16x16x32_bf16 v[148:151], v[60:63], v[108:111], v[148:151]
    ds_read_b64_tr_b16 v[58:59], v4 offset:39616
    v_lshlrev_b32 v82, 16, v25
    s_waitcnt lgkmcnt(15)
    v_mfma_f32_16x16x32_bf16 v[152:155], v[64:67], v[104:107], v[152:155]
    ds_read_b64_tr_b16 v[60:61], v4 offset:44224
    v_and_b32 v83, s15, v25
    v_mfma_f32_16x16x32_bf16 v[156:159], v[64:67], v[108:111], v[156:159]
    ds_read_b64_tr_b16 v[62:63], v4 offset:48832
    v_lshlrev_b32 v90, 16, v33
    s_waitcnt lgkmcnt(15)
    v_mfma_f32_16x16x32_bf16 v[160:163], v[68:71], v[104:107], v[160:163]
    ds_read_b64_tr_b16 v[64:65], v4 offset:35040
    v_and_b32 v91, s15, v33
    v_mfma_f32_16x16x32_bf16 v[164:167], v[68:71], v[108:111], v[164:167]
    ds_read_b64_tr_b16 v[66:67], v4 offset:39648
    v_lshlrev_b32 v84, 16, v26
    s_waitcnt lgkmcnt(15)
    v_mfma_f32_16x16x32_bf16 v[168:171], v[72:75], v[104:107], v[168:171]
    ds_read_b64_tr_b16 v[68:69], v4 offset:44256
    v_and_b32 v85, s15, v26
    v_mfma_f32_16x16x32_bf16 v[172:175], v[72:75], v[108:111], v[172:175]
    ds_read_b64_tr_b16 v[70:71], v4 offset:48864
    v_lshlrev_b32 v92, 16, v34
    s_waitcnt lgkmcnt(15)
    v_mfma_f32_16x16x32_bf16 v[176:179], v[76:79], v[104:107], v[176:179]
    ds_read_b64_tr_b16 v[72:73], v6 offset:34816
    v_and_b32 v93, s15, v34
    v_mfma_f32_16x16x32_bf16 v[180:183], v[76:79], v[108:111], v[180:183]
    ds_read_b64_tr_b16 v[74:75], v6 offset:39424
    v_lshlrev_b32 v86, 16, v27
    s_waitcnt lgkmcnt(15)
    v_mfma_f32_16x16x32_bf16 v[184:187], v[44:47], v[104:107], v[184:187]
    ds_read_b64_tr_b16 v[76:77], v6 offset:44032
    v_and_b32 v87, s15, v27
    v_mfma_f32_16x16x32_bf16 v[188:191], v[44:47], v[108:111], v[188:191]
    ds_read_b64_tr_b16 v[78:79], v6 offset:48640
    v_lshlrev_b32 v94, 16, v35
    s_waitcnt lgkmcnt(0)
    s_barrier
    v_mfma_f32_16x16x32_bf16 v[192:195], v[48:51], v[104:107], v[192:195]
    ds_read_b64_tr_b16 v[44:45], v5 offset:0
    v_and_b32 v95, s15, v35
    v_mfma_f32_16x16x32_bf16 v[196:199], v[48:51], v[108:111], v[196:199]
    ds_read_b64_tr_b16 v[46:47], v5 offset:4608
    v_add_f32 v24, v80, v88
    ds_read_b64_tr_b16 v[96:97], v10 offset:0
    v_mfma_f32_16x16x32_bf16 v[200:203], v[52:55], v[104:107], v[200:203]
    ds_read_b64_tr_b16 v[48:49], v5 offset:9216
    v_mul_f32 v36, v80, v80
    v_mfma_f32_16x16x32_bf16 v[204:207], v[52:55], v[108:111], v[204:207]
    ds_read_b64_tr_b16 v[50:51], v5 offset:13824
    v_add_f32 v25, v81, v89
    ds_read_b64_tr_b16 v[98:99], v10 offset:8192
    s_add_u32 m0, s64, 0
    s_mov_b32 s69, 1179648
    buffer_load_dwordx4 v16, s[44:47], s69 offen lds
    v_mfma_f32_16x16x32_bf16 v[208:211], v[56:59], v[104:107], v[208:211]
    ds_read_b64_tr_b16 v[52:53], v5 offset:32
    v_mul_f32 v37, v81, v81
    v_mfma_f32_16x16x32_bf16 v[212:215], v[56:59], v[108:111], v[212:215]
    ds_read_b64_tr_b16 v[54:55], v5 offset:4640
    v_add_f32 v26, v82, v90
    ds_read_b64_tr_b16 v[100:101], v11 offset:0
    v_mfma_f32_16x16x32_bf16 v[216:219], v[60:63], v[104:107], v[216:219]
    ds_read_b64_tr_b16 v[56:57], v5 offset:9248
    v_mul_f32 v38, v82, v82
    v_mfma_f32_16x16x32_bf16 v[220:223], v[60:63], v[108:111], v[220:223]
    ds_read_b64_tr_b16 v[58:59], v5 offset:13856
    v_add_f32 v27, v83, v91
    ds_read_b64_tr_b16 v[102:103], v11 offset:8192
    s_add_u32 m0, s65, 0
    s_mov_b32 s69, 1179648
    buffer_load_dwordx4 v17, s[44:47], s69 offen lds
    v_mfma_f32_16x16x32_bf16 v[224:227], v[64:67], v[104:107], v[224:227]
    ds_read_b64_tr_b16 v[60:61], v5 offset:64
    v_mul_f32 v39, v83, v83
    v_mfma_f32_16x16x32_bf16 v[228:231], v[64:67], v[108:111], v[228:231]
    ds_read_b64_tr_b16 v[62:63], v5 offset:4672
    v_add_f32 v32, v84, v92
    v_mfma_f32_16x16x32_bf16 v[232:235], v[68:71], v[104:107], v[232:235]
    ds_read_b64_tr_b16 v[64:65], v5 offset:9280
    v_mul_f32 v40, v84, v84
    v_mfma_f32_16x16x32_bf16 v[236:239], v[68:71], v[108:111], v[236:239]
    ds_read_b64_tr_b16 v[66:67], v5 offset:13888
    v_add_f32 v33, v85, v93
    s_add_u32 m0, s66, 0
    s_mov_b32 s69, 1179648
    buffer_load_dwordx4 v18, s[44:47], s69 offen lds
    v_mfma_f32_16x16x32_bf16 v[240:243], v[72:75], v[104:107], v[240:243]
    ds_read_b64_tr_b16 v[68:69], v5 offset:96
    v_mul_f32 v41, v85, v85
    v_mfma_f32_16x16x32_bf16 v[244:247], v[72:75], v[108:111], v[244:247]
    ds_read_b64_tr_b16 v[70:71], v5 offset:4704
    v_add_f32 v34, v86, v94
    v_mfma_f32_16x16x32_bf16 v[248:251], v[76:79], v[104:107], v[248:251]
    ds_read_b64_tr_b16 v[72:73], v5 offset:9312
    v_mul_f32 v42, v86, v86
    v_mfma_f32_16x16x32_bf16 v[252:255], v[76:79], v[108:111], v[252:255]
    ds_read_b64_tr_b16 v[74:75], v5 offset:13920
    v_add_f32 v35, v87, v95
    s_add_u32 m0, s67, 0
    s_mov_b32 s69, 1179648
    buffer_load_dwordx4 v19, s[44:47], s69 offen lds
    s_waitcnt lgkmcnt(8)
    v_mfma_f32_16x16x32_bf16 v[112:115], v[44:47], v[96:99], v[112:115]
    ds_read_b64_tr_b16 v[76:77], v5 offset:128
    v_mul_f32 v43, v87, v87
    v_mfma_f32_16x16x32_bf16 v[116:119], v[44:47], v[100:103], v[116:119]
    ds_read_b64_tr_b16 v[78:79], v5 offset:4736
    v_fmac_f32 v36, v88, v88
    v_mfma_f32_16x16x32_bf16 v[120:123], v[48:51], v[96:99], v[120:123]
    ds_read_b64_tr_b16 v[44:45], v5 offset:9344
    v_fmac_f32 v37, v89, v89
    v_mfma_f32_16x16x32_bf16 v[124:127], v[48:51], v[100:103], v[124:127]
    ds_read_b64_tr_b16 v[46:47], v5 offset:13952
    v_fmac_f32 v38, v90, v90
    s_add_u32 m0, s68, 0
    s_mov_b32 exec_hi, 0
    buffer_load_dwordx4 v20, s[44:47], s69 offen lds
    s_mov_b32 exec_hi, -1
    v_mfma_f32_16x16x32_bf16 v[128:131], v[52:55], v[96:99], v[128:131]
    ds_read_b64_tr_b16 v[48:49], v5 offset:160
    v_fmac_f32 v39, v91, v91
    v_mfma_f32_16x16x32_bf16 v[132:135], v[52:55], v[100:103], v[132:135]
    ds_read_b64_tr_b16 v[50:51], v5 offset:4768
    v_fmac_f32 v40, v92, v92
    v_mfma_f32_16x16x32_bf16 v[136:139], v[56:59], v[96:99], v[136:139]
    ds_read_b64_tr_b16 v[52:53], v5 offset:9376
    v_fmac_f32 v41, v93, v93
    v_mfma_f32_16x16x32_bf16 v[140:143], v[56:59], v[100:103], v[140:143]
    ds_read_b64_tr_b16 v[54:55], v5 offset:13984
    v_fmac_f32 v42, v94, v94
    s_add_u32 m0, s70, 18432
    s_mov_b32 s71, 524288
    buffer_load_dwordx4 v21, s[52:55], s71 offen sc1 lds
    s_waitcnt lgkmcnt(14)
    v_mfma_f32_16x16x32_bf16 v[144:147], v[60:63], v[96:99], v[144:147]
    ds_read_b64_tr_b16 v[56:57], v5 offset:192
    v_fmac_f32 v43, v95, v95
    v_mfma_f32_16x16x32_bf16 v[148:151], v[60:63], v[100:103], v[148:151]
    ds_read_b64_tr_b16 v[58:59], v5 offset:4800
    v_add_f32_dpp v24, v24, v24 quad_perm:[1,0,3,2] row_mask:0xf bank_mask:0xf
    ds_read_b64_tr_b16 v[104:105], v10 offset:34816
    s_waitcnt lgkmcnt(15)
    v_mfma_f32_16x16x32_bf16 v[152:155], v[64:67], v[96:99], v[152:155]
    ds_read_b64_tr_b16 v[60:61], v5 offset:9408
    v_add_f32_dpp v25, v25, v25 quad_perm:[1,0,3,2] row_mask:0xf bank_mask:0xf
    v_mfma_f32_16x16x32_bf16 v[156:159], v[64:67], v[100:103], v[156:159]
    ds_read_b64_tr_b16 v[62:63], v5 offset:14016
    v_add_f32_dpp v26, v26, v26 quad_perm:[1,0,3,2] row_mask:0xf bank_mask:0xf
    ds_read_b64_tr_b16 v[106:107], v10 offset:43008
    s_add_u32 m0, s70, 26624
    s_mov_b32 s71, 589824
    buffer_load_dwordx4 v21, s[52:55], s71 offen sc1 lds
    s_waitcnt lgkmcnt(15)
    v_mfma_f32_16x16x32_bf16 v[160:163], v[68:71], v[96:99], v[160:163]
    ds_read_b64_tr_b16 v[64:65], v5 offset:224
    v_add_f32_dpp v27, v27, v27 quad_perm:[1,0,3,2] row_mask:0xf bank_mask:0xf
    v_mfma_f32_16x16x32_bf16 v[164:167], v[68:71], v[100:103], v[164:167]
    ds_read_b64_tr_b16 v[66:67], v5 offset:4832
    v_add_f32_dpp v32, v32, v32 quad_perm:[1,0,3,2] row_mask:0xf bank_mask:0xf
    ds_read_b64_tr_b16 v[108:109], v11 offset:34816
    s_waitcnt lgkmcnt(15)
    v_mfma_f32_16x16x32_bf16 v[168:171], v[72:75], v[96:99], v[168:171]
    ds_read_b64_tr_b16 v[68:69], v5 offset:9440
    v_add_f32_dpp v33, v33, v33 quad_perm:[1,0,3,2] row_mask:0xf bank_mask:0xf
    v_mfma_f32_16x16x32_bf16 v[172:175], v[72:75], v[100:103], v[172:175]
    ds_read_b64_tr_b16 v[70:71], v5 offset:14048
    v_add_f32_dpp v34, v34, v34 quad_perm:[1,0,3,2] row_mask:0xf bank_mask:0xf
    ds_read_b64_tr_b16 v[110:111], v11 offset:43008
    s_add_u32 m0, s70, 53248
    s_mov_b32 s71, 655360
    buffer_load_dwordx4 v21, s[52:55], s71 offen sc1 lds
    v_mfma_f32_16x16x32_bf16 v[176:179], v[76:79], v[96:99], v[176:179]
    ds_read_b64_tr_b16 v[72:73], v7 offset:0
    v_add_f32_dpp v35, v35, v35 quad_perm:[1,0,3,2] row_mask:0xf bank_mask:0xf
    v_mfma_f32_16x16x32_bf16 v[180:183], v[76:79], v[100:103], v[180:183]
    ds_read_b64_tr_b16 v[74:75], v7 offset:4608
    v_add_f32_dpp v36, v36, v36 quad_perm:[1,0,3,2] row_mask:0xf bank_mask:0xf
    s_waitcnt lgkmcnt(15)
    v_mfma_f32_16x16x32_bf16 v[184:187], v[44:47], v[96:99], v[184:187]
    ds_read_b64_tr_b16 v[76:77], v7 offset:9216
    v_add_f32_dpp v37, v37, v37 quad_perm:[1,0,3,2] row_mask:0xf bank_mask:0xf
    v_mfma_f32_16x16x32_bf16 v[188:191], v[44:47], v[100:103], v[188:191]
    ds_read_b64_tr_b16 v[78:79], v7 offset:13824
    v_add_f32_dpp v38, v38, v38 quad_perm:[1,0,3,2] row_mask:0xf bank_mask:0xf
    s_add_u32 m0, s70, 61440
    s_mov_b32 s71, 720896
    buffer_load_dwordx4 v21, s[52:55], s71 offen sc1 lds
    v_mfma_f32_16x16x32_bf16 v[192:195], v[48:51], v[96:99], v[192:195]
    ds_read_b64_tr_b16 v[44:45], v5 offset:34816
    v_add_f32_dpp v39, v39, v39 quad_perm:[1,0,3,2] row_mask:0xf bank_mask:0xf
    v_mfma_f32_16x16x32_bf16 v[196:199], v[48:51], v[100:103], v[196:199]
    ds_read_b64_tr_b16 v[46:47], v5 offset:39424
    v_add_f32_dpp v40, v40, v40 quad_perm:[1,0,3,2] row_mask:0xf bank_mask:0xf
    s_waitcnt lgkmcnt(15)
    v_mfma_f32_16x16x32_bf16 v[200:203], v[52:55], v[96:99], v[200:203]
    ds_read_b64_tr_b16 v[48:49], v5 offset:44032
    v_add_f32_dpp v41, v41, v41 quad_perm:[1,0,3,2] row_mask:0xf bank_mask:0xf
    v_mfma_f32_16x16x32_bf16 v[204:207], v[52:55], v[100:103], v[204:207]
    ds_read_b64_tr_b16 v[50:51], v5 offset:48640
    v_add_f32_dpp v42, v42, v42 quad_perm:[1,0,3,2] row_mask:0xf bank_mask:0xf
    v_mfma_f32_16x16x32_bf16 v[208:211], v[56:59], v[96:99], v[208:211]
    ds_read_b64_tr_b16 v[52:53], v5 offset:34848
    v_add_f32_dpp v43, v43, v43 quad_perm:[1,0,3,2] row_mask:0xf bank_mask:0xf
    v_mfma_f32_16x16x32_bf16 v[212:215], v[56:59], v[100:103], v[212:215]
    ds_read_b64_tr_b16 v[54:55], v5 offset:39456
    v_add_f32_dpp v24, v24, v24 quad_perm:[2,3,0,1] row_mask:0xf bank_mask:0xf
    s_waitcnt lgkmcnt(15)
    v_mfma_f32_16x16x32_bf16 v[216:219], v[60:63], v[96:99], v[216:219]
    ds_read_b64_tr_b16 v[56:57], v5 offset:44064
    v_add_f32_dpp v25, v25, v25 quad_perm:[2,3,0,1] row_mask:0xf bank_mask:0xf
    v_mfma_f32_16x16x32_bf16 v[220:223], v[60:63], v[100:103], v[220:223]
    ds_read_b64_tr_b16 v[58:59], v5 offset:48672
    v_add_f32_dpp v26, v26, v26 quad_perm:[2,3,0,1] row_mask:0xf bank_mask:0xf
    s_waitcnt lgkmcnt(15)
    v_mfma_f32_16x16x32_bf16 v[224:227], v[64:67], v[96:99], v[224:227]
    ds_read_b64_tr_b16 v[60:61], v5 offset:34880
    v_add_f32_dpp v27, v27, v27 quad_perm:[2,3,0,1] row_mask:0xf bank_mask:0xf
    v_mfma_f32_16x16x32_bf16 v[228:231], v[64:67], v[100:103], v[228:231]
    ds_read_b64_tr_b16 v[62:63], v5 offset:39488
    v_add_f32_dpp v32, v32, v32 quad_perm:[2,3,0,1] row_mask:0xf bank_mask:0xf
    s_waitcnt lgkmcnt(15)
    v_mfma_f32_16x16x32_bf16 v[232:235], v[68:71], v[96:99], v[232:235]
    ds_read_b64_tr_b16 v[64:65], v5 offset:44096
    v_add_f32_dpp v33, v33, v33 quad_perm:[2,3,0,1] row_mask:0xf bank_mask:0xf
    v_mfma_f32_16x16x32_bf16 v[236:239], v[68:71], v[100:103], v[236:239]
    ds_read_b64_tr_b16 v[66:67], v5 offset:48704
    v_add_f32_dpp v34, v34, v34 quad_perm:[2,3,0,1] row_mask:0xf bank_mask:0xf
    s_waitcnt lgkmcnt(14)
    v_mfma_f32_16x16x32_bf16 v[240:243], v[72:75], v[96:99], v[240:243]
    ds_read_b64_tr_b16 v[68:69], v5 offset:34912
    v_add_f32_dpp v35, v35, v35 quad_perm:[2,3,0,1] row_mask:0xf bank_mask:0xf
    v_mfma_f32_16x16x32_bf16 v[244:247], v[72:75], v[100:103], v[244:247]
    ds_read_b64_tr_b16 v[70:71], v5 offset:39520
    v_add_f32_dpp v36, v36, v36 quad_perm:[2,3,0,1] row_mask:0xf bank_mask:0xf
    s_waitcnt lgkmcnt(14)
    v_mfma_f32_16x16x32_bf16 v[248:251], v[76:79], v[96:99], v[248:251]
    ds_read_b64_tr_b16 v[72:73], v5 offset:44128
    v_add_f32_dpp v37, v37, v37 quad_perm:[2,3,0,1] row_mask:0xf bank_mask:0xf
    v_mfma_f32_16x16x32_bf16 v[252:255], v[76:79], v[100:103], v[252:255]
    ds_read_b64_tr_b16 v[74:75], v5 offset:48736
    v_add_f32_dpp v38, v38, v38 quad_perm:[2,3,0,1] row_mask:0xf bank_mask:0xf
    s_waitcnt lgkmcnt(14)
    v_mfma_f32_16x16x32_bf16 v[112:115], v[44:47], v[104:107], v[112:115]
    ds_read_b64_tr_b16 v[76:77], v5 offset:34944
    v_add_f32_dpp v39, v39, v39 quad_perm:[2,3,0,1] row_mask:0xf bank_mask:0xf
    v_mfma_f32_16x16x32_bf16 v[116:119], v[44:47], v[108:111], v[116:119]
    ds_read_b64_tr_b16 v[78:79], v5 offset:39552
    v_add_f32_dpp v40, v40, v40 quad_perm:[2,3,0,1] row_mask:0xf bank_mask:0xf
    s_waitcnt lgkmcnt(14)
    v_mfma_f32_16x16x32_bf16 v[120:123], v[48:51], v[104:107], v[120:123]
    ds_read_b64_tr_b16 v[44:45], v5 offset:44160
    v_add_f32_dpp v41, v41, v41 quad_perm:[2,3,0,1] row_mask:0xf bank_mask:0xf
    v_mfma_f32_16x16x32_bf16 v[124:127], v[48:51], v[108:111], v[124:127]
    ds_read_b64_tr_b16 v[46:47], v5 offset:48768
    v_add_f32_dpp v42, v42, v42 quad_perm:[2,3,0,1] row_mask:0xf bank_mask:0xf
    s_waitcnt lgkmcnt(14)
    v_mfma_f32_16x16x32_bf16 v[128:131], v[52:55], v[104:107], v[128:131]
    ds_read_b64_tr_b16 v[48:49], v5 offset:34976
    v_add_f32_dpp v43, v43, v43 quad_perm:[2,3,0,1] row_mask:0xf bank_mask:0xf
    v_mfma_f32_16x16x32_bf16 v[132:135], v[52:55], v[108:111], v[132:135]
    ds_read_b64_tr_b16 v[50:51], v5 offset:39584
    v_add_f32_dpp v24, v24, v24 row_half_mirror row_mask:0xf bank_mask:0xf
    s_waitcnt lgkmcnt(14)
    v_mfma_f32_16x16x32_bf16 v[136:139], v[56:59], v[104:107], v[136:139]
    ds_read_b64_tr_b16 v[52:53], v5 offset:44192
    v_add_f32_dpp v25, v25, v25 row_half_mirror row_mask:0xf bank_mask:0xf
    v_mfma_f32_16x16x32_bf16 v[140:143], v[56:59], v[108:111], v[140:143]
    ds_read_b64_tr_b16 v[54:55], v5 offset:48800
    v_add_f32_dpp v26, v26, v26 row_half_mirror row_mask:0xf bank_mask:0xf
    s_waitcnt lgkmcnt(14)
    v_mfma_f32_16x16x32_bf16 v[144:147], v[60:63], v[104:107], v[144:147]
    ds_read_b64_tr_b16 v[56:57], v5 offset:35008
    v_add_f32_dpp v27, v27, v27 row_half_mirror row_mask:0xf bank_mask:0xf
    v_mfma_f32_16x16x32_bf16 v[148:151], v[60:63], v[108:111], v[148:151]
    ds_read_b64_tr_b16 v[58:59], v5 offset:39616
    v_add_f32_dpp v32, v32, v32 row_half_mirror row_mask:0xf bank_mask:0xf
    s_waitcnt lgkmcnt(14)
    v_mfma_f32_16x16x32_bf16 v[152:155], v[64:67], v[104:107], v[152:155]
    ds_read_b64_tr_b16 v[60:61], v5 offset:44224
    v_add_f32_dpp v33, v33, v33 row_half_mirror row_mask:0xf bank_mask:0xf
    v_mfma_f32_16x16x32_bf16 v[156:159], v[64:67], v[108:111], v[156:159]
    ds_read_b64_tr_b16 v[62:63], v5 offset:48832
    v_add_f32_dpp v34, v34, v34 row_half_mirror row_mask:0xf bank_mask:0xf
    s_waitcnt lgkmcnt(14)
    v_mfma_f32_16x16x32_bf16 v[160:163], v[68:71], v[104:107], v[160:163]
    ds_read_b64_tr_b16 v[64:65], v5 offset:35040
    v_add_f32_dpp v35, v35, v35 row_half_mirror row_mask:0xf bank_mask:0xf
    v_mfma_f32_16x16x32_bf16 v[164:167], v[68:71], v[108:111], v[164:167]
    ds_read_b64_tr_b16 v[66:67], v5 offset:39648
    v_add_f32_dpp v36, v36, v36 row_half_mirror row_mask:0xf bank_mask:0xf
    s_waitcnt lgkmcnt(14)
    v_mfma_f32_16x16x32_bf16 v[168:171], v[72:75], v[104:107], v[168:171]
    ds_read_b64_tr_b16 v[68:69], v5 offset:44256
    v_add_f32_dpp v37, v37, v37 row_half_mirror row_mask:0xf bank_mask:0xf
    v_mfma_f32_16x16x32_bf16 v[172:175], v[72:75], v[108:111], v[172:175]
    ds_read_b64_tr_b16 v[70:71], v5 offset:48864
    v_add_f32_dpp v38, v38, v38 row_half_mirror row_mask:0xf bank_mask:0xf
    s_waitcnt lgkmcnt(14)
    v_mfma_f32_16x16x32_bf16 v[176:179], v[76:79], v[104:107], v[176:179]
    ds_read_b64_tr_b16 v[72:73], v7 offset:34816
    v_add_f32_dpp v39, v39, v39 row_half_mirror row_mask:0xf bank_mask:0xf
    v_mfma_f32_16x16x32_bf16 v[180:183], v[76:79], v[108:111], v[180:183]
    ds_read_b64_tr_b16 v[74:75], v7 offset:39424
    v_add_f32_dpp v40, v40, v40 row_half_mirror row_mask:0xf bank_mask:0xf
    s_waitcnt lgkmcnt(14)
    v_mfma_f32_16x16x32_bf16 v[184:187], v[44:47], v[104:107], v[184:187]
    ds_read_b64_tr_b16 v[76:77], v7 offset:44032
    v_add_f32_dpp v41, v41, v41 row_half_mirror row_mask:0xf bank_mask:0xf
    v_mfma_f32_16x16x32_bf16 v[188:191], v[44:47], v[108:111], v[188:191]
    ds_read_b64_tr_b16 v[78:79], v7 offset:48640
    v_add_f32_dpp v42, v42, v42 row_half_mirror row_mask:0xf bank_mask:0xf
    s_waitcnt lgkmcnt(0)
    s_waitcnt vmcnt(0)
    s_barrier
    v_mfma_f32_16x16x32_bf16 v[192:195], v[48:51], v[104:107], v[192:195]
    ds_read_b64_tr_b16 v[44:45], v4 offset:0
    v_add_f32_dpp v43, v43, v43 row_half_mirror row_mask:0xf bank_mask:0xf
    v_mfma_f32_16x16x32_bf16 v[196:199], v[48:51], v[108:111], v[196:199]
    ds_read_b64_tr_b16 v[46:47], v4 offset:4608
    v_add_f32_dpp v24, v24, v24 row_mirror row_mask:0xf bank_mask:0xf
    ds_read_b64_tr_b16 v[96:97], v8 offset:0
    v_mfma_f32_16x16x32_bf16 v[200:203], v[52:55], v[104:107], v[200:203]
    ds_read_b64_tr_b16 v[48:49], v4 offset:9216
    v_add_f32_dpp v25, v25, v25 row_mirror row_mask:0xf bank_mask:0xf
    v_mfma_f32_16x16x32_bf16 v[204:207], v[52:55], v[108:111], v[204:207]
    ds_read_b64_tr_b16 v[50:51], v4 offset:13824
    v_add_f32_dpp v26, v26, v26 row_mirror row_mask:0xf bank_mask:0xf
    ds_read_b64_tr_b16 v[98:99], v8 offset:8192
    s_add_u32 m0, s64, 69632
    s_mov_b32 s69, 1769472
    buffer_load_dwordx4 v16, s[44:47], s69 offen lds
    v_mfma_f32_16x16x32_bf16 v[208:211], v[56:59], v[104:107], v[208:211]
    ds_read_b64_tr_b16 v[52:53], v4 offset:32
    v_add_f32_dpp v27, v27, v27 row_mirror row_mask:0xf bank_mask:0xf
    v_mfma_f32_16x16x32_bf16 v[212:215], v[56:59], v[108:111], v[212:215]
    ds_read_b64_tr_b16 v[54:55], v4 offset:4640
    v_add_f32_dpp v32, v32, v32 row_mirror row_mask:0xf bank_mask:0xf
    ds_read_b64_tr_b16 v[100:101], v9 offset:0
    v_mfma_f32_16x16x32_bf16 v[216:219], v[60:63], v[104:107], v[216:219]
    ds_read_b64_tr_b16 v[56:57], v4 offset:9248
    v_add_f32_dpp v33, v33, v33 row_mirror row_mask:0xf bank_mask:0xf
    v_mfma_f32_16x16x32_bf16 v[220:223], v[60:63], v[108:111], v[220:223]
    ds_read_b64_tr_b16 v[58:59], v4 offset:13856
    v_add_f32_dpp v34, v34, v34 row_mirror row_mask:0xf bank_mask:0xf
    ds_read_b64_tr_b16 v[102:103], v9 offset:8192
    s_add_u32 m0, s65, 69632
    s_mov_b32 s69, 1769472
    buffer_load_dwordx4 v17, s[44:47], s69 offen lds
    v_mfma_f32_16x16x32_bf16 v[224:227], v[64:67], v[104:107], v[224:227]
    ds_read_b64_tr_b16 v[60:61], v4 offset:64
    v_add_f32_dpp v35, v35, v35 row_mirror row_mask:0xf bank_mask:0xf
    v_mfma_f32_16x16x32_bf16 v[228:231], v[64:67], v[108:111], v[228:231]
    ds_read_b64_tr_b16 v[62:63], v4 offset:4672
    v_add_f32_dpp v36, v36, v36 row_mirror row_mask:0xf bank_mask:0xf
    v_mfma_f32_16x16x32_bf16 v[232:235], v[68:71], v[104:107], v[232:235]
    ds_read_b64_tr_b16 v[64:65], v4 offset:9280
    v_add_f32_dpp v37, v37, v37 row_mirror row_mask:0xf bank_mask:0xf
    v_mfma_f32_16x16x32_bf16 v[236:239], v[68:71], v[108:111], v[236:239]
    ds_read_b64_tr_b16 v[66:67], v4 offset:13888
    v_add_f32_dpp v38, v38, v38 row_mirror row_mask:0xf bank_mask:0xf
    s_add_u32 m0, s66, 69632
    s_mov_b32 s69, 1769472
    buffer_load_dwordx4 v18, s[44:47], s69 offen lds
    v_mfma_f32_16x16x32_bf16 v[240:243], v[72:75], v[104:107], v[240:243]
    ds_read_b64_tr_b16 v[68:69], v4 offset:96
    v_add_f32_dpp v39, v39, v39 row_mirror row_mask:0xf bank_mask:0xf
    v_mfma_f32_16x16x32_bf16 v[244:247], v[72:75], v[108:111], v[244:247]
    ds_read_b64_tr_b16 v[70:71], v4 offset:4704
    v_add_f32_dpp v40, v40, v40 row_mirror row_mask:0xf bank_mask:0xf
    v_mfma_f32_16x16x32_bf16 v[248:251], v[76:79], v[104:107], v[248:251]
    ds_read_b64_tr_b16 v[72:73], v4 offset:9312
    v_add_f32_dpp v41, v41, v41 row_mirror row_mask:0xf bank_mask:0xf
    v_mfma_f32_16x16x32_bf16 v[252:255], v[76:79], v[108:111], v[252:255]
    ds_read_b64_tr_b16 v[74:75], v4 offset:13920
    v_add_f32_dpp v42, v42, v42 row_mirror row_mask:0xf bank_mask:0xf
    s_add_u32 m0, s67, 69632
    s_mov_b32 s69, 1769472
    buffer_load_dwordx4 v19, s[44:47], s69 offen lds
    s_waitcnt lgkmcnt(8)
    v_mfma_f32_16x16x32_bf16 v[112:115], v[44:47], v[96:99], v[112:115]
    ds_read_b64_tr_b16 v[76:77], v4 offset:128
    v_add_f32_dpp v43, v43, v43 row_mirror row_mask:0xf bank_mask:0xf
    v_mfma_f32_16x16x32_bf16 v[116:119], v[44:47], v[100:103], v[116:119]
    ds_read_b64_tr_b16 v[78:79], v4 offset:4736
    v_and_b32 v28, 15, v0
    v_mfma_f32_16x16x32_bf16 v[120:123], v[48:51], v[96:99], v[120:123]
    ds_read_b64_tr_b16 v[44:45], v4 offset:9344
    v_lshrrev_b32 v29, 4, v0
    v_mfma_f32_16x16x32_bf16 v[124:127], v[48:51], v[100:103], v[124:127]
    ds_read_b64_tr_b16 v[46:47], v4 offset:13952
    v_lshlrev_b32 v29, 6, v29
    s_add_u32 m0, s68, 69632
    s_mov_b32 exec_hi, 0
    buffer_load_dwordx4 v20, s[44:47], s69 offen lds
    s_mov_b32 exec_hi, -1
    v_mfma_f32_16x16x32_bf16 v[128:131], v[52:55], v[96:99], v[128:131]
    ds_read_b64_tr_b16 v[48:49], v4 offset:160
    v_add_u32 v29, 159936, v29
    v_mfma_f32_16x16x32_bf16 v[132:135], v[52:55], v[100:103], v[132:135]
    ds_read_b64_tr_b16 v[50:51], v4 offset:4768
    v_cmp_eq_u32 vcc, 0, v28
    s_and_saveexec_b64 s[12:13], vcc
    ds_write_b128 v29, v[24:27]
    ds_write_b128 v29, v[32:35] offset:16
    ds_write_b128 v29, v[36:39] offset:32
    ds_write_b128 v29, v[40:43] offset:48
    s_mov_b64 exec, s[12:13]
    v_mfma_f32_16x16x32_bf16 v[136:139], v[56:59], v[96:99], v[136:139]
    ds_read_b64_tr_b16 v[52:53], v4 offset:9376
    v_mfma_f32_16x16x32_bf16 v[140:143], v[56:59], v[100:103], v[140:143]
    ds_read_b64_tr_b16 v[54:55], v4 offset:13984
    s_add_u32 m0, s70, 88064
    s_mov_b32 s71, 786432
    buffer_load_dwordx4 v21, s[52:55], s71 offen sc1 lds
    s_waitcnt lgkmcnt(15)
    v_mfma_f32_16x16x32_bf16 v[144:147], v[60:63], v[96:99], v[144:147]
    ds_read_b64_tr_b16 v[56:57], v4 offset:192
    v_mfma_f32_16x16x32_bf16 v[148:151], v[60:63], v[100:103], v[148:151]
    ds_read_b64_tr_b16 v[58:59], v4 offset:4800
    ds_read_b64_tr_b16 v[104:105], v8 offset:34816
    v_mfma_f32_16x16x32_bf16 v[152:155], v[64:67], v[96:99], v[152:155]
    ds_read_b64_tr_b16 v[60:61], v4 offset:9408
    v_mfma_f32_16x16x32_bf16 v[156:159], v[64:67], v[100:103], v[156:159]
    ds_read_b64_tr_b16 v[62:63], v4 offset:14016
    ds_read_b64_tr_b16 v[106:107], v8 offset:43008
    s_add_u32 m0, s70, 96256
    s_mov_b32 s71, 851968
    buffer_load_dwordx4 v21, s[52:55], s71 offen sc1 lds
    s_waitcnt lgkmcnt(15)
    v_mfma_f32_16x16x32_bf16 v[160:163], v[68:71], v[96:99], v[160:163]
    ds_read_b64_tr_b16 v[64:65], v4 offset:224
    v_mfma_f32_16x16x32_bf16 v[164:167], v[68:71], v[100:103], v[164:167]
    ds_read_b64_tr_b16 v[66:67], v4 offset:4832
    ds_read_b64_tr_b16 v[108:109], v9 offset:34816
    v_mfma_f32_16x16x32_bf16 v[168:171], v[72:75], v[96:99], v[168:171]
    ds_read_b64_tr_b16 v[68:69], v4 offset:9440
    v_mfma_f32_16x16x32_bf16 v[172:175], v[72:75], v[100:103], v[172:175]
    ds_read_b64_tr_b16 v[70:71], v4 offset:14048
    ds_read_b64_tr_b16 v[110:111], v9 offset:43008
    s_add_u32 m0, s70, 122880
    s_mov_b32 s71, 917504
    buffer_load_dwordx4 v21, s[52:55], s71 offen sc1 lds
    v_mfma_f32_16x16x32_bf16 v[176:179], v[76:79], v[96:99], v[176:179]
    ds_read_b64_tr_b16 v[72:73], v6 offset:0
    v_mfma_f32_16x16x32_bf16 v[180:183], v[76:79], v[100:103], v[180:183]
    ds_read_b64_tr_b16 v[74:75], v6 offset:4608
    s_waitcnt lgkmcnt(15)
    v_mfma_f32_16x16x32_bf16 v[184:187], v[44:47], v[96:99], v[184:187]
    ds_read_b64_tr_b16 v[76:77], v6 offset:9216
    v_mfma_f32_16x16x32_bf16 v[188:191], v[44:47], v[100:103], v[188:191]
    ds_read_b64_tr_b16 v[78:79], v6 offset:13824
    s_add_u32 m0, s70, 131072
    s_mov_b32 s71, 983040
    buffer_load_dwordx4 v21, s[52:55], s71 offen sc1 lds
    v_mfma_f32_16x16x32_bf16 v[192:195], v[48:51], v[96:99], v[192:195]
    ds_read_b64_tr_b16 v[44:45], v4 offset:34816
    v_mfma_f32_16x16x32_bf16 v[196:199], v[48:51], v[100:103], v[196:199]
    ds_read_b64_tr_b16 v[46:47], v4 offset:39424
    s_waitcnt lgkmcnt(15)
    v_mfma_f32_16x16x32_bf16 v[200:203], v[52:55], v[96:99], v[200:203]
    ds_read_b64_tr_b16 v[48:49], v4 offset:44032
    v_mfma_f32_16x16x32_bf16 v[204:207], v[52:55], v[100:103], v[204:207]
    ds_read_b64_tr_b16 v[50:51], v4 offset:48640
    v_mfma_f32_16x16x32_bf16 v[208:211], v[56:59], v[96:99], v[208:211]
    ds_read_b64_tr_b16 v[52:53], v4 offset:34848
    v_mfma_f32_16x16x32_bf16 v[212:215], v[56:59], v[100:103], v[212:215]
    ds_read_b64_tr_b16 v[54:55], v4 offset:39456
    s_waitcnt lgkmcnt(15)
    v_mfma_f32_16x16x32_bf16 v[216:219], v[60:63], v[96:99], v[216:219]
    ds_read_b64_tr_b16 v[56:57], v4 offset:44064
    v_mfma_f32_16x16x32_bf16 v[220:223], v[60:63], v[100:103], v[220:223]
    ds_read_b64_tr_b16 v[58:59], v4 offset:48672
    s_waitcnt lgkmcnt(15)
    v_mfma_f32_16x16x32_bf16 v[224:227], v[64:67], v[96:99], v[224:227]
    ds_read_b64_tr_b16 v[60:61], v4 offset:34880
    v_mfma_f32_16x16x32_bf16 v[228:231], v[64:67], v[100:103], v[228:231]
    ds_read_b64_tr_b16 v[62:63], v4 offset:39488
    s_waitcnt lgkmcnt(15)
    v_mfma_f32_16x16x32_bf16 v[232:235], v[68:71], v[96:99], v[232:235]
    ds_read_b64_tr_b16 v[64:65], v4 offset:44096
    v_mfma_f32_16x16x32_bf16 v[236:239], v[68:71], v[100:103], v[236:239]
    ds_read_b64_tr_b16 v[66:67], v4 offset:48704
    s_waitcnt lgkmcnt(14)
    v_mfma_f32_16x16x32_bf16 v[240:243], v[72:75], v[96:99], v[240:243]
    ds_read_b64_tr_b16 v[68:69], v4 offset:34912
    v_mfma_f32_16x16x32_bf16 v[244:247], v[72:75], v[100:103], v[244:247]
    ds_read_b64_tr_b16 v[70:71], v4 offset:39520
    s_waitcnt lgkmcnt(14)
    v_mfma_f32_16x16x32_bf16 v[248:251], v[76:79], v[96:99], v[248:251]
    ds_read_b64_tr_b16 v[72:73], v4 offset:44128
    v_mfma_f32_16x16x32_bf16 v[252:255], v[76:79], v[100:103], v[252:255]
    ds_read_b64_tr_b16 v[74:75], v4 offset:48736
    s_waitcnt lgkmcnt(14)
    v_mfma_f32_16x16x32_bf16 v[112:115], v[44:47], v[104:107], v[112:115]
    ds_read_b64_tr_b16 v[76:77], v4 offset:34944
    v_mfma_f32_16x16x32_bf16 v[116:119], v[44:47], v[108:111], v[116:119]
    ds_read_b64_tr_b16 v[78:79], v4 offset:39552
    s_waitcnt lgkmcnt(14)
    v_mfma_f32_16x16x32_bf16 v[120:123], v[48:51], v[104:107], v[120:123]
    ds_read_b64_tr_b16 v[44:45], v4 offset:44160
    v_mfma_f32_16x16x32_bf16 v[124:127], v[48:51], v[108:111], v[124:127]
    ds_read_b64_tr_b16 v[46:47], v4 offset:48768
    s_waitcnt lgkmcnt(14)
    v_mfma_f32_16x16x32_bf16 v[128:131], v[52:55], v[104:107], v[128:131]
    ds_read_b64_tr_b16 v[48:49], v4 offset:34976
    v_mfma_f32_16x16x32_bf16 v[132:135], v[52:55], v[108:111], v[132:135]
    ds_read_b64_tr_b16 v[50:51], v4 offset:39584
    s_waitcnt lgkmcnt(14)
    v_mfma_f32_16x16x32_bf16 v[136:139], v[56:59], v[104:107], v[136:139]
    ds_read_b64_tr_b16 v[52:53], v4 offset:44192
    v_mfma_f32_16x16x32_bf16 v[140:143], v[56:59], v[108:111], v[140:143]
    ds_read_b64_tr_b16 v[54:55], v4 offset:48800
    s_waitcnt lgkmcnt(14)
    v_mfma_f32_16x16x32_bf16 v[144:147], v[60:63], v[104:107], v[144:147]
    ds_read_b64_tr_b16 v[56:57], v4 offset:35008
    v_mfma_f32_16x16x32_bf16 v[148:151], v[60:63], v[108:111], v[148:151]
    ds_read_b64_tr_b16 v[58:59], v4 offset:39616
    s_waitcnt lgkmcnt(14)
    v_mfma_f32_16x16x32_bf16 v[152:155], v[64:67], v[104:107], v[152:155]
    ds_read_b64_tr_b16 v[60:61], v4 offset:44224
    v_mfma_f32_16x16x32_bf16 v[156:159], v[64:67], v[108:111], v[156:159]
    ds_read_b64_tr_b16 v[62:63], v4 offset:48832
    s_waitcnt lgkmcnt(14)
    v_mfma_f32_16x16x32_bf16 v[160:163], v[68:71], v[104:107], v[160:163]
    ds_read_b64_tr_b16 v[64:65], v4 offset:35040
    v_mfma_f32_16x16x32_bf16 v[164:167], v[68:71], v[108:111], v[164:167]
    ds_read_b64_tr_b16 v[66:67], v4 offset:39648
    s_waitcnt lgkmcnt(14)
    v_mfma_f32_16x16x32_bf16 v[168:171], v[72:75], v[104:107], v[168:171]
    ds_read_b64_tr_b16 v[68:69], v4 offset:44256
    v_mfma_f32_16x16x32_bf16 v[172:175], v[72:75], v[108:111], v[172:175]
    ds_read_b64_tr_b16 v[70:71], v4 offset:48864
    s_waitcnt lgkmcnt(14)
    v_mfma_f32_16x16x32_bf16 v[176:179], v[76:79], v[104:107], v[176:179]
    ds_read_b64_tr_b16 v[72:73], v6 offset:34816
    v_mfma_f32_16x16x32_bf16 v[180:183], v[76:79], v[108:111], v[180:183]
    ds_read_b64_tr_b16 v[74:75], v6 offset:39424
    s_waitcnt lgkmcnt(14)
    v_mfma_f32_16x16x32_bf16 v[184:187], v[44:47], v[104:107], v[184:187]
    ds_read_b64_tr_b16 v[76:77], v6 offset:44032
    v_mfma_f32_16x16x32_bf16 v[188:191], v[44:47], v[108:111], v[188:191]
    ds_read_b64_tr_b16 v[78:79], v6 offset:48640
    s_waitcnt lgkmcnt(0)
    s_waitcnt vmcnt(0)
    s_barrier
    s_cmp_eq_u32 s3, 7
    s_cbranch_scc0 sequential_preLN__ssm_conv_s4d__glu_gated_reglu__prompt_kernel_sf21
    v_and_b32 v28, 15, v1
    v_lshrrev_b32 v29, 4, v1
    v_lshlrev_b32 v29, 9, v29
    v_lshl_add_u32 v28, v28, 2, v29
    v_add_u32 v28, 159936, v28
    ds_read_b32 v32, v28 offset:0
    ds_read_b32 v33, v28 offset:64
    ds_read_b32 v34, v28 offset:128
    ds_read_b32 v35, v28 offset:192
    ds_read_b32 v36, v28 offset:256
    ds_read_b32 v37, v28 offset:320
    ds_read_b32 v38, v28 offset:384
    ds_read_b32 v39, v28 offset:448
    s_waitcnt lgkmcnt(0)
    v_add_f32 v32, v32, v33
    v_add_f32 v34, v34, v35
    v_add_f32 v36, v36, v37
    v_add_f32 v38, v38, v39
    v_add_f32 v32, v32, v34
    v_add_f32 v36, v36, v38
    v_add_f32 v32, v32, v36
    v_mov_b32 v33, v32
    s_nop 1
    v_permlane32_swap_b32 v32, v33
    s_nop 1
    v_add_f32 v32, v32, v33
    v_mov_b32 v33, v32
    s_nop 1
    v_permlane16_swap_b32 v32, v33
    s_nop 1
    v_add_f32 v32, v32, v33
    s_nop 1
    v_mov_b32_dpp v33, v32 row_shl:8 row_mask:0xf bank_mask:0xf
    s_mov_b32 s12, 0x3ae38e39
    v_mul_f32 v32, s12, v32
    v_mul_f32 v33, s12, v33
    v_fma_f32 v33, -v32, v32, v33
    v_max_f32 v33, 0, v33
    v_cvt_pk_bf16_f32 v32, v32, v32
    v_lshlrev_b32 v32, 16, v32
    v_cvt_pk_bf16_f32 v33, v33, v33
    v_lshlrev_b32 v33, 16, v33
    v_add_f32 v33, 0x3727c5ac, v33
    v_cvt_pk_bf16_f32 v33, v33, v33
    v_lshlrev_b32 v33, 16, v33
    v_sqrt_f32 v33, v33
    s_nop 0
    v_cvt_pk_bf16_f32 v33, v33, v33
    v_lshlrev_b32 v33, 16, v33
    v_rcp_f32 v33, v33
    s_nop 0
    v_mul_f32 v33, v33, v33
    s_mov_b64 exec, 0xff
    v_lshlrev_b32 v28, 2, v1
    v_add_u32 v29, 159872, v28
    ds_write_b32 v29, v33
    s_add_u32 s60, s42, 81920
    s_addc_u32 s61, s43, 0
    s_and_b32 s61, s61, 0xffff
    s_mov_b32 s62, 8192
    s_mov_b32 s63, 0x20000
    s_lshl_b32 s12, s11, 2
    buffer_store_dword v32, v28, s[60:63], s12 offen sc1
    s_mov_b64 exec, -1
    s_waitcnt lgkmcnt(0)
sequential_preLN__ssm_conv_s4d__glu_gated_reglu__prompt_kernel_sf21:
    s_cmp_lt_u32 s3, 5
    s_cbranch_scc0 sequential_preLN__ssm_conv_s4d__glu_gated_reglu__prompt_kernel_cr22
    v_lshlrev_b32 v28, 2, v0
    v_add_u32 v29, 139264, v28
    ds_read_b32 v32, v29 offset:0
    ds_read_b32 v33, v29 offset:1152
    ds_read_b32 v34, v29 offset:2304
    ds_read_b32 v35, v29 offset:3456
    ds_read_b32 v36, v29 offset:4608
    ds_read_b32 v37, v29 offset:5760
    ds_read_b32 v38, v29 offset:6912
    ds_read_b32 v39, v29 offset:8064
    s_waitcnt lgkmcnt(0)
    v_add_f32 v32, v32, v33
    v_add_f32 v32, v32, v34
    v_add_f32 v32, v32, v35
    v_add_f32 v32, v32, v36
    v_add_f32 v32, v32, v37
    v_add_f32 v32, v32, v38
    v_add_f32 v32, v32, v39
    v_add_u32 v29, 148480, v28
    v_cmp_gt_u32 vcc, 288, v0
    s_and_saveexec_b64 s[12:13], vcc
    ds_write_b32 v29, v32
    s_mov_b64 exec, s[12:13]
    s_waitcnt lgkmcnt(0)
sequential_preLN__ssm_conv_s4d__glu_gated_reglu__prompt_kernel_cr22:
    v_mfma_f32_16x16x32_bf16 v[192:195], v[48:51], v[104:107], v[192:195]
    ds_read_b64_tr_b16 v[44:45], v5 offset:0
    v_mfma_f32_16x16x32_bf16 v[196:199], v[48:51], v[108:111], v[196:199]
    ds_read_b64_tr_b16 v[46:47], v5 offset:4608
    ds_read_b64_tr_b16 v[96:97], v10 offset:0
    v_mfma_f32_16x16x32_bf16 v[200:203], v[52:55], v[104:107], v[200:203]
    ds_read_b64_tr_b16 v[48:49], v5 offset:9216
    v_mfma_f32_16x16x32_bf16 v[204:207], v[52:55], v[108:111], v[204:207]
    ds_read_b64_tr_b16 v[50:51], v5 offset:13824
    ds_read_b64_tr_b16 v[98:99], v10 offset:8192
    s_add_u32 m0, s64, 0
    s_mov_b32 s69, 2359296
    buffer_load_dwordx4 v16, s[44:47], s69 offen lds
    v_mfma_f32_16x16x32_bf16 v[208:211], v[56:59], v[104:107], v[208:211]
    ds_read_b64_tr_b16 v[52:53], v5 offset:32
    v_mfma_f32_16x16x32_bf16 v[212:215], v[56:59], v[108:111], v[212:215]
    ds_read_b64_tr_b16 v[54:55], v5 offset:4640
    ds_read_b64_tr_b16 v[100:101], v11 offset:0
    v_mfma_f32_16x16x32_bf16 v[216:219], v[60:63], v[104:107], v[216:219]
    ds_read_b64_tr_b16 v[56:57], v5 offset:9248
    v_mfma_f32_16x16x32_bf16 v[220:223], v[60:63], v[108:111], v[220:223]
    ds_read_b64_tr_b16 v[58:59], v5 offset:13856
    ds_read_b64_tr_b16 v[102:103], v11 offset:8192
    s_add_u32 m0, s65, 0
    s_mov_b32 s69, 2359296
    buffer_load_dwordx4 v17, s[44:47], s69 offen lds
    v_mfma_f32_16x16x32_bf16 v[224:227], v[64:67], v[104:107], v[224:227]
    ds_read_b64_tr_b16 v[60:61], v5 offset:64
    v_mfma_f32_16x16x32_bf16 v[228:231], v[64:67], v[108:111], v[228:231]
    ds_read_b64_tr_b16 v[62:63], v5 offset:4672
    v_mfma_f32_16x16x32_bf16 v[232:235], v[68:71], v[104:107], v[232:235]
    ds_read_b64_tr_b16 v[64:65], v5 offset:9280
    v_mfma_f32_16x16x32_bf16 v[236:239], v[68:71], v[108:111], v[236:239]
    ds_read_b64_tr_b16 v[66:67], v5 offset:13888
    s_add_u32 m0, s66, 0
    s_mov_b32 s69, 2359296
    buffer_load_dwordx4 v18, s[44:47], s69 offen lds
    v_mfma_f32_16x16x32_bf16 v[240:243], v[72:75], v[104:107], v[240:243]
    ds_read_b64_tr_b16 v[68:69], v5 offset:96
    v_mfma_f32_16x16x32_bf16 v[244:247], v[72:75], v[108:111], v[244:247]
    ds_read_b64_tr_b16 v[70:71], v5 offset:4704
    v_mfma_f32_16x16x32_bf16 v[248:251], v[76:79], v[104:107], v[248:251]
    ds_read_b64_tr_b16 v[72:73], v5 offset:9312
    v_mfma_f32_16x16x32_bf16 v[252:255], v[76:79], v[108:111], v[252:255]
    ds_read_b64_tr_b16 v[74:75], v5 offset:13920
    s_add_u32 m0, s67, 0
    s_mov_b32 s69, 2359296
    buffer_load_dwordx4 v19, s[44:47], s69 offen lds
    s_waitcnt lgkmcnt(8)
    v_mfma_f32_16x16x32_bf16 v[112:115], v[44:47], v[96:99], v[112:115]
    ds_read_b64_tr_b16 v[76:77], v5 offset:128
    v_mfma_f32_16x16x32_bf16 v[116:119], v[44:47], v[100:103], v[116:119]
    ds_read_b64_tr_b16 v[78:79], v5 offset:4736
    v_mfma_f32_16x16x32_bf16 v[120:123], v[48:51], v[96:99], v[120:123]
    ds_read_b64_tr_b16 v[44:45], v5 offset:9344
    v_mfma_f32_16x16x32_bf16 v[124:127], v[48:51], v[100:103], v[124:127]
    ds_read_b64_tr_b16 v[46:47], v5 offset:13952
    s_add_u32 m0, s68, 0
    s_mov_b32 exec_hi, 0
    buffer_load_dwordx4 v20, s[44:47], s69 offen lds
    s_mov_b32 exec_hi, -1
    v_mfma_f32_16x16x32_bf16 v[128:131], v[52:55], v[96:99], v[128:131]
    ds_read_b64_tr_b16 v[48:49], v5 offset:160
    v_mfma_f32_16x16x32_bf16 v[132:135], v[52:55], v[100:103], v[132:135]
    ds_read_b64_tr_b16 v[50:51], v5 offset:4768
    v_mfma_f32_16x16x32_bf16 v[136:139], v[56:59], v[96:99], v[136:139]
    ds_read_b64_tr_b16 v[52:53], v5 offset:9376
    v_mfma_f32_16x16x32_bf16 v[140:143], v[56:59], v[100:103], v[140:143]
    ds_read_b64_tr_b16 v[54:55], v5 offset:13984
    s_add_u32 m0, s70, 18432
    s_mov_b32 s71, 1048576
    buffer_load_dwordx4 v21, s[52:55], s71 offen sc1 lds
    s_waitcnt lgkmcnt(14)
    v_mfma_f32_16x16x32_bf16 v[144:147], v[60:63], v[96:99], v[144:147]
    ds_read_b64_tr_b16 v[56:57], v5 offset:192
    v_mfma_f32_16x16x32_bf16 v[148:151], v[60:63], v[100:103], v[148:151]
    ds_read_b64_tr_b16 v[58:59], v5 offset:4800
    ds_read_b64_tr_b16 v[104:105], v10 offset:34816
    s_waitcnt lgkmcnt(15)
    v_mfma_f32_16x16x32_bf16 v[152:155], v[64:67], v[96:99], v[152:155]
    ds_read_b64_tr_b16 v[60:61], v5 offset:9408
    v_mfma_f32_16x16x32_bf16 v[156:159], v[64:67], v[100:103], v[156:159]
    ds_read_b64_tr_b16 v[62:63], v5 offset:14016
    ds_read_b64_tr_b16 v[106:107], v10 offset:43008
    s_add_u32 m0, s70, 26624
    s_mov_b32 s71, 1114112
    buffer_load_dwordx4 v21, s[52:55], s71 offen sc1 lds
    s_waitcnt lgkmcnt(15)
    v_mfma_f32_16x16x32_bf16 v[160:163], v[68:71], v[96:99], v[160:163]
    ds_read_b64_tr_b16 v[64:65], v5 offset:224
    v_mfma_f32_16x16x32_bf16 v[164:167], v[68:71], v[100:103], v[164:167]
    ds_read_b64_tr_b16 v[66:67], v5 offset:4832
    ds_read_b64_tr_b16 v[108:109], v11 offset:34816
    s_waitcnt lgkmcnt(15)
    v_mfma_f32_16x16x32_bf16 v[168:171], v[72:75], v[96:99], v[168:171]
    ds_read_b64_tr_b16 v[68:69], v5 offset:9440
    v_mfma_f32_16x16x32_bf16 v[172:175], v[72:75], v[100:103], v[172:175]
    ds_read_b64_tr_b16 v[70:71], v5 offset:14048
    ds_read_b64_tr_b16 v[110:111], v11 offset:43008
    s_add_u32 m0, s70, 53248
    s_mov_b32 s71, 1179648
    buffer_load_dwordx4 v21, s[52:55], s71 offen sc1 lds
    v_mfma_f32_16x16x32_bf16 v[176:179], v[76:79], v[96:99], v[176:179]
    ds_read_b64_tr_b16 v[72:73], v7 offset:0
    v_mfma_f32_16x16x32_bf16 v[180:183], v[76:79], v[100:103], v[180:183]
    ds_read_b64_tr_b16 v[74:75], v7 offset:4608
    s_waitcnt lgkmcnt(15)
    v_mfma_f32_16x16x32_bf16 v[184:187], v[44:47], v[96:99], v[184:187]
    ds_read_b64_tr_b16 v[76:77], v7 offset:9216
    v_mfma_f32_16x16x32_bf16 v[188:191], v[44:47], v[100:103], v[188:191]
    ds_read_b64_tr_b16 v[78:79], v7 offset:13824
    s_add_u32 m0, s70, 61440
    s_mov_b32 s71, 1245184
    buffer_load_dwordx4 v21, s[52:55], s71 offen sc1 lds
    v_mfma_f32_16x16x32_bf16 v[192:195], v[48:51], v[96:99], v[192:195]
    ds_read_b64_tr_b16 v[44:45], v5 offset:34816
    v_mfma_f32_16x16x32_bf16 v[196:199], v[48:51], v[100:103], v[196:199]
    ds_read_b64_tr_b16 v[46:47], v5 offset:39424
    s_waitcnt lgkmcnt(15)
    v_mfma_f32_16x16x32_bf16 v[200:203], v[52:55], v[96:99], v[200:203]
    ds_read_b64_tr_b16 v[48:49], v5 offset:44032
    v_mfma_f32_16x16x32_bf16 v[204:207], v[52:55], v[100:103], v[204:207]
    ds_read_b64_tr_b16 v[50:51], v5 offset:48640
    v_mfma_f32_16x16x32_bf16 v[208:211], v[56:59], v[96:99], v[208:211]
    ds_read_b64_tr_b16 v[52:53], v5 offset:34848
    v_mfma_f32_16x16x32_bf16 v[212:215], v[56:59], v[100:103], v[212:215]
    ds_read_b64_tr_b16 v[54:55], v5 offset:39456
    s_waitcnt lgkmcnt(15)
    v_mfma_f32_16x16x32_bf16 v[216:219], v[60:63], v[96:99], v[216:219]
    ds_read_b64_tr_b16 v[56:57], v5 offset:44064
    v_mfma_f32_16x16x32_bf16 v[220:223], v[60:63], v[100:103], v[220:223]
    ds_read_b64_tr_b16 v[58:59], v5 offset:48672
    s_waitcnt lgkmcnt(15)
    v_mfma_f32_16x16x32_bf16 v[224:227], v[64:67], v[96:99], v[224:227]
    ds_read_b64_tr_b16 v[60:61], v5 offset:34880
    v_mfma_f32_16x16x32_bf16 v[228:231], v[64:67], v[100:103], v[228:231]
    ds_read_b64_tr_b16 v[62:63], v5 offset:39488
    s_waitcnt lgkmcnt(15)
    v_mfma_f32_16x16x32_bf16 v[232:235], v[68:71], v[96:99], v[232:235]
    ds_read_b64_tr_b16 v[64:65], v5 offset:44096
    v_mfma_f32_16x16x32_bf16 v[236:239], v[68:71], v[100:103], v[236:239]
    ds_read_b64_tr_b16 v[66:67], v5 offset:48704
    s_waitcnt lgkmcnt(14)
    v_mfma_f32_16x16x32_bf16 v[240:243], v[72:75], v[96:99], v[240:243]
    ds_read_b64_tr_b16 v[68:69], v5 offset:34912
    v_mfma_f32_16x16x32_bf16 v[244:247], v[72:75], v[100:103], v[244:247]
    ds_read_b64_tr_b16 v[70:71], v5 offset:39520
    s_waitcnt lgkmcnt(14)
    v_mfma_f32_16x16x32_bf16 v[248:251], v[76:79], v[96:99], v[248:251]
    ds_read_b64_tr_b16 v[72:73], v5 offset:44128
    v_mfma_f32_16x16x32_bf16 v[252:255], v[76:79], v[100:103], v[252:255]
    ds_read_b64_tr_b16 v[74:75], v5 offset:48736
    s_waitcnt lgkmcnt(14)
    v_mfma_f32_16x16x32_bf16 v[112:115], v[44:47], v[104:107], v[112:115]
    ds_read_b64_tr_b16 v[76:77], v5 offset:34944
    v_mfma_f32_16x16x32_bf16 v[116:119], v[44:47], v[108:111], v[116:119]
    ds_read_b64_tr_b16 v[78:79], v5 offset:39552
    s_waitcnt lgkmcnt(14)
    v_mfma_f32_16x16x32_bf16 v[120:123], v[48:51], v[104:107], v[120:123]
    ds_read_b64_tr_b16 v[44:45], v5 offset:44160
    v_mfma_f32_16x16x32_bf16 v[124:127], v[48:51], v[108:111], v[124:127]
    ds_read_b64_tr_b16 v[46:47], v5 offset:48768
    s_waitcnt lgkmcnt(14)
    v_mfma_f32_16x16x32_bf16 v[128:131], v[52:55], v[104:107], v[128:131]
    ds_read_b64_tr_b16 v[48:49], v5 offset:34976
    v_mfma_f32_16x16x32_bf16 v[132:135], v[52:55], v[108:111], v[132:135]
    ds_read_b64_tr_b16 v[50:51], v5 offset:39584
    s_waitcnt lgkmcnt(14)
    v_mfma_f32_16x16x32_bf16 v[136:139], v[56:59], v[104:107], v[136:139]
    ds_read_b64_tr_b16 v[52:53], v5 offset:44192
    v_mfma_f32_16x16x32_bf16 v[140:143], v[56:59], v[108:111], v[140:143]
    ds_read_b64_tr_b16 v[54:55], v5 offset:48800
    s_waitcnt lgkmcnt(14)
    v_mfma_f32_16x16x32_bf16 v[144:147], v[60:63], v[104:107], v[144:147]
    ds_read_b64_tr_b16 v[56:57], v5 offset:35008
    v_mfma_f32_16x16x32_bf16 v[148:151], v[60:63], v[108:111], v[148:151]
    ds_read_b64_tr_b16 v[58:59], v5 offset:39616
    s_waitcnt lgkmcnt(14)
    v_mfma_f32_16x16x32_bf16 v[152:155], v[64:67], v[104:107], v[152:155]
    ds_read_b64_tr_b16 v[60:61], v5 offset:44224
    v_mfma_f32_16x16x32_bf16 v[156:159], v[64:67], v[108:111], v[156:159]
    ds_read_b64_tr_b16 v[62:63], v5 offset:48832
    s_waitcnt lgkmcnt(14)
    v_mfma_f32_16x16x32_bf16 v[160:163], v[68:71], v[104:107], v[160:163]
    ds_read_b64_tr_b16 v[64:65], v5 offset:35040
    v_mfma_f32_16x16x32_bf16 v[164:167], v[68:71], v[108:111], v[164:167]
    ds_read_b64_tr_b16 v[66:67], v5 offset:39648
    s_waitcnt lgkmcnt(14)
    v_mfma_f32_16x16x32_bf16 v[168:171], v[72:75], v[104:107], v[168:171]
    ds_read_b64_tr_b16 v[68:69], v5 offset:44256
    v_mfma_f32_16x16x32_bf16 v[172:175], v[72:75], v[108:111], v[172:175]
    ds_read_b64_tr_b16 v[70:71], v5 offset:48864
    s_waitcnt lgkmcnt(14)
    v_mfma_f32_16x16x32_bf16 v[176:179], v[76:79], v[104:107], v[176:179]
    ds_read_b64_tr_b16 v[72:73], v7 offset:34816
    v_mfma_f32_16x16x32_bf16 v[180:183], v[76:79], v[108:111], v[180:183]
    ds_read_b64_tr_b16 v[74:75], v7 offset:39424
    s_waitcnt lgkmcnt(14)
    v_mfma_f32_16x16x32_bf16 v[184:187], v[44:47], v[104:107], v[184:187]
    ds_read_b64_tr_b16 v[76:77], v7 offset:44032
    v_mfma_f32_16x16x32_bf16 v[188:191], v[44:47], v[108:111], v[188:191]
    ds_read_b64_tr_b16 v[78:79], v7 offset:48640
    s_waitcnt lgkmcnt(0)
    s_waitcnt vmcnt(0)
    s_barrier
    v_mfma_f32_16x16x32_bf16 v[192:195], v[48:51], v[104:107], v[192:195]
    ds_read_b64_tr_b16 v[44:45], v4 offset:0
    v_mfma_f32_16x16x32_bf16 v[196:199], v[48:51], v[108:111], v[196:199]
    ds_read_b64_tr_b16 v[46:47], v4 offset:4608
    ds_read_b64_tr_b16 v[96:97], v8 offset:0
    v_mfma_f32_16x16x32_bf16 v[200:203], v[52:55], v[104:107], v[200:203]
    ds_read_b64_tr_b16 v[48:49], v4 offset:9216
    v_mfma_f32_16x16x32_bf16 v[204:207], v[52:55], v[108:111], v[204:207]
    ds_read_b64_tr_b16 v[50:51], v4 offset:13824
    ds_read_b64_tr_b16 v[98:99], v8 offset:8192
    s_add_u32 m0, s64, 69632
    s_mov_b32 s69, 2949120
    buffer_load_dwordx4 v16, s[44:47], s69 offen lds
    v_mfma_f32_16x16x32_bf16 v[208:211], v[56:59], v[104:107], v[208:211]
    ds_read_b64_tr_b16 v[52:53], v4 offset:32
    v_mfma_f32_16x16x32_bf16 v[212:215], v[56:59], v[108:111], v[212:215]
    ds_read_b64_tr_b16 v[54:55], v4 offset:4640
    ds_read_b64_tr_b16 v[100:101], v9 offset:0
    v_mfma_f32_16x16x32_bf16 v[216:219], v[60:63], v[104:107], v[216:219]
    ds_read_b64_tr_b16 v[56:57], v4 offset:9248
    v_mfma_f32_16x16x32_bf16 v[220:223], v[60:63], v[108:111], v[220:223]
    ds_read_b64_tr_b16 v[58:59], v4 offset:13856
    ds_read_b64_tr_b16 v[102:103], v9 offset:8192
    s_add_u32 m0, s65, 69632
    s_mov_b32 s69, 2949120
    buffer_load_dwordx4 v17, s[44:47], s69 offen lds
    v_mfma_f32_16x16x32_bf16 v[224:227], v[64:67], v[104:107], v[224:227]
    ds_read_b64_tr_b16 v[60:61], v4 offset:64
    v_mfma_f32_16x16x32_bf16 v[228:231], v[64:67], v[108:111], v[228:231]
    ds_read_b64_tr_b16 v[62:63], v4 offset:4672
    v_mfma_f32_16x16x32_bf16 v[232:235], v[68:71], v[104:107], v[232:235]
    ds_read_b64_tr_b16 v[64:65], v4 offset:9280
    v_mfma_f32_16x16x32_bf16 v[236:239], v[68:71], v[108:111], v[236:239]
    ds_read_b64_tr_b16 v[66:67], v4 offset:13888
    s_add_u32 m0, s66, 69632
    s_mov_b32 s69, 2949120
    buffer_load_dwordx4 v18, s[44:47], s69 offen lds
    v_mfma_f32_16x16x32_bf16 v[240:243], v[72:75], v[104:107], v[240:243]
    ds_read_b64_tr_b16 v[68:69], v4 offset:96
    v_mfma_f32_16x16x32_bf16 v[244:247], v[72:75], v[108:111], v[244:247]
    ds_read_b64_tr_b16 v[70:71], v4 offset:4704
    v_mfma_f32_16x16x32_bf16 v[248:251], v[76:79], v[104:107], v[248:251]
    ds_read_b64_tr_b16 v[72:73], v4 offset:9312
    v_mfma_f32_16x16x32_bf16 v[252:255], v[76:79], v[108:111], v[252:255]
    ds_read_b64_tr_b16 v[74:75], v4 offset:13920
    s_add_u32 m0, s67, 69632
    s_mov_b32 s69, 2949120
    buffer_load_dwordx4 v19, s[44:47], s69 offen lds
    s_waitcnt lgkmcnt(8)
    v_mfma_f32_16x16x32_bf16 v[112:115], v[44:47], v[96:99], v[112:115]
    ds_read_b64_tr_b16 v[76:77], v4 offset:128
    v_mfma_f32_16x16x32_bf16 v[116:119], v[44:47], v[100:103], v[116:119]
    ds_read_b64_tr_b16 v[78:79], v4 offset:4736
    v_mfma_f32_16x16x32_bf16 v[120:123], v[48:51], v[96:99], v[120:123]
    ds_read_b64_tr_b16 v[44:45], v4 offset:9344
    v_mfma_f32_16x16x32_bf16 v[124:127], v[48:51], v[100:103], v[124:127]
    ds_read_b64_tr_b16 v[46:47], v4 offset:13952
    s_add_u32 m0, s68, 69632
    s_mov_b32 exec_hi, 0
    buffer_load_dwordx4 v20, s[44:47], s69 offen lds
    s_mov_b32 exec_hi, -1
    v_mfma_f32_16x16x32_bf16 v[128:131], v[52:55], v[96:99], v[128:131]
    ds_read_b64_tr_b16 v[48:49], v4 offset:160
    v_mfma_f32_16x16x32_bf16 v[132:135], v[52:55], v[100:103], v[132:135]
    ds_read_b64_tr_b16 v[50:51], v4 offset:4768
    v_mfma_f32_16x16x32_bf16 v[136:139], v[56:59], v[96:99], v[136:139]
    ds_read_b64_tr_b16 v[52:53], v4 offset:9376
    v_mfma_f32_16x16x32_bf16 v[140:143], v[56:59], v[100:103], v[140:143]
    ds_read_b64_tr_b16 v[54:55], v4 offset:13984
    s_add_u32 m0, s70, 88064
    s_mov_b32 s71, 1310720
    buffer_load_dwordx4 v21, s[52:55], s71 offen sc1 lds
    s_waitcnt lgkmcnt(14)
    v_mfma_f32_16x16x32_bf16 v[144:147], v[60:63], v[96:99], v[144:147]
    ds_read_b64_tr_b16 v[56:57], v4 offset:192
    v_mfma_f32_16x16x32_bf16 v[148:151], v[60:63], v[100:103], v[148:151]
    ds_read_b64_tr_b16 v[58:59], v4 offset:4800
    ds_read_b64_tr_b16 v[104:105], v8 offset:34816
    s_waitcnt lgkmcnt(15)
    v_mfma_f32_16x16x32_bf16 v[152:155], v[64:67], v[96:99], v[152:155]
    ds_read_b64_tr_b16 v[60:61], v4 offset:9408
    v_mfma_f32_16x16x32_bf16 v[156:159], v[64:67], v[100:103], v[156:159]
    ds_read_b64_tr_b16 v[62:63], v4 offset:14016
    ds_read_b64_tr_b16 v[106:107], v8 offset:43008
    s_add_u32 m0, s70, 96256
    s_mov_b32 s71, 1376256
    buffer_load_dwordx4 v21, s[52:55], s71 offen sc1 lds
    s_waitcnt lgkmcnt(15)
    v_mfma_f32_16x16x32_bf16 v[160:163], v[68:71], v[96:99], v[160:163]
    ds_read_b64_tr_b16 v[64:65], v4 offset:224
    v_mfma_f32_16x16x32_bf16 v[164:167], v[68:71], v[100:103], v[164:167]
    ds_read_b64_tr_b16 v[66:67], v4 offset:4832
    ds_read_b64_tr_b16 v[108:109], v9 offset:34816
    s_waitcnt lgkmcnt(15)
    v_mfma_f32_16x16x32_bf16 v[168:171], v[72:75], v[96:99], v[168:171]
    ds_read_b64_tr_b16 v[68:69], v4 offset:9440
    v_mfma_f32_16x16x32_bf16 v[172:175], v[72:75], v[100:103], v[172:175]
    ds_read_b64_tr_b16 v[70:71], v4 offset:14048
    ds_read_b64_tr_b16 v[110:111], v9 offset:43008
    s_add_u32 m0, s70, 122880
    s_mov_b32 s71, 1441792
    buffer_load_dwordx4 v21, s[52:55], s71 offen sc1 lds
    v_mfma_f32_16x16x32_bf16 v[176:179], v[76:79], v[96:99], v[176:179]
    ds_read_b64_tr_b16 v[72:73], v6 offset:0
    v_mfma_f32_16x16x32_bf16 v[180:183], v[76:79], v[100:103], v[180:183]
    ds_read_b64_tr_b16 v[74:75], v6 offset:4608
    s_waitcnt lgkmcnt(15)
    v_mfma_f32_16x16x32_bf16 v[184:187], v[44:47], v[96:99], v[184:187]
    ds_read_b64_tr_b16 v[76:77], v6 offset:9216
    v_mfma_f32_16x16x32_bf16 v[188:191], v[44:47], v[100:103], v[188:191]
    ds_read_b64_tr_b16 v[78:79], v6 offset:13824
    s_add_u32 m0, s70, 131072
    s_mov_b32 s71, 1507328
    buffer_load_dwordx4 v21, s[52:55], s71 offen sc1 lds
    v_mfma_f32_16x16x32_bf16 v[192:195], v[48:51], v[96:99], v[192:195]
    ds_read_b64_tr_b16 v[44:45], v4 offset:34816
    v_mfma_f32_16x16x32_bf16 v[196:199], v[48:51], v[100:103], v[196:199]
    ds_read_b64_tr_b16 v[46:47], v4 offset:39424
    s_waitcnt lgkmcnt(15)
    v_mfma_f32_16x16x32_bf16 v[200:203], v[52:55], v[96:99], v[200:203]
    ds_read_b64_tr_b16 v[48:49], v4 offset:44032
    v_mfma_f32_16x16x32_bf16 v[204:207], v[52:55], v[100:103], v[204:207]
    ds_read_b64_tr_b16 v[50:51], v4 offset:48640
    v_mfma_f32_16x16x32_bf16 v[208:211], v[56:59], v[96:99], v[208:211]
    ds_read_b64_tr_b16 v[52:53], v4 offset:34848
    v_mfma_f32_16x16x32_bf16 v[212:215], v[56:59], v[100:103], v[212:215]
    ds_read_b64_tr_b16 v[54:55], v4 offset:39456
    s_waitcnt lgkmcnt(15)
    v_mfma_f32_16x16x32_bf16 v[216:219], v[60:63], v[96:99], v[216:219]
    ds_read_b64_tr_b16 v[56:57], v4 offset:44064
    v_mfma_f32_16x16x32_bf16 v[220:223], v[60:63], v[100:103], v[220:223]
    ds_read_b64_tr_b16 v[58:59], v4 offset:48672
    s_waitcnt lgkmcnt(15)
    v_mfma_f32_16x16x32_bf16 v[224:227], v[64:67], v[96:99], v[224:227]
    ds_read_b64_tr_b16 v[60:61], v4 offset:34880
    v_mfma_f32_16x16x32_bf16 v[228:231], v[64:67], v[100:103], v[228:231]
    ds_read_b64_tr_b16 v[62:63], v4 offset:39488
    s_waitcnt lgkmcnt(15)
    v_mfma_f32_16x16x32_bf16 v[232:235], v[68:71], v[96:99], v[232:235]
    ds_read_b64_tr_b16 v[64:65], v4 offset:44096
    v_mfma_f32_16x16x32_bf16 v[236:239], v[68:71], v[100:103], v[236:239]
    ds_read_b64_tr_b16 v[66:67], v4 offset:48704
    s_waitcnt lgkmcnt(14)
    v_mfma_f32_16x16x32_bf16 v[240:243], v[72:75], v[96:99], v[240:243]
    ds_read_b64_tr_b16 v[68:69], v4 offset:34912
    v_mfma_f32_16x16x32_bf16 v[244:247], v[72:75], v[100:103], v[244:247]
    ds_read_b64_tr_b16 v[70:71], v4 offset:39520
    s_waitcnt lgkmcnt(14)
    v_mfma_f32_16x16x32_bf16 v[248:251], v[76:79], v[96:99], v[248:251]
    ds_read_b64_tr_b16 v[72:73], v4 offset:44128
    v_mfma_f32_16x16x32_bf16 v[252:255], v[76:79], v[100:103], v[252:255]
    ds_read_b64_tr_b16 v[74:75], v4 offset:48736
    s_cmp_eq_u32 s3, 7
    s_cbranch_scc0 sequential_preLN__ssm_conv_s4d__glu_gated_reglu__prompt_kernel_ma23
    s_lshl_b32 s12, s6, 7
    s_add_u32 s12, s12, 16384
    s_mov_b64 exec, 1
    v_mov_b32 v24, s12
    v_mov_b32 v25, 1
    global_atomic_add v24, v25, s[42:43] sc1
    s_mov_b64 exec, -1
sequential_preLN__ssm_conv_s4d__glu_gated_reglu__prompt_kernel_ma23:
    s_waitcnt lgkmcnt(14)
    v_mfma_f32_16x16x32_bf16 v[112:115], v[44:47], v[104:107], v[112:115]
    ds_read_b64_tr_b16 v[76:77], v4 offset:34944
    v_mfma_f32_16x16x32_bf16 v[116:119], v[44:47], v[108:111], v[116:119]
    ds_read_b64_tr_b16 v[78:79], v4 offset:39552
    s_waitcnt lgkmcnt(14)
    v_mfma_f32_16x16x32_bf16 v[120:123], v[48:51], v[104:107], v[120:123]
    ds_read_b64_tr_b16 v[44:45], v4 offset:44160
    v_mfma_f32_16x16x32_bf16 v[124:127], v[48:51], v[108:111], v[124:127]
    ds_read_b64_tr_b16 v[46:47], v4 offset:48768
    s_waitcnt lgkmcnt(14)
    v_mfma_f32_16x16x32_bf16 v[128:131], v[52:55], v[104:107], v[128:131]
    ds_read_b64_tr_b16 v[48:49], v4 offset:34976
    v_mfma_f32_16x16x32_bf16 v[132:135], v[52:55], v[108:111], v[132:135]
    ds_read_b64_tr_b16 v[50:51], v4 offset:39584
    s_waitcnt lgkmcnt(14)
    v_mfma_f32_16x16x32_bf16 v[136:139], v[56:59], v[104:107], v[136:139]
    ds_read_b64_tr_b16 v[52:53], v4 offset:44192
    v_mfma_f32_16x16x32_bf16 v[140:143], v[56:59], v[108:111], v[140:143]
    ds_read_b64_tr_b16 v[54:55], v4 offset:48800
    s_waitcnt lgkmcnt(14)
    v_mfma_f32_16x16x32_bf16 v[144:147], v[60:63], v[104:107], v[144:147]
    ds_read_b64_tr_b16 v[56:57], v4 offset:35008
    v_mfma_f32_16x16x32_bf16 v[148:151], v[60:63], v[108:111], v[148:151]
    ds_read_b64_tr_b16 v[58:59], v4 offset:39616
    s_waitcnt lgkmcnt(14)
    v_mfma_f32_16x16x32_bf16 v[152:155], v[64:67], v[104:107], v[152:155]
    ds_read_b64_tr_b16 v[60:61], v4 offset:44224
    v_mfma_f32_16x16x32_bf16 v[156:159], v[64:67], v[108:111], v[156:159]
    ds_read_b64_tr_b16 v[62:63], v4 offset:48832
    s_waitcnt lgkmcnt(14)
    v_mfma_f32_16x16x32_bf16 v[160:163], v[68:71], v[104:107], v[160:163]
    ds_read_b64_tr_b16 v[64:65], v4 offset:35040
    v_mfma_f32_16x16x32_bf16 v[164:167], v[68:71], v[108:111], v[164:167]
    ds_read_b64_tr_b16 v[66:67], v4 offset:39648
    s_waitcnt lgkmcnt(14)
    v_mfma_f32_16x16x32_bf16 v[168:171], v[72:75], v[104:107], v[168:171]
    ds_read_b64_tr_b16 v[68:69], v4 offset:44256
    v_mfma_f32_16x16x32_bf16 v[172:175], v[72:75], v[108:111], v[172:175]
    ds_read_b64_tr_b16 v[70:71], v4 offset:48864
    s_waitcnt lgkmcnt(14)
    v_mfma_f32_16x16x32_bf16 v[176:179], v[76:79], v[104:107], v[176:179]
    ds_read_b64_tr_b16 v[72:73], v6 offset:34816
    v_mfma_f32_16x16x32_bf16 v[180:183], v[76:79], v[108:111], v[180:183]
    ds_read_b64_tr_b16 v[74:75], v6 offset:39424
    s_waitcnt lgkmcnt(14)
    v_mfma_f32_16x16x32_bf16 v[184:187], v[44:47], v[104:107], v[184:187]
    ds_read_b64_tr_b16 v[76:77], v6 offset:44032
    v_mfma_f32_16x16x32_bf16 v[188:191], v[44:47], v[108:111], v[188:191]
    ds_read_b64_tr_b16 v[78:79], v6 offset:48640
    s_waitcnt lgkmcnt(0)
    s_waitcnt vmcnt(0)
    s_barrier
    v_mfma_f32_16x16x32_bf16 v[192:195], v[48:51], v[104:107], v[192:195]
    ds_read_b64_tr_b16 v[44:45], v5 offset:0
    v_mfma_f32_16x16x32_bf16 v[196:199], v[48:51], v[108:111], v[196:199]
    ds_read_b64_tr_b16 v[46:47], v5 offset:4608
    ds_read_b64_tr_b16 v[96:97], v10 offset:0
    v_mfma_f32_16x16x32_bf16 v[200:203], v[52:55], v[104:107], v[200:203]
    ds_read_b64_tr_b16 v[48:49], v5 offset:9216
    v_mfma_f32_16x16x32_bf16 v[204:207], v[52:55], v[108:111], v[204:207]
    ds_read_b64_tr_b16 v[50:51], v5 offset:13824
    ds_read_b64_tr_b16 v[98:99], v10 offset:8192
    s_add_u32 m0, s64, 0
    s_mov_b32 s69, 3538944
    buffer_load_dwordx4 v16, s[44:47], s69 offen lds
    v_mfma_f32_16x16x32_bf16 v[208:211], v[56:59], v[104:107], v[208:211]
    ds_read_b64_tr_b16 v[52:53], v5 offset:32
    v_mfma_f32_16x16x32_bf16 v[212:215], v[56:59], v[108:111], v[212:215]
    ds_read_b64_tr_b16 v[54:55], v5 offset:4640
    ds_read_b64_tr_b16 v[100:101], v11 offset:0
    v_mfma_f32_16x16x32_bf16 v[216:219], v[60:63], v[104:107], v[216:219]
    ds_read_b64_tr_b16 v[56:57], v5 offset:9248
    v_mfma_f32_16x16x32_bf16 v[220:223], v[60:63], v[108:111], v[220:223]
    ds_read_b64_tr_b16 v[58:59], v5 offset:13856
    ds_read_b64_tr_b16 v[102:103], v11 offset:8192
    s_add_u32 m0, s65, 0
    s_mov_b32 s69, 3538944
    buffer_load_dwordx4 v17, s[44:47], s69 offen lds
    v_mfma_f32_16x16x32_bf16 v[224:227], v[64:67], v[104:107], v[224:227]
    ds_read_b64_tr_b16 v[60:61], v5 offset:64
    v_mfma_f32_16x16x32_bf16 v[228:231], v[64:67], v[108:111], v[228:231]
    ds_read_b64_tr_b16 v[62:63], v5 offset:4672
    v_mfma_f32_16x16x32_bf16 v[232:235], v[68:71], v[104:107], v[232:235]
    ds_read_b64_tr_b16 v[64:65], v5 offset:9280
    v_mfma_f32_16x16x32_bf16 v[236:239], v[68:71], v[108:111], v[236:239]
    ds_read_b64_tr_b16 v[66:67], v5 offset:13888
    s_add_u32 m0, s66, 0
    s_mov_b32 s69, 3538944
    buffer_load_dwordx4 v18, s[44:47], s69 offen lds
    v_mfma_f32_16x16x32_bf16 v[240:243], v[72:75], v[104:107], v[240:243]
    ds_read_b64_tr_b16 v[68:69], v5 offset:96
    v_mfma_f32_16x16x32_bf16 v[244:247], v[72:75], v[108:111], v[244:247]
    ds_read_b64_tr_b16 v[70:71], v5 offset:4704
    v_mfma_f32_16x16x32_bf16 v[248:251], v[76:79], v[104:107], v[248:251]
    ds_read_b64_tr_b16 v[72:73], v5 offset:9312
    v_mfma_f32_16x16x32_bf16 v[252:255], v[76:79], v[108:111], v[252:255]
    ds_read_b64_tr_b16 v[74:75], v5 offset:13920
    s_add_u32 m0, s67, 0
    s_mov_b32 s69, 3538944
    buffer_load_dwordx4 v19, s[44:47], s69 offen lds
    s_waitcnt lgkmcnt(8)
    v_mfma_f32_16x16x32_bf16 v[112:115], v[44:47], v[96:99], v[112:115]
    ds_read_b64_tr_b16 v[76:77], v5 offset:128
    v_mfma_f32_16x16x32_bf16 v[116:119], v[44:47], v[100:103], v[116:119]
    ds_read_b64_tr_b16 v[78:79], v5 offset:4736
    v_mfma_f32_16x16x32_bf16 v[120:123], v[48:51], v[96:99], v[120:123]
    ds_read_b64_tr_b16 v[44:45], v5 offset:9344
    v_mfma_f32_16x16x32_bf16 v[124:127], v[48:51], v[100:103], v[124:127]
    ds_read_b64_tr_b16 v[46:47], v5 offset:13952
    s_add_u32 m0, s68, 0
    s_mov_b32 exec_hi, 0
    buffer_load_dwordx4 v20, s[44:47], s69 offen lds
    s_mov_b32 exec_hi, -1
    v_mfma_f32_16x16x32_bf16 v[128:131], v[52:55], v[96:99], v[128:131]
    ds_read_b64_tr_b16 v[48:49], v5 offset:160
    v_mfma_f32_16x16x32_bf16 v[132:135], v[52:55], v[100:103], v[132:135]
    ds_read_b64_tr_b16 v[50:51], v5 offset:4768
    v_mfma_f32_16x16x32_bf16 v[136:139], v[56:59], v[96:99], v[136:139]
    ds_read_b64_tr_b16 v[52:53], v5 offset:9376
    v_mfma_f32_16x16x32_bf16 v[140:143], v[56:59], v[100:103], v[140:143]
    ds_read_b64_tr_b16 v[54:55], v5 offset:13984
    s_add_u32 m0, s70, 18432
    s_mov_b32 s71, 1572864
    buffer_load_dwordx4 v21, s[52:55], s71 offen sc1 lds
    s_waitcnt lgkmcnt(14)
    v_mfma_f32_16x16x32_bf16 v[144:147], v[60:63], v[96:99], v[144:147]
    ds_read_b64_tr_b16 v[56:57], v5 offset:192
    v_mfma_f32_16x16x32_bf16 v[148:151], v[60:63], v[100:103], v[148:151]
    ds_read_b64_tr_b16 v[58:59], v5 offset:4800
    ds_read_b64_tr_b16 v[104:105], v10 offset:34816
    s_waitcnt lgkmcnt(15)
    v_mfma_f32_16x16x32_bf16 v[152:155], v[64:67], v[96:99], v[152:155]
    ds_read_b64_tr_b16 v[60:61], v5 offset:9408
    v_mfma_f32_16x16x32_bf16 v[156:159], v[64:67], v[100:103], v[156:159]
    ds_read_b64_tr_b16 v[62:63], v5 offset:14016
    ds_read_b64_tr_b16 v[106:107], v10 offset:43008
    s_add_u32 m0, s70, 26624
    s_mov_b32 s71, 1638400
    buffer_load_dwordx4 v21, s[52:55], s71 offen sc1 lds
    s_waitcnt lgkmcnt(15)
    v_mfma_f32_16x16x32_bf16 v[160:163], v[68:71], v[96:99], v[160:163]
    ds_read_b64_tr_b16 v[64:65], v5 offset:224
    v_mfma_f32_16x16x32_bf16 v[164:167], v[68:71], v[100:103], v[164:167]
    ds_read_b64_tr_b16 v[66:67], v5 offset:4832
    ds_read_b64_tr_b16 v[108:109], v11 offset:34816
    s_waitcnt lgkmcnt(15)
    v_mfma_f32_16x16x32_bf16 v[168:171], v[72:75], v[96:99], v[168:171]
    ds_read_b64_tr_b16 v[68:69], v5 offset:9440
    v_mfma_f32_16x16x32_bf16 v[172:175], v[72:75], v[100:103], v[172:175]
    ds_read_b64_tr_b16 v[70:71], v5 offset:14048
    ds_read_b64_tr_b16 v[110:111], v11 offset:43008
    s_add_u32 m0, s70, 53248
    s_mov_b32 s71, 1703936
    buffer_load_dwordx4 v21, s[52:55], s71 offen sc1 lds
    v_mfma_f32_16x16x32_bf16 v[176:179], v[76:79], v[96:99], v[176:179]
    ds_read_b64_tr_b16 v[72:73], v7 offset:0
    v_mfma_f32_16x16x32_bf16 v[180:183], v[76:79], v[100:103], v[180:183]
    ds_read_b64_tr_b16 v[74:75], v7 offset:4608
    s_waitcnt lgkmcnt(15)
    v_mfma_f32_16x16x32_bf16 v[184:187], v[44:47], v[96:99], v[184:187]
    ds_read_b64_tr_b16 v[76:77], v7 offset:9216
    v_mfma_f32_16x16x32_bf16 v[188:191], v[44:47], v[100:103], v[188:191]
    ds_read_b64_tr_b16 v[78:79], v7 offset:13824
    s_add_u32 m0, s70, 61440
    s_mov_b32 s71, 1769472
    buffer_load_dwordx4 v21, s[52:55], s71 offen sc1 lds
    v_mfma_f32_16x16x32_bf16 v[192:195], v[48:51], v[96:99], v[192:195]
    ds_read_b64_tr_b16 v[44:45], v5 offset:34816
    v_mfma_f32_16x16x32_bf16 v[196:199], v[48:51], v[100:103], v[196:199]
    ds_read_b64_tr_b16 v[46:47], v5 offset:39424
    s_waitcnt lgkmcnt(15)
    v_mfma_f32_16x16x32_bf16 v[200:203], v[52:55], v[96:99], v[200:203]
    ds_read_b64_tr_b16 v[48:49], v5 offset:44032
    v_mfma_f32_16x16x32_bf16 v[204:207], v[52:55], v[100:103], v[204:207]
    ds_read_b64_tr_b16 v[50:51], v5 offset:48640
    v_mfma_f32_16x16x32_bf16 v[208:211], v[56:59], v[96:99], v[208:211]
    ds_read_b64_tr_b16 v[52:53], v5 offset:34848
    v_mfma_f32_16x16x32_bf16 v[212:215], v[56:59], v[100:103], v[212:215]
    ds_read_b64_tr_b16 v[54:55], v5 offset:39456
    s_waitcnt lgkmcnt(15)
    v_mfma_f32_16x16x32_bf16 v[216:219], v[60:63], v[96:99], v[216:219]
    ds_read_b64_tr_b16 v[56:57], v5 offset:44064
    v_mfma_f32_16x16x32_bf16 v[220:223], v[60:63], v[100:103], v[220:223]
    ds_read_b64_tr_b16 v[58:59], v5 offset:48672
    s_waitcnt lgkmcnt(15)
    v_mfma_f32_16x16x32_bf16 v[224:227], v[64:67], v[96:99], v[224:227]
    ds_read_b64_tr_b16 v[60:61], v5 offset:34880
    v_mfma_f32_16x16x32_bf16 v[228:231], v[64:67], v[100:103], v[228:231]
    ds_read_b64_tr_b16 v[62:63], v5 offset:39488
    s_waitcnt lgkmcnt(15)
    v_mfma_f32_16x16x32_bf16 v[232:235], v[68:71], v[96:99], v[232:235]
    ds_read_b64_tr_b16 v[64:65], v5 offset:44096
    v_mfma_f32_16x16x32_bf16 v[236:239], v[68:71], v[100:103], v[236:239]
    ds_read_b64_tr_b16 v[66:67], v5 offset:48704
    s_waitcnt lgkmcnt(14)
    v_mfma_f32_16x16x32_bf16 v[240:243], v[72:75], v[96:99], v[240:243]
    ds_read_b64_tr_b16 v[68:69], v5 offset:34912
    v_mfma_f32_16x16x32_bf16 v[244:247], v[72:75], v[100:103], v[244:247]
    ds_read_b64_tr_b16 v[70:71], v5 offset:39520
    s_waitcnt lgkmcnt(14)
    v_mfma_f32_16x16x32_bf16 v[248:251], v[76:79], v[96:99], v[248:251]
    ds_read_b64_tr_b16 v[72:73], v5 offset:44128
    v_mfma_f32_16x16x32_bf16 v[252:255], v[76:79], v[100:103], v[252:255]
    ds_read_b64_tr_b16 v[74:75], v5 offset:48736
    s_waitcnt lgkmcnt(14)
    v_mfma_f32_16x16x32_bf16 v[112:115], v[44:47], v[104:107], v[112:115]
    ds_read_b64_tr_b16 v[76:77], v5 offset:34944
    v_mfma_f32_16x16x32_bf16 v[116:119], v[44:47], v[108:111], v[116:119]
    ds_read_b64_tr_b16 v[78:79], v5 offset:39552
    s_waitcnt lgkmcnt(14)
    v_mfma_f32_16x16x32_bf16 v[120:123], v[48:51], v[104:107], v[120:123]
    ds_read_b64_tr_b16 v[44:45], v5 offset:44160
    v_mfma_f32_16x16x32_bf16 v[124:127], v[48:51], v[108:111], v[124:127]
    ds_read_b64_tr_b16 v[46:47], v5 offset:48768
    s_waitcnt lgkmcnt(14)
    v_mfma_f32_16x16x32_bf16 v[128:131], v[52:55], v[104:107], v[128:131]
    ds_read_b64_tr_b16 v[48:49], v5 offset:34976
    v_mfma_f32_16x16x32_bf16 v[132:135], v[52:55], v[108:111], v[132:135]
    ds_read_b64_tr_b16 v[50:51], v5 offset:39584
    s_waitcnt lgkmcnt(14)
    v_mfma_f32_16x16x32_bf16 v[136:139], v[56:59], v[104:107], v[136:139]
    ds_read_b64_tr_b16 v[52:53], v5 offset:44192
    v_mfma_f32_16x16x32_bf16 v[140:143], v[56:59], v[108:111], v[140:143]
    ds_read_b64_tr_b16 v[54:55], v5 offset:48800
    s_waitcnt lgkmcnt(14)
    v_mfma_f32_16x16x32_bf16 v[144:147], v[60:63], v[104:107], v[144:147]
    ds_read_b64_tr_b16 v[56:57], v5 offset:35008
    v_mfma_f32_16x16x32_bf16 v[148:151], v[60:63], v[108:111], v[148:151]
    ds_read_b64_tr_b16 v[58:59], v5 offset:39616
    s_waitcnt lgkmcnt(14)
    v_mfma_f32_16x16x32_bf16 v[152:155], v[64:67], v[104:107], v[152:155]
    ds_read_b64_tr_b16 v[60:61], v5 offset:44224
    v_mfma_f32_16x16x32_bf16 v[156:159], v[64:67], v[108:111], v[156:159]
    ds_read_b64_tr_b16 v[62:63], v5 offset:48832
    s_waitcnt lgkmcnt(14)
    v_mfma_f32_16x16x32_bf16 v[160:163], v[68:71], v[104:107], v[160:163]
    ds_read_b64_tr_b16 v[64:65], v5 offset:35040
    v_mfma_f32_16x16x32_bf16 v[164:167], v[68:71], v[108:111], v[164:167]
    ds_read_b64_tr_b16 v[66:67], v5 offset:39648
    s_waitcnt lgkmcnt(14)
    v_mfma_f32_16x16x32_bf16 v[168:171], v[72:75], v[104:107], v[168:171]
    ds_read_b64_tr_b16 v[68:69], v5 offset:44256
    v_mfma_f32_16x16x32_bf16 v[172:175], v[72:75], v[108:111], v[172:175]
    ds_read_b64_tr_b16 v[70:71], v5 offset:48864
    s_waitcnt lgkmcnt(14)
    v_mfma_f32_16x16x32_bf16 v[176:179], v[76:79], v[104:107], v[176:179]
    ds_read_b64_tr_b16 v[72:73], v7 offset:34816
    v_mfma_f32_16x16x32_bf16 v[180:183], v[76:79], v[108:111], v[180:183]
    ds_read_b64_tr_b16 v[74:75], v7 offset:39424
    s_waitcnt lgkmcnt(14)
    v_mfma_f32_16x16x32_bf16 v[184:187], v[44:47], v[104:107], v[184:187]
    ds_read_b64_tr_b16 v[76:77], v7 offset:44032
    v_mfma_f32_16x16x32_bf16 v[188:191], v[44:47], v[108:111], v[188:191]
    ds_read_b64_tr_b16 v[78:79], v7 offset:48640
    s_waitcnt lgkmcnt(0)
    s_waitcnt vmcnt(0)
    s_barrier
    v_mfma_f32_16x16x32_bf16 v[192:195], v[48:51], v[104:107], v[192:195]
    ds_read_b64_tr_b16 v[44:45], v4 offset:0
    v_mfma_f32_16x16x32_bf16 v[196:199], v[48:51], v[108:111], v[196:199]
    ds_read_b64_tr_b16 v[46:47], v4 offset:4608
    ds_read_b64_tr_b16 v[96:97], v8 offset:0
    v_mfma_f32_16x16x32_bf16 v[200:203], v[52:55], v[104:107], v[200:203]
    ds_read_b64_tr_b16 v[48:49], v4 offset:9216
    v_mfma_f32_16x16x32_bf16 v[204:207], v[52:55], v[108:111], v[204:207]
    ds_read_b64_tr_b16 v[50:51], v4 offset:13824
    ds_read_b64_tr_b16 v[98:99], v8 offset:8192
    s_add_u32 m0, s64, 69632
    s_mov_b32 s69, 4128768
    buffer_load_dwordx4 v16, s[44:47], s69 offen lds
    v_mfma_f32_16x16x32_bf16 v[208:211], v[56:59], v[104:107], v[208:211]
    ds_read_b64_tr_b16 v[52:53], v4 offset:32
    v_mfma_f32_16x16x32_bf16 v[212:215], v[56:59], v[108:111], v[212:215]
    ds_read_b64_tr_b16 v[54:55], v4 offset:4640
    ds_read_b64_tr_b16 v[100:101], v9 offset:0
    v_mfma_f32_16x16x32_bf16 v[216:219], v[60:63], v[104:107], v[216:219]
    ds_read_b64_tr_b16 v[56:57], v4 offset:9248
    v_mfma_f32_16x16x32_bf16 v[220:223], v[60:63], v[108:111], v[220:223]
    ds_read_b64_tr_b16 v[58:59], v4 offset:13856
    ds_read_b64_tr_b16 v[102:103], v9 offset:8192
    s_add_u32 m0, s65, 69632
    s_mov_b32 s69, 4128768
    buffer_load_dwordx4 v17, s[44:47], s69 offen lds
    v_mfma_f32_16x16x32_bf16 v[224:227], v[64:67], v[104:107], v[224:227]
    ds_read_b64_tr_b16 v[60:61], v4 offset:64
    v_mfma_f32_16x16x32_bf16 v[228:231], v[64:67], v[108:111], v[228:231]
    ds_read_b64_tr_b16 v[62:63], v4 offset:4672
    v_mfma_f32_16x16x32_bf16 v[232:235], v[68:71], v[104:107], v[232:235]
    ds_read_b64_tr_b16 v[64:65], v4 offset:9280
    v_mfma_f32_16x16x32_bf16 v[236:239], v[68:71], v[108:111], v[236:239]
    ds_read_b64_tr_b16 v[66:67], v4 offset:13888
    s_add_u32 m0, s66, 69632
    s_mov_b32 s69, 4128768
    buffer_load_dwordx4 v18, s[44:47], s69 offen lds
    v_mfma_f32_16x16x32_bf16 v[240:243], v[72:75], v[104:107], v[240:243]
    ds_read_b64_tr_b16 v[68:69], v4 offset:96
    v_mfma_f32_16x16x32_bf16 v[244:247], v[72:75], v[108:111], v[244:247]
    ds_read_b64_tr_b16 v[70:71], v4 offset:4704
    v_mfma_f32_16x16x32_bf16 v[248:251], v[76:79], v[104:107], v[248:251]
    ds_read_b64_tr_b16 v[72:73], v4 offset:9312
    v_mfma_f32_16x16x32_bf16 v[252:255], v[76:79], v[108:111], v[252:255]
    ds_read_b64_tr_b16 v[74:75], v4 offset:13920
    s_add_u32 m0, s67, 69632
    s_mov_b32 s69, 4128768
    buffer_load_dwordx4 v19, s[44:47], s69 offen lds
    s_waitcnt lgkmcnt(8)
    v_mfma_f32_16x16x32_bf16 v[112:115], v[44:47], v[96:99], v[112:115]
    ds_read_b64_tr_b16 v[76:77], v4 offset:128
    v_mfma_f32_16x16x32_bf16 v[116:119], v[44:47], v[100:103], v[116:119]
    ds_read_b64_tr_b16 v[78:79], v4 offset:4736
    v_mfma_f32_16x16x32_bf16 v[120:123], v[48:51], v[96:99], v[120:123]
    ds_read_b64_tr_b16 v[44:45], v4 offset:9344
    v_mfma_f32_16x16x32_bf16 v[124:127], v[48:51], v[100:103], v[124:127]
    ds_read_b64_tr_b16 v[46:47], v4 offset:13952
    s_add_u32 m0, s68, 69632
    s_mov_b32 exec_hi, 0
    buffer_load_dwordx4 v20, s[44:47], s69 offen lds
    s_mov_b32 exec_hi, -1
    v_mfma_f32_16x16x32_bf16 v[128:131], v[52:55], v[96:99], v[128:131]
    ds_read_b64_tr_b16 v[48:49], v4 offset:160
    v_mfma_f32_16x16x32_bf16 v[132:135], v[52:55], v[100:103], v[132:135]
    ds_read_b64_tr_b16 v[50:51], v4 offset:4768
    v_mfma_f32_16x16x32_bf16 v[136:139], v[56:59], v[96:99], v[136:139]
    ds_read_b64_tr_b16 v[52:53], v4 offset:9376
    v_mfma_f32_16x16x32_bf16 v[140:143], v[56:59], v[100:103], v[140:143]
    ds_read_b64_tr_b16 v[54:55], v4 offset:13984
    s_add_u32 m0, s70, 88064
    s_mov_b32 s71, 1835008
    buffer_load_dwordx4 v21, s[52:55], s71 offen sc1 lds
    s_waitcnt lgkmcnt(14)
    v_mfma_f32_16x16x32_bf16 v[144:147], v[60:63], v[96:99], v[144:147]
    ds_read_b64_tr_b16 v[56:57], v4 offset:192
    v_mfma_f32_16x16x32_bf16 v[148:151], v[60:63], v[100:103], v[148:151]
    ds_read_b64_tr_b16 v[58:59], v4 offset:4800
    ds_read_b64_tr_b16 v[104:105], v8 offset:34816
    s_waitcnt lgkmcnt(15)
    v_mfma_f32_16x16x32_bf16 v[152:155], v[64:67], v[96:99], v[152:155]
    ds_read_b64_tr_b16 v[60:61], v4 offset:9408
    v_mfma_f32_16x16x32_bf16 v[156:159], v[64:67], v[100:103], v[156:159]
    ds_read_b64_tr_b16 v[62:63], v4 offset:14016
    ds_read_b64_tr_b16 v[106:107], v8 offset:43008
    s_add_u32 m0, s70, 96256
    s_mov_b32 s71, 1900544
    buffer_load_dwordx4 v21, s[52:55], s71 offen sc1 lds
    s_waitcnt lgkmcnt(15)
    v_mfma_f32_16x16x32_bf16 v[160:163], v[68:71], v[96:99], v[160:163]
    ds_read_b64_tr_b16 v[64:65], v4 offset:224
    v_mfma_f32_16x16x32_bf16 v[164:167], v[68:71], v[100:103], v[164:167]
    ds_read_b64_tr_b16 v[66:67], v4 offset:4832
    ds_read_b64_tr_b16 v[108:109], v9 offset:34816
    s_waitcnt lgkmcnt(15)
    v_mfma_f32_16x16x32_bf16 v[168:171], v[72:75], v[96:99], v[168:171]
    ds_read_b64_tr_b16 v[68:69], v4 offset:9440
    v_mfma_f32_16x16x32_bf16 v[172:175], v[72:75], v[100:103], v[172:175]
    ds_read_b64_tr_b16 v[70:71], v4 offset:14048
    ds_read_b64_tr_b16 v[110:111], v9 offset:43008
    s_add_u32 m0, s70, 122880
    s_mov_b32 s71, 1966080
    buffer_load_dwordx4 v21, s[52:55], s71 offen sc1 lds
    v_mfma_f32_16x16x32_bf16 v[176:179], v[76:79], v[96:99], v[176:179]
    ds_read_b64_tr_b16 v[72:73], v6 offset:0
    v_mfma_f32_16x16x32_bf16 v[180:183], v[76:79], v[100:103], v[180:183]
    ds_read_b64_tr_b16 v[74:75], v6 offset:4608
    s_waitcnt lgkmcnt(15)
    v_mfma_f32_16x16x32_bf16 v[184:187], v[44:47], v[96:99], v[184:187]
    ds_read_b64_tr_b16 v[76:77], v6 offset:9216
    v_mfma_f32_16x16x32_bf16 v[188:191], v[44:47], v[100:103], v[188:191]
    ds_read_b64_tr_b16 v[78:79], v6 offset:13824
    s_add_u32 m0, s70, 131072
    s_mov_b32 s71, 2031616
    buffer_load_dwordx4 v21, s[52:55], s71 offen sc1 lds
    v_mfma_f32_16x16x32_bf16 v[192:195], v[48:51], v[96:99], v[192:195]
    ds_read_b64_tr_b16 v[44:45], v4 offset:34816
    v_mfma_f32_16x16x32_bf16 v[196:199], v[48:51], v[100:103], v[196:199]
    ds_read_b64_tr_b16 v[46:47], v4 offset:39424
    s_waitcnt lgkmcnt(15)
    v_mfma_f32_16x16x32_bf16 v[200:203], v[52:55], v[96:99], v[200:203]
    ds_read_b64_tr_b16 v[48:49], v4 offset:44032
    v_mfma_f32_16x16x32_bf16 v[204:207], v[52:55], v[100:103], v[204:207]
    ds_read_b64_tr_b16 v[50:51], v4 offset:48640
    v_mfma_f32_16x16x32_bf16 v[208:211], v[56:59], v[96:99], v[208:211]
    ds_read_b64_tr_b16 v[52:53], v4 offset:34848
    v_mfma_f32_16x16x32_bf16 v[212:215], v[56:59], v[100:103], v[212:215]
    ds_read_b64_tr_b16 v[54:55], v4 offset:39456
    s_waitcnt lgkmcnt(15)
    v_mfma_f32_16x16x32_bf16 v[216:219], v[60:63], v[96:99], v[216:219]
    ds_read_b64_tr_b16 v[56:57], v4 offset:44064
    v_mfma_f32_16x16x32_bf16 v[220:223], v[60:63], v[100:103], v[220:223]
    ds_read_b64_tr_b16 v[58:59], v4 offset:48672
    s_waitcnt lgkmcnt(15)
    v_mfma_f32_16x16x32_bf16 v[224:227], v[64:67], v[96:99], v[224:227]
    ds_read_b64_tr_b16 v[60:61], v4 offset:34880
    v_mfma_f32_16x16x32_bf16 v[228:231], v[64:67], v[100:103], v[228:231]
    ds_read_b64_tr_b16 v[62:63], v4 offset:39488
    s_waitcnt lgkmcnt(15)
    v_mfma_f32_16x16x32_bf16 v[232:235], v[68:71], v[96:99], v[232:235]
    ds_read_b64_tr_b16 v[64:65], v4 offset:44096
    v_mfma_f32_16x16x32_bf16 v[236:239], v[68:71], v[100:103], v[236:239]
    ds_read_b64_tr_b16 v[66:67], v4 offset:48704
    s_waitcnt lgkmcnt(14)
    v_mfma_f32_16x16x32_bf16 v[240:243], v[72:75], v[96:99], v[240:243]
    ds_read_b64_tr_b16 v[68:69], v4 offset:34912
    v_mfma_f32_16x16x32_bf16 v[244:247], v[72:75], v[100:103], v[244:247]
    ds_read_b64_tr_b16 v[70:71], v4 offset:39520
    s_waitcnt lgkmcnt(14)
    v_mfma_f32_16x16x32_bf16 v[248:251], v[76:79], v[96:99], v[248:251]
    ds_read_b64_tr_b16 v[72:73], v4 offset:44128
    v_mfma_f32_16x16x32_bf16 v[252:255], v[76:79], v[100:103], v[252:255]
    ds_read_b64_tr_b16 v[74:75], v4 offset:48736
    s_lshl_b32 s12, s6, 7
    s_add_u32 s12, s12, 16384
    v_mov_b32 v24, s12
    global_load_dword v25, v24, s[42:43] sc1
    s_waitcnt lgkmcnt(14)
    v_mfma_f32_16x16x32_bf16 v[112:115], v[44:47], v[104:107], v[112:115]
    ds_read_b64_tr_b16 v[76:77], v4 offset:34944
    v_mfma_f32_16x16x32_bf16 v[116:119], v[44:47], v[108:111], v[116:119]
    ds_read_b64_tr_b16 v[78:79], v4 offset:39552
    s_waitcnt lgkmcnt(14)
    v_mfma_f32_16x16x32_bf16 v[120:123], v[48:51], v[104:107], v[120:123]
    ds_read_b64_tr_b16 v[44:45], v4 offset:44160
    v_mfma_f32_16x16x32_bf16 v[124:127], v[48:51], v[108:111], v[124:127]
    ds_read_b64_tr_b16 v[46:47], v4 offset:48768
    s_waitcnt lgkmcnt(14)
    v_mfma_f32_16x16x32_bf16 v[128:131], v[52:55], v[104:107], v[128:131]
    ds_read_b64_tr_b16 v[48:49], v4 offset:34976
    v_mfma_f32_16x16x32_bf16 v[132:135], v[52:55], v[108:111], v[132:135]
    ds_read_b64_tr_b16 v[50:51], v4 offset:39584
    s_waitcnt lgkmcnt(14)
    v_mfma_f32_16x16x32_bf16 v[136:139], v[56:59], v[104:107], v[136:139]
    ds_read_b64_tr_b16 v[52:53], v4 offset:44192
    v_mfma_f32_16x16x32_bf16 v[140:143], v[56:59], v[108:111], v[140:143]
    ds_read_b64_tr_b16 v[54:55], v4 offset:48800
    s_waitcnt lgkmcnt(14)
    v_mfma_f32_16x16x32_bf16 v[144:147], v[60:63], v[104:107], v[144:147]
    ds_read_b64_tr_b16 v[56:57], v4 offset:35008
    v_mfma_f32_16x16x32_bf16 v[148:151], v[60:63], v[108:111], v[148:151]
    ds_read_b64_tr_b16 v[58:59], v4 offset:39616
    s_waitcnt lgkmcnt(14)
    v_mfma_f32_16x16x32_bf16 v[152:155], v[64:67], v[104:107], v[152:155]
    ds_read_b64_tr_b16 v[60:61], v4 offset:44224
    v_mfma_f32_16x16x32_bf16 v[156:159], v[64:67], v[108:111], v[156:159]
    ds_read_b64_tr_b16 v[62:63], v4 offset:48832
    s_waitcnt lgkmcnt(14)
    v_mfma_f32_16x16x32_bf16 v[160:163], v[68:71], v[104:107], v[160:163]
    ds_read_b64_tr_b16 v[64:65], v4 offset:35040
    v_mfma_f32_16x16x32_bf16 v[164:167], v[68:71], v[108:111], v[164:167]
    ds_read_b64_tr_b16 v[66:67], v4 offset:39648
    s_waitcnt lgkmcnt(14)
    v_mfma_f32_16x16x32_bf16 v[168:171], v[72:75], v[104:107], v[168:171]
    ds_read_b64_tr_b16 v[68:69], v4 offset:44256
    v_mfma_f32_16x16x32_bf16 v[172:175], v[72:75], v[108:111], v[172:175]
    ds_read_b64_tr_b16 v[70:71], v4 offset:48864
    s_waitcnt lgkmcnt(14)
    v_mfma_f32_16x16x32_bf16 v[176:179], v[76:79], v[104:107], v[176:179]
    ds_read_b64_tr_b16 v[72:73], v6 offset:34816
    v_mfma_f32_16x16x32_bf16 v[180:183], v[76:79], v[108:111], v[180:183]
    ds_read_b64_tr_b16 v[74:75], v6 offset:39424
    s_waitcnt lgkmcnt(14)
    v_mfma_f32_16x16x32_bf16 v[184:187], v[44:47], v[104:107], v[184:187]
    ds_read_b64_tr_b16 v[76:77], v6 offset:44032
    v_mfma_f32_16x16x32_bf16 v[188:191], v[44:47], v[108:111], v[188:191]
    ds_read_b64_tr_b16 v[78:79], v6 offset:48640
    s_waitcnt lgkmcnt(0)
    s_waitcnt vmcnt(1)
    s_barrier
    v_mfma_f32_16x16x32_bf16 v[192:195], v[48:51], v[104:107], v[192:195]
    ds_read_b64_tr_b16 v[44:45], v5 offset:0
    v_mfma_f32_16x16x32_bf16 v[196:199], v[48:51], v[108:111], v[196:199]
    ds_read_b64_tr_b16 v[46:47], v5 offset:4608
    ds_read_b64_tr_b16 v[96:97], v10 offset:0
    v_mfma_f32_16x16x32_bf16 v[200:203], v[52:55], v[104:107], v[200:203]
    ds_read_b64_tr_b16 v[48:49], v5 offset:9216
    v_mfma_f32_16x16x32_bf16 v[204:207], v[52:55], v[108:111], v[204:207]
    ds_read_b64_tr_b16 v[50:51], v5 offset:13824
    ds_read_b64_tr_b16 v[98:99], v10 offset:8192
    s_add_u32 m0, s64, 0
    s_mov_b32 s69, 4718592
    buffer_load_dwordx4 v16, s[44:47], s69 offen lds
    v_mfma_f32_16x16x32_bf16 v[208:211], v[56:59], v[104:107], v[208:211]
    ds_read_b64_tr_b16 v[52:53], v5 offset:32
    v_mfma_f32_16x16x32_bf16 v[212:215], v[56:59], v[108:111], v[212:215]
    ds_read_b64_tr_b16 v[54:55], v5 offset:4640
    ds_read_b64_tr_b16 v[100:101], v11 offset:0
    v_mfma_f32_16x16x32_bf16 v[216:219], v[60:63], v[104:107], v[216:219]
    ds_read_b64_tr_b16 v[56:57], v5 offset:9248
    v_mfma_f32_16x16x32_bf16 v[220:223], v[60:63], v[108:111], v[220:223]
    ds_read_b64_tr_b16 v[58:59], v5 offset:13856
    ds_read_b64_tr_b16 v[102:103], v11 offset:8192
    s_add_u32 m0, s65, 0
    s_mov_b32 s69, 4718592
    buffer_load_dwordx4 v17, s[44:47], s69 offen lds
    v_mfma_f32_16x16x32_bf16 v[224:227], v[64:67], v[104:107], v[224:227]
    ds_read_b64_tr_b16 v[60:61], v5 offset:64
    v_mfma_f32_16x16x32_bf16 v[228:231], v[64:67], v[108:111], v[228:231]
    ds_read_b64_tr_b16 v[62:63], v5 offset:4672
    v_mfma_f32_16x16x32_bf16 v[232:235], v[68:71], v[104:107], v[232:235]
    ds_read_b64_tr_b16 v[64:65], v5 offset:9280
    v_mfma_f32_16x16x32_bf16 v[236:239], v[68:71], v[108:111], v[236:239]
    ds_read_b64_tr_b16 v[66:67], v5 offset:13888
    s_add_u32 m0, s66, 0
    s_mov_b32 s69, 4718592
    buffer_load_dwordx4 v18, s[44:47], s69 offen lds
    v_mfma_f32_16x16x32_bf16 v[240:243], v[72:75], v[104:107], v[240:243]
    ds_read_b64_tr_b16 v[68:69], v5 offset:96
    v_mfma_f32_16x16x32_bf16 v[244:247], v[72:75], v[108:111], v[244:247]
    ds_read_b64_tr_b16 v[70:71], v5 offset:4704
    v_mfma_f32_16x16x32_bf16 v[248:251], v[76:79], v[104:107], v[248:251]
    ds_read_b64_tr_b16 v[72:73], v5 offset:9312
    v_mfma_f32_16x16x32_bf16 v[252:255], v[76:79], v[108:111], v[252:255]
    ds_read_b64_tr_b16 v[74:75], v5 offset:13920
    s_add_u32 m0, s67, 0
    s_mov_b32 s69, 4718592
    buffer_load_dwordx4 v19, s[44:47], s69 offen lds
    s_waitcnt lgkmcnt(8)
    v_mfma_f32_16x16x32_bf16 v[112:115], v[44:47], v[96:99], v[112:115]
    ds_read_b64_tr_b16 v[76:77], v5 offset:128
    v_mfma_f32_16x16x32_bf16 v[116:119], v[44:47], v[100:103], v[116:119]
    ds_read_b64_tr_b16 v[78:79], v5 offset:4736
    s_add_u32 m0, s68, 0
    s_mov_b32 exec_hi, 0
    buffer_load_dwordx4 v20, s[44:47], s69 offen lds
    s_mov_b32 exec_hi, -1
    v_mfma_f32_16x16x32_bf16 v[120:123], v[48:51], v[96:99], v[120:123]
    ds_read_b64_tr_b16 v[44:45], v5 offset:9344
    v_mfma_f32_16x16x32_bf16 v[124:127], v[48:51], v[100:103], v[124:127]
    ds_read_b64_tr_b16 v[46:47], v5 offset:13952
    s_add_u32 m0, s70, 18432
    s_mov_b32 s71, 2097152
    buffer_load_dwordx4 v21, s[52:55], s71 offen sc1 lds
    v_mfma_f32_16x16x32_bf16 v[128:131], v[52:55], v[96:99], v[128:131]
    ds_read_b64_tr_b16 v[48:49], v5 offset:160
    v_mfma_f32_16x16x32_bf16 v[132:135], v[52:55], v[100:103], v[132:135]
    ds_read_b64_tr_b16 v[50:51], v5 offset:4768
    s_add_u32 m0, s70, 26624
    s_mov_b32 s71, 2162688
    buffer_load_dwordx4 v21, s[52:55], s71 offen sc1 lds
    v_mfma_f32_16x16x32_bf16 v[136:139], v[56:59], v[96:99], v[136:139]
    ds_read_b64_tr_b16 v[52:53], v5 offset:9376
    v_mfma_f32_16x16x32_bf16 v[140:143], v[56:59], v[100:103], v[140:143]
    ds_read_b64_tr_b16 v[54:55], v5 offset:13984
    s_add_u32 m0, s70, 53248
    s_mov_b32 s71, 2228224
    buffer_load_dwordx4 v21, s[52:55], s71 offen sc1 lds
    s_waitcnt lgkmcnt(14)
    v_mfma_f32_16x16x32_bf16 v[144:147], v[60:63], v[96:99], v[144:147]
    ds_read_b64_tr_b16 v[56:57], v5 offset:192
    v_mfma_f32_16x16x32_bf16 v[148:151], v[60:63], v[100:103], v[148:151]
    ds_read_b64_tr_b16 v[58:59], v5 offset:4800
    ds_read_b64_tr_b16 v[104:105], v10 offset:34816
    s_add_u32 m0, s70, 61440
    s_mov_b32 s71, 2293760
    buffer_load_dwordx4 v21, s[52:55], s71 offen sc1 lds
    s_waitcnt lgkmcnt(15)
    v_mfma_f32_16x16x32_bf16 v[152:155], v[64:67], v[96:99], v[152:155]
    ds_read_b64_tr_b16 v[60:61], v5 offset:9408
    v_mfma_f32_16x16x32_bf16 v[156:159], v[64:67], v[100:103], v[156:159]
    ds_read_b64_tr_b16 v[62:63], v5 offset:14016
    ds_read_b64_tr_b16 v[106:107], v10 offset:43008
    s_waitcnt lgkmcnt(15)
    v_mfma_f32_16x16x32_bf16 v[160:163], v[68:71], v[96:99], v[160:163]
    ds_read_b64_tr_b16 v[64:65], v5 offset:224
    v_mfma_f32_16x16x32_bf16 v[164:167], v[68:71], v[100:103], v[164:167]
    ds_read_b64_tr_b16 v[66:67], v5 offset:4832
    ds_read_b64_tr_b16 v[108:109], v11 offset:34816
    s_waitcnt lgkmcnt(15)
    v_mfma_f32_16x16x32_bf16 v[168:171], v[72:75], v[96:99], v[168:171]
    ds_read_b64_tr_b16 v[68:69], v5 offset:9440
    v_mfma_f32_16x16x32_bf16 v[172:175], v[72:75], v[100:103], v[172:175]
    ds_read_b64_tr_b16 v[70:71], v5 offset:14048
    ds_read_b64_tr_b16 v[110:111], v11 offset:43008
    v_mfma_f32_16x16x32_bf16 v[176:179], v[76:79], v[96:99], v[176:179]
    ds_read_b64_tr_b16 v[72:73], v7 offset:0
    v_mfma_f32_16x16x32_bf16 v[180:183], v[76:79], v[100:103], v[180:183]
    ds_read_b64_tr_b16 v[74:75], v7 offset:4608
    s_waitcnt lgkmcnt(15)
    v_mfma_f32_16x16x32_bf16 v[184:187], v[44:47], v[96:99], v[184:187]
    ds_read_b64_tr_b16 v[76:77], v7 offset:9216
    v_mfma_f32_16x16x32_bf16 v[188:191], v[44:47], v[100:103], v[188:191]
    ds_read_b64_tr_b16 v[78:79], v7 offset:13824
    v_mfma_f32_16x16x32_bf16 v[192:195], v[48:51], v[96:99], v[192:195]
    ds_read_b64_tr_b16 v[44:45], v5 offset:34816
    v_mfma_f32_16x16x32_bf16 v[196:199], v[48:51], v[100:103], v[196:199]
    ds_read_b64_tr_b16 v[46:47], v5 offset:39424
    s_waitcnt lgkmcnt(15)
    v_mfma_f32_16x16x32_bf16 v[200:203], v[52:55], v[96:99], v[200:203]
    ds_read_b64_tr_b16 v[48:49], v5 offset:44032
    v_mfma_f32_16x16x32_bf16 v[204:207], v[52:55], v[100:103], v[204:207]
    ds_read_b64_tr_b16 v[50:51], v5 offset:48640
    v_mfma_f32_16x16x32_bf16 v[208:211], v[56:59], v[96:99], v[208:211]
    ds_read_b64_tr_b16 v[52:53], v5 offset:34848
    v_mfma_f32_16x16x32_bf16 v[212:215], v[56:59], v[100:103], v[212:215]
    ds_read_b64_tr_b16 v[54:55], v5 offset:39456
    s_waitcnt lgkmcnt(15)
    v_mfma_f32_16x16x32_bf16 v[216:219], v[60:63], v[96:99], v[216:219]
    ds_read_b64_tr_b16 v[56:57], v5 offset:44064
    v_mfma_f32_16x16x32_bf16 v[220:223], v[60:63], v[100:103], v[220:223]
    ds_read_b64_tr_b16 v[58:59], v5 offset:48672
    s_waitcnt lgkmcnt(15)
    v_mfma_f32_16x16x32_bf16 v[224:227], v[64:67], v[96:99], v[224:227]
    ds_read_b64_tr_b16 v[60:61], v5 offset:34880
    v_mfma_f32_16x16x32_bf16 v[228:231], v[64:67], v[100:103], v[228:231]
    ds_read_b64_tr_b16 v[62:63], v5 offset:39488
    s_waitcnt lgkmcnt(15)
    v_mfma_f32_16x16x32_bf16 v[232:235], v[68:71], v[96:99], v[232:235]
    ds_read_b64_tr_b16 v[64:65], v5 offset:44096
    v_mfma_f32_16x16x32_bf16 v[236:239], v[68:71], v[100:103], v[236:239]
    ds_read_b64_tr_b16 v[66:67], v5 offset:48704
    s_waitcnt lgkmcnt(14)
    v_mfma_f32_16x16x32_bf16 v[240:243], v[72:75], v[96:99], v[240:243]
    ds_read_b64_tr_b16 v[68:69], v5 offset:34912
    v_mfma_f32_16x16x32_bf16 v[244:247], v[72:75], v[100:103], v[244:247]
    ds_read_b64_tr_b16 v[70:71], v5 offset:39520
    s_waitcnt lgkmcnt(14)
    v_mfma_f32_16x16x32_bf16 v[248:251], v[76:79], v[96:99], v[248:251]
    ds_read_b64_tr_b16 v[72:73], v5 offset:44128
    v_mfma_f32_16x16x32_bf16 v[252:255], v[76:79], v[100:103], v[252:255]
    ds_read_b64_tr_b16 v[74:75], v5 offset:48736
    s_waitcnt lgkmcnt(14)
    v_mfma_f32_16x16x32_bf16 v[112:115], v[44:47], v[104:107], v[112:115]
    ds_read_b64_tr_b16 v[76:77], v5 offset:34944
    v_mfma_f32_16x16x32_bf16 v[116:119], v[44:47], v[108:111], v[116:119]
    ds_read_b64_tr_b16 v[78:79], v5 offset:39552
    s_waitcnt lgkmcnt(14)
    v_mfma_f32_16x16x32_bf16 v[120:123], v[48:51], v[104:107], v[120:123]
    ds_read_b64_tr_b16 v[44:45], v5 offset:44160
    v_mfma_f32_16x16x32_bf16 v[124:127], v[48:51], v[108:111], v[124:127]
    ds_read_b64_tr_b16 v[46:47], v5 offset:48768
    s_waitcnt lgkmcnt(14)
    v_mfma_f32_16x16x32_bf16 v[128:131], v[52:55], v[104:107], v[128:131]
    ds_read_b64_tr_b16 v[48:49], v5 offset:34976
    v_mfma_f32_16x16x32_bf16 v[132:135], v[52:55], v[108:111], v[132:135]
    ds_read_b64_tr_b16 v[50:51], v5 offset:39584
    s_waitcnt lgkmcnt(14)
    v_mfma_f32_16x16x32_bf16 v[136:139], v[56:59], v[104:107], v[136:139]
    ds_read_b64_tr_b16 v[52:53], v5 offset:44192
    v_mfma_f32_16x16x32_bf16 v[140:143], v[56:59], v[108:111], v[140:143]
    ds_read_b64_tr_b16 v[54:55], v5 offset:48800
    s_waitcnt lgkmcnt(14)
    v_mfma_f32_16x16x32_bf16 v[144:147], v[60:63], v[104:107], v[144:147]
    ds_read_b64_tr_b16 v[56:57], v5 offset:35008
    v_mfma_f32_16x16x32_bf16 v[148:151], v[60:63], v[108:111], v[148:151]
    ds_read_b64_tr_b16 v[58:59], v5 offset:39616
    s_waitcnt lgkmcnt(14)
    v_mfma_f32_16x16x32_bf16 v[152:155], v[64:67], v[104:107], v[152:155]
    ds_read_b64_tr_b16 v[60:61], v5 offset:44224
    v_mfma_f32_16x16x32_bf16 v[156:159], v[64:67], v[108:111], v[156:159]
    ds_read_b64_tr_b16 v[62:63], v5 offset:48832
    s_waitcnt lgkmcnt(14)
    v_mfma_f32_16x16x32_bf16 v[160:163], v[68:71], v[104:107], v[160:163]
    ds_read_b64_tr_b16 v[64:65], v5 offset:35040
    v_mfma_f32_16x16x32_bf16 v[164:167], v[68:71], v[108:111], v[164:167]
    ds_read_b64_tr_b16 v[66:67], v5 offset:39648
    s_waitcnt lgkmcnt(14)
    v_mfma_f32_16x16x32_bf16 v[168:171], v[72:75], v[104:107], v[168:171]
    ds_read_b64_tr_b16 v[68:69], v5 offset:44256
    v_mfma_f32_16x16x32_bf16 v[172:175], v[72:75], v[108:111], v[172:175]
    ds_read_b64_tr_b16 v[70:71], v5 offset:48864
    s_waitcnt lgkmcnt(14)
    v_mfma_f32_16x16x32_bf16 v[176:179], v[76:79], v[104:107], v[176:179]
    ds_read_b64_tr_b16 v[72:73], v7 offset:34816
    v_mfma_f32_16x16x32_bf16 v[180:183], v[76:79], v[108:111], v[180:183]
    ds_read_b64_tr_b16 v[74:75], v7 offset:39424
    s_waitcnt lgkmcnt(14)
    v_mfma_f32_16x16x32_bf16 v[184:187], v[44:47], v[104:107], v[184:187]
    ds_read_b64_tr_b16 v[76:77], v7 offset:44032
    v_mfma_f32_16x16x32_bf16 v[188:191], v[44:47], v[108:111], v[188:191]
    ds_read_b64_tr_b16 v[78:79], v7 offset:48640
    s_waitcnt lgkmcnt(0)
    s_waitcnt vmcnt(0)
    s_barrier
    s_add_u32 s12, s5, 0
    s_and_b32 s12, s12, 3
    s_mul_i32 s13, s12, 5
    s_lshr_b32 s12, s12, 1
    s_sub_u32 s13, s13, s12
    s_mul_i32 s64, s13, 36864
    s_add_u32 s12, s5, 1
    s_and_b32 s12, s12, 3
    s_mul_i32 s13, s12, 5
    s_lshr_b32 s12, s12, 1
    s_sub_u32 s13, s13, s12
    s_mul_i32 s65, s13, 36864
    s_mul_i32 s12, s4, 18
    s_add_u32 s12, s12, s13
    s_lshl_b32 s68, s12, 17
    s_add_u32 s12, s5, 2
    s_and_b32 s12, s12, 3
    s_mul_i32 s13, s12, 5
    s_lshr_b32 s12, s12, 1
    s_sub_u32 s13, s13, s12
    s_mul_i32 s66, s13, 36864
    s_mul_i32 s12, s4, 18
    s_add_u32 s12, s12, s13
    s_lshl_b32 s69, s12, 17
    s_add_u32 s12, s5, 3
    s_and_b32 s12, s12, 3
    s_mul_i32 s13, s12, 5
    s_lshr_b32 s12, s12, 1
    s_sub_u32 s13, s13, s12
    s_mul_i32 s67, s13, 36864
    s_mul_i32 s12, s4, 18
    s_add_u32 s12, s12, s13
    s_lshl_b32 s70, s12, 17
    v_mfma_f32_16x16x32_bf16 v[192:195], v[48:51], v[104:107], v[192:195]
    ds_read_b64_tr_b16 v[44:45], v4 offset:0
    v_mfma_f32_16x16x32_bf16 v[196:199], v[48:51], v[108:111], v[196:199]
    ds_read_b64_tr_b16 v[46:47], v4 offset:4608
    ds_read_b64_tr_b16 v[96:97], v8 offset:0
    s_add_u32 m0, s80, 73728
    s_add_u32 s81, s64, 0
    buffer_load_dwordx4 v12, s[72:75], s81 offen lds
    v_mfma_f32_16x16x32_bf16 v[200:203], v[52:55], v[104:107], v[200:203]
    ds_read_b64_tr_b16 v[48:49], v4 offset:9216
    v_mfma_f32_16x16x32_bf16 v[204:207], v[52:55], v[108:111], v[204:207]
    ds_read_b64_tr_b16 v[50:51], v4 offset:13824
    ds_read_b64_tr_b16 v[98:99], v8 offset:8192
    s_add_u32 m0, s80, 81920
    s_add_u32 s81, s64, 0
    buffer_load_dwordx4 v13, s[72:75], s81 offen lds
    v_mfma_f32_16x16x32_bf16 v[208:211], v[56:59], v[104:107], v[208:211]
    ds_read_b64_tr_b16 v[52:53], v4 offset:32
    v_mfma_f32_16x16x32_bf16 v[212:215], v[56:59], v[108:111], v[212:215]
    ds_read_b64_tr_b16 v[54:55], v4 offset:4640
    ds_read_b64_tr_b16 v[100:101], v9 offset:0
    s_add_u32 m0, s83, 90112
    s_mov_b64 exec, 0xffff
    buffer_load_dwordx4 v14, s[72:75], s81 offen lds
    s_mov_b64 exec, -1
    v_mfma_f32_16x16x32_bf16 v[216:219], v[60:63], v[104:107], v[216:219]
    ds_read_b64_tr_b16 v[56:57], v4 offset:9248
    v_mfma_f32_16x16x32_bf16 v[220:223], v[60:63], v[108:111], v[220:223]
    ds_read_b64_tr_b16 v[58:59], v4 offset:13856
    ds_read_b64_tr_b16 v[102:103], v9 offset:8192
    s_add_u32 m0, s80, 92160
    s_add_u32 s81, s64, 73728
    buffer_load_dwordx4 v12, s[72:75], s81 offen lds
    v_mfma_f32_16x16x32_bf16 v[224:227], v[64:67], v[104:107], v[224:227]
    ds_read_b64_tr_b16 v[60:61], v4 offset:64
    v_mfma_f32_16x16x32_bf16 v[228:231], v[64:67], v[108:111], v[228:231]
    ds_read_b64_tr_b16 v[62:63], v4 offset:4672
    s_add_u32 m0, s80, 100352
    s_add_u32 s81, s64, 73728
    buffer_load_dwordx4 v13, s[72:75], s81 offen lds
    v_mfma_f32_16x16x32_bf16 v[232:235], v[68:71], v[104:107], v[232:235]
    ds_read_b64_tr_b16 v[64:65], v4 offset:9280
    v_mfma_f32_16x16x32_bf16 v[236:239], v[68:71], v[108:111], v[236:239]
    ds_read_b64_tr_b16 v[66:67], v4 offset:13888
    s_add_u32 m0, s83, 108544
    s_mov_b64 exec, 0xffff
    buffer_load_dwordx4 v14, s[72:75], s81 offen lds
    s_mov_b64 exec, -1
    v_mfma_f32_16x16x32_bf16 v[240:243], v[72:75], v[104:107], v[240:243]
    ds_read_b64_tr_b16 v[68:69], v4 offset:96
    v_mfma_f32_16x16x32_bf16 v[244:247], v[72:75], v[108:111], v[244:247]
    ds_read_b64_tr_b16 v[70:71], v4 offset:4704
    s_add_u32 m0, s80, 110592
    s_add_u32 s81, s65, 0
    buffer_load_dwordx4 v12, s[72:75], s81 offen lds
    v_mfma_f32_16x16x32_bf16 v[248:251], v[76:79], v[104:107], v[248:251]
    ds_read_b64_tr_b16 v[72:73], v4 offset:9312
    v_mfma_f32_16x16x32_bf16 v[252:255], v[76:79], v[108:111], v[252:255]
    ds_read_b64_tr_b16 v[74:75], v4 offset:13920
    s_add_u32 m0, s80, 118784
    s_add_u32 s81, s65, 0
    buffer_load_dwordx4 v13, s[72:75], s81 offen lds
    v_readfirstlane_b32 s12, v25
    s_nop 3
    s_cmp_ge_u32 s12, 32
    s_cselect_b32 s61, 1, 0
    s_cmp_eq_u32 s3, 0
    s_cselect_b32 s12, s61, 0
    s_cmp_eq_u32 s12, 1
    s_cbranch_scc0 sequential_preLN__ssm_conv_s4d__glu_gated_reglu__prompt_kernel_mf24
    s_add_u32 s76, s42, 81920
    s_addc_u32 s77, s43, 0
    s_and_b32 s77, s77, 0xffff
    s_mov_b32 s78, 8192
    s_mov_b32 s79, 0x20000
    s_mov_b32 m0, 158848
    v_lshlrev_b32 v24, 4, v1
    s_lshl_b32 s12, s6, 10
    buffer_load_dwordx4 v24, s[76:79], s12 offen sc1 lds
sequential_preLN__ssm_conv_s4d__glu_gated_reglu__prompt_kernel_mf24:
    s_waitcnt lgkmcnt(8)
    v_mfma_f32_16x16x32_bf16 v[112:115], v[44:47], v[96:99], v[112:115]
    ds_read_b64_tr_b16 v[76:77], v4 offset:128
    v_mfma_f32_16x16x32_bf16 v[116:119], v[44:47], v[100:103], v[116:119]
    ds_read_b64_tr_b16 v[78:79], v4 offset:4736
    s_add_u32 m0, s83, 126976
    s_mov_b64 exec, 0xffff
    buffer_load_dwordx4 v14, s[72:75], s81 offen lds
    s_mov_b64 exec, -1
    v_mfma_f32_16x16x32_bf16 v[120:123], v[48:51], v[96:99], v[120:123]
    ds_read_b64_tr_b16 v[44:45], v4 offset:9344
    v_mfma_f32_16x16x32_bf16 v[124:127], v[48:51], v[100:103], v[124:127]
    ds_read_b64_tr_b16 v[46:47], v4 offset:13952
    s_add_u32 m0, s80, 129024
    s_add_u32 s81, s65, 73728
    buffer_load_dwordx4 v12, s[72:75], s81 offen lds
    v_mfma_f32_16x16x32_bf16 v[128:131], v[52:55], v[96:99], v[128:131]
    ds_read_b64_tr_b16 v[48:49], v4 offset:160
    v_mfma_f32_16x16x32_bf16 v[132:135], v[52:55], v[100:103], v[132:135]
    ds_read_b64_tr_b16 v[50:51], v4 offset:4768
    s_add_u32 m0, s80, 137216
    s_add_u32 s81, s65, 73728
    buffer_load_dwordx4 v13, s[72:75], s81 offen lds
    v_mfma_f32_16x16x32_bf16 v[136:139], v[56:59], v[96:99], v[136:139]
    ds_read_b64_tr_b16 v[52:53], v4 offset:9376
    v_mfma_f32_16x16x32_bf16 v[140:143], v[56:59], v[100:103], v[140:143]
    ds_read_b64_tr_b16 v[54:55], v4 offset:13984
    s_add_u32 m0, s83, 145408
    s_mov_b64 exec, 0xffff
    buffer_load_dwordx4 v14, s[72:75], s81 offen lds
    s_mov_b64 exec, -1
    s_waitcnt lgkmcnt(14)
    v_mfma_f32_16x16x32_bf16 v[144:147], v[60:63], v[96:99], v[144:147]
    ds_read_b64_tr_b16 v[56:57], v4 offset:192
    v_mfma_f32_16x16x32_bf16 v[148:151], v[60:63], v[100:103], v[148:151]
    ds_read_b64_tr_b16 v[58:59], v4 offset:4800
    ds_read_b64_tr_b16 v[104:105], v8 offset:34816
    s_waitcnt lgkmcnt(15)
    v_mfma_f32_16x16x32_bf16 v[152:155], v[64:67], v[96:99], v[152:155]
    ds_read_b64_tr_b16 v[60:61], v4 offset:9408
    v_mfma_f32_16x16x32_bf16 v[156:159], v[64:67], v[100:103], v[156:159]
    ds_read_b64_tr_b16 v[62:63], v4 offset:14016
    ds_read_b64_tr_b16 v[106:107], v8 offset:43008
    s_waitcnt lgkmcnt(15)
    v_mfma_f32_16x16x32_bf16 v[160:163], v[68:71], v[96:99], v[160:163]
    ds_read_b64_tr_b16 v[64:65], v4 offset:224
    v_mfma_f32_16x16x32_bf16 v[164:167], v[68:71], v[100:103], v[164:167]
    ds_read_b64_tr_b16 v[66:67], v4 offset:4832
    ds_read_b64_tr_b16 v[108:109], v9 offset:34816
    s_waitcnt lgkmcnt(15)
    v_mfma_f32_16x16x32_bf16 v[168:171], v[72:75], v[96:99], v[168:171]
    ds_read_b64_tr_b16 v[68:69], v4 offset:9440
    v_mfma_f32_16x16x32_bf16 v[172:175], v[72:75], v[100:103], v[172:175]
    ds_read_b64_tr_b16 v[70:71], v4 offset:14048
    ds_read_b64_tr_b16 v[110:111], v9 offset:43008
    v_mfma_f32_16x16x32_bf16 v[176:179], v[76:79], v[96:99], v[176:179]
    ds_read_b64_tr_b16 v[72:73], v6 offset:0
    v_mfma_f32_16x16x32_bf16 v[180:183], v[76:79], v[100:103], v[180:183]
    ds_read_b64_tr_b16 v[74:75], v6 offset:4608
    s_waitcnt lgkmcnt(15)
    v_mfma_f32_16x16x32_bf16 v[184:187], v[44:47], v[96:99], v[184:187]
    ds_read_b64_tr_b16 v[76:77], v6 offset:9216
    v_mfma_f32_16x16x32_bf16 v[188:191], v[44:47], v[100:103], v[188:191]
    ds_read_b64_tr_b16 v[78:79], v6 offset:13824
    v_mfma_f32_16x16x32_bf16 v[192:195], v[48:51], v[96:99], v[192:195]
    ds_read_b64_tr_b16 v[44:45], v4 offset:34816
    v_mfma_f32_16x16x32_bf16 v[196:199], v[48:51], v[100:103], v[196:199]
    ds_read_b64_tr_b16 v[46:47], v4 offset:39424
    s_waitcnt lgkmcnt(15)
    v_mfma_f32_16x16x32_bf16 v[200:203], v[52:55], v[96:99], v[200:203]
    ds_read_b64_tr_b16 v[48:49], v4 offset:44032
    v_mfma_f32_16x16x32_bf16 v[204:207], v[52:55], v[100:103], v[204:207]
    ds_read_b64_tr_b16 v[50:51], v4 offset:48640
    v_mfma_f32_16x16x32_bf16 v[208:211], v[56:59], v[96:99], v[208:211]
    ds_read_b64_tr_b16 v[52:53], v4 offset:34848
    v_mfma_f32_16x16x32_bf16 v[212:215], v[56:59], v[100:103], v[212:215]
    ds_read_b64_tr_b16 v[54:55], v4 offset:39456
    s_waitcnt lgkmcnt(15)
    v_mfma_f32_16x16x32_bf16 v[216:219], v[60:63], v[96:99], v[216:219]
    ds_read_b64_tr_b16 v[56:57], v4 offset:44064
    v_mfma_f32_16x16x32_bf16 v[220:223], v[60:63], v[100:103], v[220:223]
    ds_read_b64_tr_b16 v[58:59], v4 offset:48672
    s_waitcnt lgkmcnt(15)
    v_mfma_f32_16x16x32_bf16 v[224:227], v[64:67], v[96:99], v[224:227]
    ds_read_b64_tr_b16 v[60:61], v4 offset:34880
    v_mfma_f32_16x16x32_bf16 v[228:231], v[64:67], v[100:103], v[228:231]
    ds_read_b64_tr_b16 v[62:63], v4 offset:39488
    s_waitcnt lgkmcnt(15)
    v_mfma_f32_16x16x32_bf16 v[232:235], v[68:71], v[96:99], v[232:235]
    ds_read_b64_tr_b16 v[64:65], v4 offset:44096
    v_mfma_f32_16x16x32_bf16 v[236:239], v[68:71], v[100:103], v[236:239]
    ds_read_b64_tr_b16 v[66:67], v4 offset:48704
    s_waitcnt lgkmcnt(14)
    v_mfma_f32_16x16x32_bf16 v[240:243], v[72:75], v[96:99], v[240:243]
    ds_read_b64_tr_b16 v[68:69], v4 offset:34912
    v_mfma_f32_16x16x32_bf16 v[244:247], v[72:75], v[100:103], v[244:247]
    ds_read_b64_tr_b16 v[70:71], v4 offset:39520
    s_waitcnt lgkmcnt(14)
    v_mfma_f32_16x16x32_bf16 v[248:251], v[76:79], v[96:99], v[248:251]
    ds_read_b64_tr_b16 v[72:73], v4 offset:44128
    v_mfma_f32_16x16x32_bf16 v[252:255], v[76:79], v[100:103], v[252:255]
    ds_read_b64_tr_b16 v[74:75], v4 offset:48736
    s_waitcnt lgkmcnt(14)
    v_mfma_f32_16x16x32_bf16 v[112:115], v[44:47], v[104:107], v[112:115]
    ds_read_b64_tr_b16 v[76:77], v4 offset:34944
    v_mfma_f32_16x16x32_bf16 v[116:119], v[44:47], v[108:111], v[116:119]
    ds_read_b64_tr_b16 v[78:79], v4 offset:39552
    s_waitcnt lgkmcnt(14)
    v_mfma_f32_16x16x32_bf16 v[120:123], v[48:51], v[104:107], v[120:123]
    ds_read_b64_tr_b16 v[44:45], v4 offset:44160
    v_mfma_f32_16x16x32_bf16 v[124:127], v[48:51], v[108:111], v[124:127]
    ds_read_b64_tr_b16 v[46:47], v4 offset:48768
    s_waitcnt lgkmcnt(14)
    v_mfma_f32_16x16x32_bf16 v[128:131], v[52:55], v[104:107], v[128:131]
    ds_read_b64_tr_b16 v[48:49], v4 offset:34976
    v_mfma_f32_16x16x32_bf16 v[132:135], v[52:55], v[108:111], v[132:135]
    ds_read_b64_tr_b16 v[50:51], v4 offset:39584
    s_waitcnt lgkmcnt(14)
    v_mfma_f32_16x16x32_bf16 v[136:139], v[56:59], v[104:107], v[136:139]
    ds_read_b64_tr_b16 v[52:53], v4 offset:44192
    v_mfma_f32_16x16x32_bf16 v[140:143], v[56:59], v[108:111], v[140:143]
    ds_read_b64_tr_b16 v[54:55], v4 offset:48800
    s_waitcnt lgkmcnt(14)
    v_mfma_f32_16x16x32_bf16 v[144:147], v[60:63], v[104:107], v[144:147]
    ds_read_b64_tr_b16 v[56:57], v4 offset:35008
    v_mfma_f32_16x16x32_bf16 v[148:151], v[60:63], v[108:111], v[148:151]
    ds_read_b64_tr_b16 v[58:59], v4 offset:39616
    s_waitcnt lgkmcnt(14)
    v_mfma_f32_16x16x32_bf16 v[152:155], v[64:67], v[104:107], v[152:155]
    ds_read_b64_tr_b16 v[60:61], v4 offset:44224
    v_mfma_f32_16x16x32_bf16 v[156:159], v[64:67], v[108:111], v[156:159]
    ds_read_b64_tr_b16 v[62:63], v4 offset:48832
    s_waitcnt lgkmcnt(14)
    v_mfma_f32_16x16x32_bf16 v[160:163], v[68:71], v[104:107], v[160:163]
    ds_read_b64_tr_b16 v[64:65], v4 offset:35040
    v_mfma_f32_16x16x32_bf16 v[164:167], v[68:71], v[108:111], v[164:167]
    ds_read_b64_tr_b16 v[66:67], v4 offset:39648
    s_waitcnt lgkmcnt(14)
    v_mfma_f32_16x16x32_bf16 v[168:171], v[72:75], v[104:107], v[168:171]
    ds_read_b64_tr_b16 v[68:69], v4 offset:44256
    v_mfma_f32_16x16x32_bf16 v[172:175], v[72:75], v[108:111], v[172:175]
    ds_read_b64_tr_b16 v[70:71], v4 offset:48864
    s_waitcnt lgkmcnt(14)
    v_mfma_f32_16x16x32_bf16 v[176:179], v[76:79], v[104:107], v[176:179]
    ds_read_b64_tr_b16 v[72:73], v6 offset:34816
    v_mfma_f32_16x16x32_bf16 v[180:183], v[76:79], v[108:111], v[180:183]
    ds_read_b64_tr_b16 v[74:75], v6 offset:39424
    s_waitcnt lgkmcnt(14)
    v_mfma_f32_16x16x32_bf16 v[184:187], v[44:47], v[104:107], v[184:187]
    ds_read_b64_tr_b16 v[76:77], v6 offset:44032
    v_mfma_f32_16x16x32_bf16 v[188:191], v[44:47], v[108:111], v[188:191]
    ds_read_b64_tr_b16 v[78:79], v6 offset:48640
    s_waitcnt lgkmcnt(14)
    v_mfma_f32_16x16x32_bf16 v[192:195], v[48:51], v[104:107], v[192:195]
    v_mfma_f32_16x16x32_bf16 v[196:199], v[48:51], v[108:111], v[196:199]
    s_waitcnt lgkmcnt(12)
    v_mfma_f32_16x16x32_bf16 v[200:203], v[52:55], v[104:107], v[200:203]
    v_mfma_f32_16x16x32_bf16 v[204:207], v[52:55], v[108:111], v[204:207]
    s_waitcnt lgkmcnt(10)
    v_mfma_f32_16x16x32_bf16 v[208:211], v[56:59], v[104:107], v[208:211]
    v_mfma_f32_16x16x32_bf16 v[212:215], v[56:59], v[108:111], v[212:215]
    s_waitcnt lgkmcnt(8)
    v_mfma_f32_16x16x32_bf16 v[216:219], v[60:63], v[104:107], v[216:219]
    v_mfma_f32_16x16x32_bf16 v[220:223], v[60:63], v[108:111], v[220:223]
    s_waitcnt lgkmcnt(6)
    v_mfma_f32_16x16x32_bf16 v[224:227], v[64:67], v[104:107], v[224:227]
    v_mfma_f32_16x16x32_bf16 v[228:231], v[64:67], v[108:111], v[228:231]
    s_waitcnt lgkmcnt(4)
    v_mfma_f32_16x16x32_bf16 v[232:235], v[68:71], v[104:107], v[232:235]
    v_mfma_f32_16x16x32_bf16 v[236:239], v[68:71], v[108:111], v[236:239]
    s_waitcnt lgkmcnt(2)
    v_mfma_f32_16x16x32_bf16 v[240:243], v[72:75], v[104:107], v[240:243]
    v_mfma_f32_16x16x32_bf16 v[244:247], v[72:75], v[108:111], v[244:247]
    s_waitcnt lgkmcnt(0)
    v_mfma_f32_16x16x32_bf16 v[248:251], v[76:79], v[104:107], v[248:251]
    v_mfma_f32_16x16x32_bf16 v[252:255], v[76:79], v[108:111], v[252:255]
    s_waitcnt vmcnt(0)
    s_cmp_eq_u32 s3, 0
    s_cbranch_scc0 sequential_preLN__ssm_conv_s4d__glu_gated_reglu__prompt_kernel_mw25
    s_cmp_eq_u32 s61, 0
    s_cbranch_scc0 sequential_preLN__ssm_conv_s4d__glu_gated_reglu__prompt_kernel_mw25
    s_lshl_b32 s12, s6, 7
    s_add_u32 s12, s12, 16384
    s_mov_b64 exec, 1
    v_mov_b32 v28, s12
    s_mov_b32 s60, 0
sequential_preLN__ssm_conv_s4d__glu_gated_reglu__prompt_kernel_pollm26:
    global_load_dword v29, v28, s[42:43] sc1
    s_add_u32 s60, s60, 1
    s_waitcnt vmcnt(0)
    v_cmp_gt_u32 vcc, 32, v29
    s_cmp_eq_u64 vcc, 0
    s_cbranch_scc1 sequential_preLN__ssm_conv_s4d__glu_gated_reglu__prompt_kernel_pdonem27
    s_cmp_ge_u32 s60, 0x200000
    s_cbranch_scc1 sequential_preLN__ssm_conv_s4d__glu_gated_reglu__prompt_kernel_pdonem27
    s_sleep 2
    s_branch sequential_preLN__ssm_conv_s4d__glu_gated_reglu__prompt_kernel_pollm26
sequential_preLN__ssm_conv_s4d__glu_gated_reglu__prompt_kernel_pdonem27:
    s_mov_b64 exec, -1
    s_add_u32 s76, s42, 81920
    s_addc_u32 s77, s43, 0
    s_and_b32 s77, s77, 0xffff
    s_mov_b32 s78, 8192
    s_mov_b32 s79, 0x20000
    s_mov_b32 m0, 158848
    v_lshlrev_b32 v3, 4, v1
    s_lshl_b32 s12, s6, 10
    buffer_load_dwordx4 v3, s[76:79], s12 offen sc1 lds
    s_waitcnt vmcnt(0)
sequential_preLN__ssm_conv_s4d__glu_gated_reglu__prompt_kernel_mw25:
    s_barrier
    v_and_b32 v28, 15, v1
    v_lshrrev_b32 v29, 4, v1
    s_lshl_b32 s12, s3, 7
    s_add_u32 s12, s12, 158848
    v_lshl_add_u32 v30, v28, 2, s12
    ds_read_b32 v24, v30 offset:0
    ds_read_b32 v25, v30 offset:64
    v_lshlrev_b32 v30, 4, v29
    v_add_u32 v30, 148480, v30
    s_lshl_b32 s12, s10, 6
    v_add_u32 v31, s12, v30
    s_xor_b32 s13, s10, 1
    s_lshl_b32 s13, s13, 9
    v_add_u32 v30, s13, v30
    ds_read_b128 v[40:43], v31 offset:0
    ds_read_b128 v[44:47], v31 offset:576
    ds_read_b128 v[48:51], v31 offset:64
    ds_read_b128 v[52:55], v31 offset:640
    ds_read_b128 v[56:59], v31 offset:128
    ds_read_b128 v[60:63], v31 offset:704
    ds_read_b128 v[64:67], v31 offset:192
    ds_read_b128 v[68:71], v31 offset:768
    ds_read_b128 v[72:75], v31 offset:256
    ds_read_b128 v[76:79], v31 offset:832
    ds_read_b128 v[80:83], v31 offset:320
    ds_read_b128 v[84:87], v31 offset:896
    ds_read_b128 v[88:91], v31 offset:384
    ds_read_b128 v[92:95], v31 offset:960
    ds_read_b128 v[96:99], v31 offset:448
    ds_read_b128 v[100:103], v31 offset:1024
    ds_read_b128 v[104:107], v30 offset:0
    ds_read_b128 v[108:111], v30 offset:576
    s_mul_i32 s12, s7, 9
    s_add_u32 s13, s12, s10
    s_lshr_b32 s13, s13, 1
    s_lshl_b32 s62, s13, 17
    s_add_u32 s76, s42, 48234496
    s_addc_u32 s77, s43, 0
    s_and_b32 s77, s77, 0xffff
    s_mov_b32 s78, 2097152
    s_mov_b32 s79, 0x20000
    s_lshl_b32 s61, s7, 16
    v_lshrrev_b32 v3, 1, v2
    s_waitcnt lgkmcnt(0)
    s_add_u32 m0, s80, 0
    s_add_u32 s81, s66, 0
    buffer_load_dwordx4 v12, s[72:75], s81 offen lds
    v_fma_f32 v112, -v24, v40, v112
    v_fma_f32 v113, -v24, v41, v113
    v_fma_f32 v114, -v24, v42, v114
    v_fma_f32 v115, -v24, v43, v115
    v_fma_f32 v120, -v24, v44, v120
    v_fma_f32 v121, -v24, v45, v121
    v_fma_f32 v122, -v24, v46, v122
    v_fma_f32 v123, -v24, v47, v123
    v_max_f32 v112, 0, v112
    v_max_f32 v113, 0, v113
    v_max_f32 v114, 0, v114
    v_max_f32 v115, 0, v115
    v_mul_f32 v112, v112, v120
    v_mul_f32 v113, v113, v121
    v_mul_f32 v114, v114, v122
    v_mul_f32 v115, v115, v123
    v_cvt_pk_bf16_f32 v120, v112, v113
    v_cvt_pk_bf16_f32 v121, v114, v115
    s_add_u32 m0, s80, 8192
    s_add_u32 s81, s66, 0
    buffer_load_dwordx4 v13, s[72:75], s81 offen lds
    v_fma_f32 v116, -v25, v40, v116
    v_fma_f32 v117, -v25, v41, v117
    v_fma_f32 v118, -v25, v42, v118
    v_fma_f32 v119, -v25, v43, v119
    v_fma_f32 v124, -v25, v44, v124
    v_fma_f32 v125, -v25, v45, v125
    v_fma_f32 v126, -v25, v46, v126
    v_fma_f32 v127, -v25, v47, v127
    v_max_f32 v116, 0, v116
    v_max_f32 v117, 0, v117
    v_max_f32 v118, 0, v118
    v_max_f32 v119, 0, v119
    v_mul_f32 v116, v116, v124
    v_mul_f32 v117, v117, v125
    v_mul_f32 v118, v118, v126
    v_mul_f32 v119, v119, v127
    v_cvt_pk_bf16_f32 v124, v116, v117
    v_cvt_pk_bf16_f32 v125, v118, v119
    s_add_u32 m0, s83, 16384
    s_mov_b64 exec, 0xffff
    buffer_load_dwordx4 v14, s[72:75], s81 offen lds
    s_mov_b64 exec, -1
    v_fma_f32 v128, -v24, v48, v128
    v_fma_f32 v129, -v24, v49, v129
    v_fma_f32 v130, -v24, v50, v130
    v_fma_f32 v131, -v24, v51, v131
    v_fma_f32 v136, -v24, v52, v136
    v_fma_f32 v137, -v24, v53, v137
    v_fma_f32 v138, -v24, v54, v138
    v_fma_f32 v139, -v24, v55, v139
    v_max_f32 v128, 0, v128
    v_max_f32 v129, 0, v129
    v_max_f32 v130, 0, v130
    v_max_f32 v131, 0, v131
    v_mul_f32 v128, v128, v136
    v_mul_f32 v129, v129, v137
    v_mul_f32 v130, v130, v138
    v_mul_f32 v131, v131, v139
    v_cvt_pk_bf16_f32 v122, v128, v129
    v_cvt_pk_bf16_f32 v123, v130, v131
    s_add_u32 s12, s62, 0
    buffer_store_dwordx4 v[120:123], v2, s[56:59], s12 offen offset:0 sc1
    s_add_u32 m0, s80, 18432
    s_add_u32 s81, s66, 73728
    buffer_load_dwordx4 v12, s[72:75], s81 offen lds
    v_fma_f32 v132, -v25, v48, v132
    v_fma_f32 v133, -v25, v49, v133
    v_fma_f32 v134, -v25, v50, v134
    v_fma_f32 v135, -v25, v51, v135
    v_fma_f32 v140, -v25, v52, v140
    v_fma_f32 v141, -v25, v53, v141
    v_fma_f32 v142, -v25, v54, v142
    v_fma_f32 v143, -v25, v55, v143
    v_max_f32 v132, 0, v132
    v_max_f32 v133, 0, v133
    v_max_f32 v134, 0, v134
    v_max_f32 v135, 0, v135
    v_mul_f32 v132, v132, v140
    v_mul_f32 v133, v133, v141
    v_mul_f32 v134, v134, v142
    v_mul_f32 v135, v135, v143
    v_cvt_pk_bf16_f32 v126, v132, v133
    v_cvt_pk_bf16_f32 v127, v134, v135
    s_add_u32 s12, s62, 0
    buffer_store_dwordx4 v[124:127], v2, s[56:59], s12 offen offset:1024 sc1
    s_add_u32 m0, s80, 26624
    s_add_u32 s81, s66, 73728
    buffer_load_dwordx4 v13, s[72:75], s81 offen lds
    v_fma_f32 v144, -v24, v56, v144
    v_fma_f32 v145, -v24, v57, v145
    v_fma_f32 v146, -v24, v58, v146
    v_fma_f32 v147, -v24, v59, v147
    v_fma_f32 v152, -v24, v60, v152
    v_fma_f32 v153, -v24, v61, v153
    v_fma_f32 v154, -v24, v62, v154
    v_fma_f32 v155, -v24, v63, v155
    v_max_f32 v144, 0, v144
    v_max_f32 v145, 0, v145
    v_max_f32 v146, 0, v146
    v_max_f32 v147, 0, v147
    v_mul_f32 v144, v144, v152
    v_mul_f32 v145, v145, v153
    v_mul_f32 v146, v146, v154
    v_mul_f32 v147, v147, v155
    v_cvt_pk_bf16_f32 v152, v144, v145
    v_cvt_pk_bf16_f32 v153, v146, v147
    s_add_u32 m0, s83, 34816
    s_mov_b64 exec, 0xffff
    buffer_load_dwordx4 v14, s[72:75], s81 offen lds
    s_mov_b64 exec, -1
    v_fma_f32 v148, -v25, v56, v148
    v_fma_f32 v149, -v25, v57, v149
    v_fma_f32 v150, -v25, v58, v150
    v_fma_f32 v151, -v25, v59, v151
    v_fma_f32 v156, -v25, v60, v156
    v_fma_f32 v157, -v25, v61, v157
    v_fma_f32 v158, -v25, v62, v158
    v_fma_f32 v159, -v25, v63, v159
    v_max_f32 v148, 0, v148
    v_max_f32 v149, 0, v149
    v_max_f32 v150, 0, v150
    v_max_f32 v151, 0, v151
    v_mul_f32 v148, v148, v156
    v_mul_f32 v149, v149, v157
    v_mul_f32 v150, v150, v158
    v_mul_f32 v151, v151, v159
    v_cvt_pk_bf16_f32 v156, v148, v149
    v_cvt_pk_bf16_f32 v157, v150, v151
    s_add_u32 m0, s80, 36864
    s_add_u32 s81, s67, 0
    buffer_load_dwordx4 v12, s[72:75], s81 offen lds
    v_fma_f32 v160, -v24, v64, v160
    v_fma_f32 v161, -v24, v65, v161
    v_fma_f32 v162, -v24, v66, v162
    v_fma_f32 v163, -v24, v67, v163
    v_fma_f32 v168, -v24, v68, v168
    v_fma_f32 v169, -v24, v69, v169
    v_fma_f32 v170, -v24, v70, v170
    v_fma_f32 v171, -v24, v71, v171
    v_max_f32 v160, 0, v160
    v_max_f32 v161, 0, v161
    v_max_f32 v162, 0, v162
    v_max_f32 v163, 0, v163
    v_mul_f32 v160, v160, v168
    v_mul_f32 v161, v161, v169
    v_mul_f32 v162, v162, v170
    v_mul_f32 v163, v163, v171
    v_cvt_pk_bf16_f32 v154, v160, v161
    v_cvt_pk_bf16_f32 v155, v162, v163
    s_add_u32 s12, s62, 131072
    buffer_store_dwordx4 v[152:155], v2, s[56:59], s12 offen offset:0 sc1
    s_add_u32 m0, s80, 45056
    s_add_u32 s81, s67, 0
    buffer_load_dwordx4 v13, s[72:75], s81 offen lds
    v_fma_f32 v164, -v25, v64, v164
    v_fma_f32 v165, -v25, v65, v165
    v_fma_f32 v166, -v25, v66, v166
    v_fma_f32 v167, -v25, v67, v167
    v_fma_f32 v172, -v25, v68, v172
    v_fma_f32 v173, -v25, v69, v173
    v_fma_f32 v174, -v25, v70, v174
    v_fma_f32 v175, -v25, v71, v175
    v_max_f32 v164, 0, v164
    v_max_f32 v165, 0, v165
    v_max_f32 v166, 0, v166
    v_max_f32 v167, 0, v167
    v_mul_f32 v164, v164, v172
    v_mul_f32 v165, v165, v173
    v_mul_f32 v166, v166, v174
    v_mul_f32 v167, v167, v175
    v_cvt_pk_bf16_f32 v158, v164, v165
    v_cvt_pk_bf16_f32 v159, v166, v167
    s_add_u32 s12, s62, 131072
    buffer_store_dwordx4 v[156:159], v2, s[56:59], s12 offen offset:1024 sc1
    s_add_u32 m0, s83, 53248
    s_mov_b64 exec, 0xffff
    buffer_load_dwordx4 v14, s[72:75], s81 offen lds
    s_mov_b64 exec, -1
    v_fma_f32 v176, -v24, v72, v176
    v_fma_f32 v177, -v24, v73, v177
    v_fma_f32 v178, -v24, v74, v178
    v_fma_f32 v179, -v24, v75, v179
    v_fma_f32 v184, -v24, v76, v184
    v_fma_f32 v185, -v24, v77, v185
    v_fma_f32 v186, -v24, v78, v186
    v_fma_f32 v187, -v24, v79, v187
    v_max_f32 v176, 0, v176
    v_max_f32 v177, 0, v177
    v_max_f32 v178, 0, v178
    v_max_f32 v179, 0, v179
    v_mul_f32 v176, v176, v184
    v_mul_f32 v177, v177, v185
    v_mul_f32 v178, v178, v186
    v_mul_f32 v179, v179, v187
    v_cvt_pk_bf16_f32 v184, v176, v177
    v_cvt_pk_bf16_f32 v185, v178, v179
    s_add_u32 m0, s80, 55296
    s_add_u32 s81, s67, 73728
    buffer_load_dwordx4 v12, s[72:75], s81 offen lds
    v_fma_f32 v180, -v25, v72, v180
    v_fma_f32 v181, -v25, v73, v181
    v_fma_f32 v182, -v25, v74, v182
    v_fma_f32 v183, -v25, v75, v183
    v_fma_f32 v188, -v25, v76, v188
    v_fma_f32 v189, -v25, v77, v189
    v_fma_f32 v190, -v25, v78, v190
    v_fma_f32 v191, -v25, v79, v191
    v_max_f32 v180, 0, v180
    v_max_f32 v181, 0, v181
    v_max_f32 v182, 0, v182
    v_max_f32 v183, 0, v183
    v_mul_f32 v180, v180, v188
    v_mul_f32 v181, v181, v189
    v_mul_f32 v182, v182, v190
    v_mul_f32 v183, v183, v191
    v_cvt_pk_bf16_f32 v188, v180, v181
    v_cvt_pk_bf16_f32 v189, v182, v183
    s_add_u32 m0, s80, 63488
    s_add_u32 s81, s67, 73728
    buffer_load_dwordx4 v13, s[72:75], s81 offen lds
    v_fma_f32 v192, -v24, v80, v192
    v_fma_f32 v193, -v24, v81, v193
    v_fma_f32 v194, -v24, v82, v194
    v_fma_f32 v195, -v24, v83, v195
    v_fma_f32 v200, -v24, v84, v200
    v_fma_f32 v201, -v24, v85, v201
    v_fma_f32 v202, -v24, v86, v202
    v_fma_f32 v203, -v24, v87, v203
    v_max_f32 v192, 0, v192
    v_max_f32 v193, 0, v193
    v_max_f32 v194, 0, v194
    v_max_f32 v195, 0, v195
    v_mul_f32 v192, v192, v200
    v_mul_f32 v193, v193, v201
    v_mul_f32 v194, v194, v202
    v_mul_f32 v195, v195, v203
    v_cvt_pk_bf16_f32 v186, v192, v193
    v_cvt_pk_bf16_f32 v187, v194, v195
    s_add_u32 s12, s62, 262144
    buffer_store_dwordx4 v[184:187], v2, s[56:59], s12 offen offset:0 sc1
    s_add_u32 m0, s83, 71680
    s_mov_b64 exec, 0xffff
    buffer_load_dwordx4 v14, s[72:75], s81 offen lds
    s_mov_b64 exec, -1
    v_fma_f32 v196, -v25, v80, v196
    v_fma_f32 v197, -v25, v81, v197
    v_fma_f32 v198, -v25, v82, v198
    v_fma_f32 v199, -v25, v83, v199
    v_fma_f32 v204, -v25, v84, v204
    v_fma_f32 v205, -v25, v85, v205
    v_fma_f32 v206, -v25, v86, v206
    v_fma_f32 v207, -v25, v87, v207
    v_max_f32 v196, 0, v196
    v_max_f32 v197, 0, v197
    v_max_f32 v198, 0, v198
    v_max_f32 v199, 0, v199
    v_mul_f32 v196, v196, v204
    v_mul_f32 v197, v197, v205
    v_mul_f32 v198, v198, v206
    v_mul_f32 v199, v199, v207
    v_cvt_pk_bf16_f32 v190, v196, v197
    v_cvt_pk_bf16_f32 v191, v198, v199
    s_add_u32 s12, s62, 262144
    buffer_store_dwordx4 v[188:191], v2, s[56:59], s12 offen offset:1024 sc1
    v_fma_f32 v208, -v24, v88, v208
    v_fma_f32 v209, -v24, v89, v209
    v_fma_f32 v210, -v24, v90, v210
    v_fma_f32 v211, -v24, v91, v211
    v_fma_f32 v216, -v24, v92, v216
    v_fma_f32 v217, -v24, v93, v217
    v_fma_f32 v218, -v24, v94, v218
    v_fma_f32 v219, -v24, v95, v219
    v_max_f32 v208, 0, v208
    v_max_f32 v209, 0, v209
    v_max_f32 v210, 0, v210
    v_max_f32 v211, 0, v211
    v_mul_f32 v208, v208, v216
    v_mul_f32 v209, v209, v217
    v_mul_f32 v210, v210, v218
    v_mul_f32 v211, v211, v219
    v_cvt_pk_bf16_f32 v216, v208, v209
    v_cvt_pk_bf16_f32 v217, v210, v211
    v_fma_f32 v212, -v25, v88, v212
    v_fma_f32 v213, -v25, v89, v213
    v_fma_f32 v214, -v25, v90, v214
    v_fma_f32 v215, -v25, v91, v215
    v_fma_f32 v220, -v25, v92, v220
    v_fma_f32 v221, -v25, v93, v221
    v_fma_f32 v222, -v25, v94, v222
    v_fma_f32 v223, -v25, v95, v223
    v_max_f32 v212, 0, v212
    v_max_f32 v213, 0, v213
    v_max_f32 v214, 0, v214
    v_max_f32 v215, 0, v215
    v_mul_f32 v212, v212, v220
    v_mul_f32 v213, v213, v221
    v_mul_f32 v214, v214, v222
    v_mul_f32 v215, v215, v223
    v_cvt_pk_bf16_f32 v220, v212, v213
    v_cvt_pk_bf16_f32 v221, v214, v215
    v_fma_f32 v224, -v24, v96, v224
    v_fma_f32 v225, -v24, v97, v225
    v_fma_f32 v226, -v24, v98, v226
    v_fma_f32 v227, -v24, v99, v227
    v_fma_f32 v232, -v24, v100, v232
    v_fma_f32 v233, -v24, v101, v233
    v_fma_f32 v234, -v24, v102, v234
    v_fma_f32 v235, -v24, v103, v235
    v_max_f32 v224, 0, v224
    v_max_f32 v225, 0, v225
    v_max_f32 v226, 0, v226
    v_max_f32 v227, 0, v227
    v_mul_f32 v224, v224, v232
    v_mul_f32 v225, v225, v233
    v_mul_f32 v226, v226, v234
    v_mul_f32 v227, v227, v235
    v_cvt_pk_bf16_f32 v218, v224, v225
    v_cvt_pk_bf16_f32 v219, v226, v227
    s_add_u32 s12, s62, 393216
    buffer_store_dwordx4 v[216:219], v2, s[56:59], s12 offen offset:0 sc1
    v_fma_f32 v228, -v25, v96, v228
    v_fma_f32 v229, -v25, v97, v229
    v_fma_f32 v230, -v25, v98, v230
    v_fma_f32 v231, -v25, v99, v231
    v_fma_f32 v236, -v25, v100, v236
    v_fma_f32 v237, -v25, v101, v237
    v_fma_f32 v238, -v25, v102, v238
    v_fma_f32 v239, -v25, v103, v239
    v_max_f32 v228, 0, v228
    v_max_f32 v229, 0, v229
    v_max_f32 v230, 0, v230
    v_max_f32 v231, 0, v231
    v_mul_f32 v228, v228, v236
    v_mul_f32 v229, v229, v237
    v_mul_f32 v230, v230, v238
    v_mul_f32 v231, v231, v239
    v_cvt_pk_bf16_f32 v222, v228, v229
    v_cvt_pk_bf16_f32 v223, v230, v231
    s_add_u32 s12, s62, 393216
    buffer_store_dwordx4 v[220:223], v2, s[56:59], s12 offen offset:1024 sc1
    v_fma_f32 v240, -v24, v104, v240
    v_fma_f32 v241, -v24, v105, v241
    v_fma_f32 v242, -v24, v106, v242
    v_fma_f32 v243, -v24, v107, v243
    v_fma_f32 v248, -v24, v108, v248
    v_fma_f32 v249, -v24, v109, v249
    v_fma_f32 v250, -v24, v110, v250
    v_fma_f32 v251, -v24, v111, v251
    v_max_f32 v240, 0, v240
    v_max_f32 v241, 0, v241
    v_max_f32 v242, 0, v242
    v_max_f32 v243, 0, v243
    v_mul_f32 v240, v240, v248
    v_mul_f32 v241, v241, v249
    v_mul_f32 v242, v242, v250
    v_mul_f32 v243, v243, v251
    v_cvt_pk_bf16_f32 v248, v240, v241
    v_cvt_pk_bf16_f32 v249, v242, v243
    buffer_store_dwordx2 v[248:249], v3, s[76:79], s61 offen offset:0 sc1
    v_fma_f32 v244, -v25, v104, v244
    v_fma_f32 v245, -v25, v105, v245
    v_fma_f32 v246, -v25, v106, v246
    v_fma_f32 v247, -v25, v107, v247
    v_fma_f32 v252, -v25, v108, v252
    v_fma_f32 v253, -v25, v109, v253
    v_fma_f32 v254, -v25, v110, v254
    v_fma_f32 v255, -v25, v111, v255
    v_max_f32 v244, 0, v244
    v_max_f32 v245, 0, v245
    v_max_f32 v246, 0, v246
    v_max_f32 v247, 0, v247
    v_mul_f32 v244, v244, v252
    v_mul_f32 v245, v245, v253
    v_mul_f32 v246, v246, v254
    v_mul_f32 v247, v247, v255
    v_cvt_pk_bf16_f32 v252, v244, v245
    v_cvt_pk_bf16_f32 v253, v246, v247
    buffer_store_dwordx2 v[252:253], v3, s[76:79], s61 offen offset:512 sc1
    s_add_u32 s44, s42, 3145728
    s_addc_u32 s45, s43, 0
    s_and_b32 s45, s45, 0xffff
    s_mov_b32 s46, 18874368
    s_mov_b32 s47, 0x20000
    s_add_u32 s48, s42, 23068672
    s_addc_u32 s49, s43, 0
    s_and_b32 s49, s49, 0xffff
    s_mov_b32 s50, 18874368
    s_mov_b32 s51, 0x20000
    s_add_u32 s52, s42, 48234496
    s_addc_u32 s53, s43, 0
    s_and_b32 s53, s53, 0xffff
    s_mov_b32 s54, 2097152
    s_mov_b32 s55, 0x20000
    s_add_u32 s56, s42, 50331648
    s_addc_u32 s57, s43, 0
    s_and_b32 s57, s57, 0xffff
    s_mov_b32 s58, 2097152
    s_mov_b32 s59, 0x20000
    s_lshl_b32 s63, s4, 18
    v_lshrrev_b32 v10, 2, v1
    v_and_b32 v11, 3, v1
    v_mul_u32_u24 v4, 288, v10
    v_lshl_add_u32 v4, v11, 3, v4
    s_xor_b32 s13, s10, 1
    s_lshl_b32 s13, s13, 8
    v_add_u32 v7, s13, v4
    s_lshl_b32 s12, s10, 5
    v_add_u32 v4, s12, v4
    v_add_u32 v5, 55296, v4
    v_add_u32 v8, 55296, v7
    v_add_u32 v6, 110592, v4
    v_add_u32 v9, 110592, v7
    ds_read_b64_tr_b16 v[88:89], v5 offset:18432
    ds_read_b64_tr_b16 v[90:91], v5 offset:23040
    ds_read_b64_tr_b16 v[92:93], v5 offset:18464
    ds_read_b64_tr_b16 v[94:95], v5 offset:23072
    ds_read_b64_tr_b16 v[96:97], v5 offset:18496
    ds_read_b64_tr_b16 v[98:99], v5 offset:23104
    ds_read_b64_tr_b16 v[100:101], v5 offset:18528
    ds_read_b64_tr_b16 v[102:103], v5 offset:23136
    ds_read_b64_tr_b16 v[104:105], v5 offset:18560
    ds_read_b64_tr_b16 v[106:107], v5 offset:23168
    s_waitcnt lgkmcnt(8)
    v_mfma_f32_16x16x32_bf16 v[16:19], v[88:91], v[120:123], 0
    ds_read_b64_tr_b16 v[108:109], v5 offset:18592
    v_mfma_f32_16x16x32_bf16 v[20:23], v[88:91], v[124:127], 0
    ds_read_b64_tr_b16 v[110:111], v5 offset:23200
    s_waitcnt lgkmcnt(8)
    v_mfma_f32_16x16x32_bf16 v[24:27], v[92:95], v[120:123], 0
    ds_read_b64_tr_b16 v[88:89], v5 offset:18624
    v_mfma_f32_16x16x32_bf16 v[28:31], v[92:95], v[124:127], 0
    ds_read_b64_tr_b16 v[90:91], v5 offset:23232
    s_waitcnt lgkmcnt(8)
    v_mfma_f32_16x16x32_bf16 v[32:35], v[96:99], v[120:123], 0
    ds_read_b64_tr_b16 v[92:93], v5 offset:18656
    v_mfma_f32_16x16x32_bf16 v[36:39], v[96:99], v[124:127], 0
    ds_read_b64_tr_b16 v[94:95], v5 offset:23264
    s_waitcnt lgkmcnt(8)
    v_mfma_f32_16x16x32_bf16 v[40:43], v[100:103], v[120:123], 0
    ds_read_b64_tr_b16 v[96:97], v8 offset:18432
    v_mfma_f32_16x16x32_bf16 v[44:47], v[100:103], v[124:127], 0
    ds_read_b64_tr_b16 v[98:99], v8 offset:23040
    s_waitcnt lgkmcnt(8)
    v_mfma_f32_16x16x32_bf16 v[48:51], v[104:107], v[120:123], 0
    ds_read_b64_tr_b16 v[100:101], v5 offset:27648
    v_mfma_f32_16x16x32_bf16 v[52:55], v[104:107], v[124:127], 0
    ds_read_b64_tr_b16 v[102:103], v5 offset:32256
    s_waitcnt lgkmcnt(8)
    v_mfma_f32_16x16x32_bf16 v[56:59], v[108:111], v[120:123], 0
    ds_read_b64_tr_b16 v[104:105], v5 offset:27680
    v_mfma_f32_16x16x32_bf16 v[60:63], v[108:111], v[124:127], 0
    ds_read_b64_tr_b16 v[106:107], v5 offset:32288
    s_waitcnt lgkmcnt(8)
    v_mfma_f32_16x16x32_bf16 v[64:67], v[88:91], v[120:123], 0
    ds_read_b64_tr_b16 v[108:109], v5 offset:27712
    v_mfma_f32_16x16x32_bf16 v[68:71], v[88:91], v[124:127], 0
    ds_read_b64_tr_b16 v[110:111], v5 offset:32320
    s_waitcnt lgkmcnt(8)
    v_mfma_f32_16x16x32_bf16 v[72:75], v[92:95], v[120:123], 0
    ds_read_b64_tr_b16 v[88:89], v5 offset:27744
    v_mfma_f32_16x16x32_bf16 v[76:79], v[92:95], v[124:127], 0
    ds_read_b64_tr_b16 v[90:91], v5 offset:32352
    s_waitcnt lgkmcnt(8)
    v_mfma_f32_16x16x32_bf16 v[80:83], v[96:99], v[120:123], 0
    ds_read_b64_tr_b16 v[92:93], v5 offset:27776
    v_mfma_f32_16x16x32_bf16 v[84:87], v[96:99], v[124:127], 0
    ds_read_b64_tr_b16 v[94:95], v5 offset:32384
    s_waitcnt lgkmcnt(8)
    v_mfma_f32_16x16x32_bf16 v[16:19], v[100:103], v[152:155], v[16:19]
    ds_read_b64_tr_b16 v[96:97], v5 offset:27808
    v_mfma_f32_16x16x32_bf16 v[20:23], v[100:103], v[156:159], v[20:23]
    ds_read_b64_tr_b16 v[98:99], v5 offset:32416
    s_waitcnt lgkmcnt(8)
    v_mfma_f32_16x16x32_bf16 v[24:27], v[104:107], v[152:155], v[24:27]
    ds_read_b64_tr_b16 v[100:101], v5 offset:27840
    v_mfma_f32_16x16x32_bf16 v[28:31], v[104:107], v[156:159], v[28:31]
    ds_read_b64_tr_b16 v[102:103], v5 offset:32448
    s_waitcnt lgkmcnt(8)
    v_mfma_f32_16x16x32_bf16 v[32:35], v[108:111], v[152:155], v[32:35]
    ds_read_b64_tr_b16 v[104:105], v5 offset:27872
    v_mfma_f32_16x16x32_bf16 v[36:39], v[108:111], v[156:159], v[36:39]
    ds_read_b64_tr_b16 v[106:107], v5 offset:32480
    s_waitcnt lgkmcnt(8)
    v_mfma_f32_16x16x32_bf16 v[40:43], v[88:91], v[152:155], v[40:43]
    ds_read_b64_tr_b16 v[108:109], v8 offset:27648
    v_mfma_f32_16x16x32_bf16 v[44:47], v[88:91], v[156:159], v[44:47]
    ds_read_b64_tr_b16 v[110:111], v8 offset:32256
    s_waitcnt lgkmcnt(8)
    v_mfma_f32_16x16x32_bf16 v[48:51], v[92:95], v[152:155], v[48:51]
    ds_read_b64_tr_b16 v[88:89], v5 offset:36864
    v_mfma_f32_16x16x32_bf16 v[52:55], v[92:95], v[156:159], v[52:55]
    ds_read_b64_tr_b16 v[90:91], v5 offset:41472
    s_waitcnt lgkmcnt(8)
    v_mfma_f32_16x16x32_bf16 v[56:59], v[96:99], v[152:155], v[56:59]
    ds_read_b64_tr_b16 v[92:93], v5 offset:36896
    v_mfma_f32_16x16x32_bf16 v[60:63], v[96:99], v[156:159], v[60:63]
    ds_read_b64_tr_b16 v[94:95], v5 offset:41504
    s_waitcnt lgkmcnt(8)
    v_mfma_f32_16x16x32_bf16 v[64:67], v[100:103], v[152:155], v[64:67]
    ds_read_b64_tr_b16 v[96:97], v5 offset:36928
    v_mfma_f32_16x16x32_bf16 v[68:71], v[100:103], v[156:159], v[68:71]
    ds_read_b64_tr_b16 v[98:99], v5 offset:41536
    s_waitcnt lgkmcnt(8)
    v_mfma_f32_16x16x32_bf16 v[72:75], v[104:107], v[152:155], v[72:75]
    ds_read_b64_tr_b16 v[100:101], v5 offset:36960
    v_mfma_f32_16x16x32_bf16 v[76:79], v[104:107], v[156:159], v[76:79]
    ds_read_b64_tr_b16 v[102:103], v5 offset:41568
    s_waitcnt lgkmcnt(8)
    v_mfma_f32_16x16x32_bf16 v[80:83], v[108:111], v[152:155], v[80:83]
    ds_read_b64_tr_b16 v[104:105], v5 offset:36992
    v_mfma_f32_16x16x32_bf16 v[84:87], v[108:111], v[156:159], v[84:87]
    ds_read_b64_tr_b16 v[106:107], v5 offset:41600
    s_waitcnt vmcnt(0)
    s_barrier
    s_cmp_eq_u32 s3, 0
    s_cbranch_scc0 sequential_preLN__ssm_conv_s4d__glu_gated_reglu__prompt_kernel_sh28
    s_lshl_b32 s12, s6, 3
    s_add_u32 s12, s12, s4
    s_lshl_b32 s12, s12, 7
    s_add_u32 s12, s12, 8192
    s_mov_b64 exec, 1
    v_mov_b32 v10, s12
    v_mov_b32 v11, 1
    global_atomic_add v10, v11, s[42:43] sc1
    s_mov_b64 exec, -1
sequential_preLN__ssm_conv_s4d__glu_gated_reglu__prompt_kernel_sh28:
    s_add_u32 m0, s80, 73728
    s_mov_b32 s81, 147456
    buffer_load_dwordx4 v12, s[72:75], s81 offen lds
    s_add_u32 m0, s80, 81920
    s_nop 0
    buffer_load_dwordx4 v15, s[72:75], s81 offen lds
    s_add_u32 m0, s83, 90112
    s_mov_b32 s81, 442368
    s_mov_b64 exec, 0xffff
    buffer_load_dwordx4 v14, s[72:75], s81 offen lds
    s_mov_b64 exec, -1
    s_waitcnt lgkmcnt(8)
    v_mfma_f32_16x16x32_bf16 v[16:19], v[88:91], v[184:187], v[16:19]
    ds_read_b64_tr_b16 v[108:109], v5 offset:37024
    v_mfma_f32_16x16x32_bf16 v[20:23], v[88:91], v[188:191], v[20:23]
    ds_read_b64_tr_b16 v[110:111], v5 offset:41632
    s_waitcnt lgkmcnt(8)
    v_mfma_f32_16x16x32_bf16 v[24:27], v[92:95], v[184:187], v[24:27]
    ds_read_b64_tr_b16 v[88:89], v5 offset:37056
    v_mfma_f32_16x16x32_bf16 v[28:31], v[92:95], v[188:191], v[28:31]
    ds_read_b64_tr_b16 v[90:91], v5 offset:41664
    s_waitcnt lgkmcnt(8)
    v_mfma_f32_16x16x32_bf16 v[32:35], v[96:99], v[184:187], v[32:35]
    ds_read_b64_tr_b16 v[92:93], v5 offset:37088
    v_mfma_f32_16x16x32_bf16 v[36:39], v[96:99], v[188:191], v[36:39]
    ds_read_b64_tr_b16 v[94:95], v5 offset:41696
    s_waitcnt lgkmcnt(8)
    v_mfma_f32_16x16x32_bf16 v[40:43], v[100:103], v[184:187], v[40:43]
    ds_read_b64_tr_b16 v[96:97], v8 offset:36864
    v_mfma_f32_16x16x32_bf16 v[44:47], v[100:103], v[188:191], v[44:47]
    ds_read_b64_tr_b16 v[98:99], v8 offset:41472
    s_waitcnt lgkmcnt(8)
    v_mfma_f32_16x16x32_bf16 v[48:51], v[104:107], v[184:187], v[48:51]
    ds_read_b64_tr_b16 v[100:101], v5 offset:46080
    v_mfma_f32_16x16x32_bf16 v[52:55], v[104:107], v[188:191], v[52:55]
    ds_read_b64_tr_b16 v[102:103], v5 offset:50688
    s_waitcnt lgkmcnt(8)
    v_mfma_f32_16x16x32_bf16 v[56:59], v[108:111], v[184:187], v[56:59]
    ds_read_b64_tr_b16 v[104:105], v5 offset:46112
    v_mfma_f32_16x16x32_bf16 v[60:63], v[108:111], v[188:191], v[60:63]
    ds_read_b64_tr_b16 v[106:107], v5 offset:50720
    s_waitcnt lgkmcnt(8)
    v_mfma_f32_16x16x32_bf16 v[64:67], v[88:91], v[184:187], v[64:67]
    ds_read_b64_tr_b16 v[108:109], v5 offset:46144
    v_mfma_f32_16x16x32_bf16 v[68:71], v[88:91], v[188:191], v[68:71]
    ds_read_b64_tr_b16 v[110:111], v5 offset:50752
    s_waitcnt lgkmcnt(8)
    v_mfma_f32_16x16x32_bf16 v[72:75], v[92:95], v[184:187], v[72:75]
    ds_read_b64_tr_b16 v[88:89], v5 offset:46176
    v_mfma_f32_16x16x32_bf16 v[76:79], v[92:95], v[188:191], v[76:79]
    ds_read_b64_tr_b16 v[90:91], v5 offset:50784
    s_waitcnt lgkmcnt(8)
    v_mfma_f32_16x16x32_bf16 v[80:83], v[96:99], v[184:187], v[80:83]
    ds_read_b64_tr_b16 v[92:93], v5 offset:46208
    v_mfma_f32_16x16x32_bf16 v[84:87], v[96:99], v[188:191], v[84:87]
    ds_read_b64_tr_b16 v[94:95], v5 offset:50816
    s_waitcnt lgkmcnt(8)
    v_mfma_f32_16x16x32_bf16 v[16:19], v[100:103], v[216:219], v[16:19]
    ds_read_b64_tr_b16 v[96:97], v5 offset:46240
    v_mfma_f32_16x16x32_bf16 v[20:23], v[100:103], v[220:223], v[20:23]
    ds_read_b64_tr_b16 v[98:99], v5 offset:50848
    s_waitcnt lgkmcnt(8)
    v_mfma_f32_16x16x32_bf16 v[24:27], v[104:107], v[216:219], v[24:27]
    ds_read_b64_tr_b16 v[100:101], v5 offset:46272
    v_mfma_f32_16x16x32_bf16 v[28:31], v[104:107], v[220:223], v[28:31]
    ds_read_b64_tr_b16 v[102:103], v5 offset:50880
    s_waitcnt lgkmcnt(8)
    v_mfma_f32_16x16x32_bf16 v[32:35], v[108:111], v[216:219], v[32:35]
    ds_read_b64_tr_b16 v[104:105], v5 offset:46304
    v_mfma_f32_16x16x32_bf16 v[36:39], v[108:111], v[220:223], v[36:39]
    ds_read_b64_tr_b16 v[106:107], v5 offset:50912
    s_waitcnt lgkmcnt(8)
    v_mfma_f32_16x16x32_bf16 v[40:43], v[88:91], v[216:219], v[40:43]
    ds_read_b64_tr_b16 v[108:109], v8 offset:46080
    v_mfma_f32_16x16x32_bf16 v[44:47], v[88:91], v[220:223], v[44:47]
    ds_read_b64_tr_b16 v[110:111], v8 offset:50688
    s_waitcnt lgkmcnt(8)
    v_mfma_f32_16x16x32_bf16 v[48:51], v[92:95], v[216:219], v[48:51]
    ds_read_b64_tr_b16 v[88:89], v6 offset:0
    v_mfma_f32_16x16x32_bf16 v[52:55], v[92:95], v[220:223], v[52:55]
    ds_read_b64_tr_b16 v[90:91], v6 offset:4608
    s_waitcnt lgkmcnt(8)
    v_mfma_f32_16x16x32_bf16 v[56:59], v[96:99], v[216:219], v[56:59]
    ds_read_b64_tr_b16 v[92:93], v6 offset:32
    v_mfma_f32_16x16x32_bf16 v[60:63], v[96:99], v[220:223], v[60:63]
    ds_read_b64_tr_b16 v[94:95], v6 offset:4640
    s_waitcnt lgkmcnt(8)
    v_mfma_f32_16x16x32_bf16 v[64:67], v[100:103], v[216:219], v[64:67]
    ds_read_b64_tr_b16 v[96:97], v6 offset:64
    v_mfma_f32_16x16x32_bf16 v[68:71], v[100:103], v[220:223], v[68:71]
    ds_read_b64_tr_b16 v[98:99], v6 offset:4672
    s_waitcnt lgkmcnt(8)
    v_mfma_f32_16x16x32_bf16 v[72:75], v[104:107], v[216:219], v[72:75]
    ds_read_b64_tr_b16 v[100:101], v6 offset:96
    v_mfma_f32_16x16x32_bf16 v[76:79], v[104:107], v[220:223], v[76:79]
    ds_read_b64_tr_b16 v[102:103], v6 offset:4704
    s_waitcnt lgkmcnt(8)
    v_mfma_f32_16x16x32_bf16 v[80:83], v[108:111], v[216:219], v[80:83]
    ds_read_b64_tr_b16 v[104:105], v6 offset:128
    v_mfma_f32_16x16x32_bf16 v[84:87], v[108:111], v[220:223], v[84:87]
    ds_read_b64_tr_b16 v[106:107], v6 offset:4736
    s_cmp_eq_u32 s3, 0
    s_cbranch_scc0 sequential_preLN__ssm_conv_s4d__glu_gated_reglu__prompt_kernel_sh229
    s_lshl_b32 s12, s6, 3
    s_add_u32 s12, s12, s4
    s_lshl_b32 s12, s12, 7
    s_add_u32 s12, s12, 8192
    s_mov_b64 exec, 1
    v_mov_b32 v10, s12
    s_mov_b32 s60, 0
sequential_preLN__ssm_conv_s4d__glu_gated_reglu__prompt_kernel_pollh30:
    global_load_dword v11, v10, s[42:43] sc1
    s_add_u32 s60, s60, 1
    s_waitcnt vmcnt(0)
    v_cmp_gt_u32 vcc, 4, v11
    s_cmp_eq_u64 vcc, 0
    s_cbranch_scc1 sequential_preLN__ssm_conv_s4d__glu_gated_reglu__prompt_kernel_pdoneh31
    s_cmp_ge_u32 s60, 0x200000
    s_cbranch_scc1 sequential_preLN__ssm_conv_s4d__glu_gated_reglu__prompt_kernel_pdoneh31
    s_sleep 1
    s_branch sequential_preLN__ssm_conv_s4d__glu_gated_reglu__prompt_kernel_pollh30
sequential_preLN__ssm_conv_s4d__glu_gated_reglu__prompt_kernel_pdoneh31:
    s_mov_b64 exec, -1
sequential_preLN__ssm_conv_s4d__glu_gated_reglu__prompt_kernel_sh229:
    s_barrier
    s_add_u32 s12, s68, 0
    buffer_load_dwordx4 v[112:115], v2, s[44:47], s12 offen sc1
    buffer_load_dwordx4 v[116:119], v2, s[44:47], s12 offen offset:1024 sc1
    s_add_u32 s12, s68, 131072
    buffer_load_dwordx4 v[128:131], v2, s[44:47], s12 offen sc1
    buffer_load_dwordx4 v[132:135], v2, s[44:47], s12 offen offset:1024 sc1
    s_add_u32 s12, s68, 262144
    buffer_load_dwordx4 v[136:139], v2, s[44:47], s12 offen sc1
    buffer_load_dwordx4 v[140:143], v2, s[44:47], s12 offen offset:1024 sc1
    s_add_u32 s12, s68, 393216
    buffer_load_dwordx4 v[144:147], v2, s[44:47], s12 offen sc1
    buffer_load_dwordx4 v[148:151], v2, s[44:47], s12 offen offset:1024 sc1
    s_waitcnt vmcnt(6)
    s_waitcnt lgkmcnt(8)
    v_mfma_f32_16x16x32_bf16 v[16:19], v[88:91], v[112:115], v[16:19]
    ds_read_b64_tr_b16 v[108:109], v6 offset:160
    v_mfma_f32_16x16x32_bf16 v[20:23], v[88:91], v[116:119], v[20:23]
    ds_read_b64_tr_b16 v[110:111], v6 offset:4768
    s_waitcnt lgkmcnt(8)
    v_mfma_f32_16x16x32_bf16 v[24:27], v[92:95], v[112:115], v[24:27]
    ds_read_b64_tr_b16 v[88:89], v6 offset:192
    v_mfma_f32_16x16x32_bf16 v[28:31], v[92:95], v[116:119], v[28:31]
    ds_read_b64_tr_b16 v[90:91], v6 offset:4800
    s_add_u32 s12, s69, 0
    buffer_load_dwordx4 v[160:163], v2, s[44:47], s12 offen sc1
    buffer_load_dwordx4 v[164:167], v2, s[44:47], s12 offen offset:1024 sc1
    s_waitcnt lgkmcnt(8)
    v_mfma_f32_16x16x32_bf16 v[32:35], v[96:99], v[112:115], v[32:35]
    ds_read_b64_tr_b16 v[92:93], v6 offset:224
    v_mfma_f32_16x16x32_bf16 v[36:39], v[96:99], v[116:119], v[36:39]
    ds_read_b64_tr_b16 v[94:95], v6 offset:4832
    s_waitcnt lgkmcnt(8)
    v_mfma_f32_16x16x32_bf16 v[40:43], v[100:103], v[112:115], v[40:43]
    ds_read_b64_tr_b16 v[96:97], v9 offset:0
    v_mfma_f32_16x16x32_bf16 v[44:47], v[100:103], v[116:119], v[44:47]
    ds_read_b64_tr_b16 v[98:99], v9 offset:4608
    s_waitcnt lgkmcnt(8)
    v_mfma_f32_16x16x32_bf16 v[48:51], v[104:107], v[112:115], v[48:51]
    ds_read_b64_tr_b16 v[100:101], v6 offset:9216
    v_mfma_f32_16x16x32_bf16 v[52:55], v[104:107], v[116:119], v[52:55]
    ds_read_b64_tr_b16 v[102:103], v6 offset:13824
    s_add_u32 s12, s69, 131072
    buffer_load_dwordx4 v[168:171], v2, s[44:47], s12 offen sc1
    buffer_load_dwordx4 v[172:175], v2, s[44:47], s12 offen offset:1024 sc1
    s_waitcnt lgkmcnt(8)
    v_mfma_f32_16x16x32_bf16 v[56:59], v[108:111], v[112:115], v[56:59]
    ds_read_b64_tr_b16 v[104:105], v6 offset:9248
    v_mfma_f32_16x16x32_bf16 v[60:63], v[108:111], v[116:119], v[60:63]
    ds_read_b64_tr_b16 v[106:107], v6 offset:13856
    s_waitcnt lgkmcnt(8)
    v_mfma_f32_16x16x32_bf16 v[64:67], v[88:91], v[112:115], v[64:67]
    ds_read_b64_tr_b16 v[108:109], v6 offset:9280
    v_mfma_f32_16x16x32_bf16 v[68:71], v[88:91], v[116:119], v[68:71]
    ds_read_b64_tr_b16 v[110:111], v6 offset:13888
    s_waitcnt lgkmcnt(8)
    v_mfma_f32_16x16x32_bf16 v[72:75], v[92:95], v[112:115], v[72:75]
    ds_read_b64_tr_b16 v[88:89], v6 offset:9312
    v_mfma_f32_16x16x32_bf16 v[76:79], v[92:95], v[116:119], v[76:79]
    ds_read_b64_tr_b16 v[90:91], v6 offset:13920
    s_add_u32 s12, s69, 262144
    buffer_load_dwordx4 v[176:179], v2, s[44:47], s12 offen sc1
    buffer_load_dwordx4 v[180:183], v2, s[44:47], s12 offen offset:1024 sc1
    s_waitcnt lgkmcnt(8)
    v_mfma_f32_16x16x32_bf16 v[80:83], v[96:99], v[112:115], v[80:83]
    ds_read_b64_tr_b16 v[92:93], v6 offset:9344
    v_mfma_f32_16x16x32_bf16 v[84:87], v[96:99], v[116:119], v[84:87]
    ds_read_b64_tr_b16 v[94:95], v6 offset:13952
    s_waitcnt vmcnt(10)
    s_waitcnt lgkmcnt(8)
    v_mfma_f32_16x16x32_bf16 v[16:19], v[100:103], v[128:131], v[16:19]
    ds_read_b64_tr_b16 v[96:97], v6 offset:9376
    v_mfma_f32_16x16x32_bf16 v[20:23], v[100:103], v[132:135], v[20:23]
    ds_read_b64_tr_b16 v[98:99], v6 offset:13984
    s_waitcnt lgkmcnt(8)
    v_mfma_f32_16x16x32_bf16 v[24:27], v[104:107], v[128:131], v[24:27]
    ds_read_b64_tr_b16 v[100:101], v6 offset:9408
    v_mfma_f32_16x16x32_bf16 v[28:31], v[104:107], v[132:135], v[28:31]
    ds_read_b64_tr_b16 v[102:103], v6 offset:14016
    s_add_u32 s12, s69, 393216
    buffer_load_dwordx4 v[192:195], v2, s[44:47], s12 offen sc1
    buffer_load_dwordx4 v[196:199], v2, s[44:47], s12 offen offset:1024 sc1
    s_waitcnt lgkmcnt(8)
    v_mfma_f32_16x16x32_bf16 v[32:35], v[108:111], v[128:131], v[32:35]
    ds_read_b64_tr_b16 v[104:105], v6 offset:9440
    v_mfma_f32_16x16x32_bf16 v[36:39], v[108:111], v[132:135], v[36:39]
    ds_read_b64_tr_b16 v[106:107], v6 offset:14048
    s_waitcnt lgkmcnt(8)
    v_mfma_f32_16x16x32_bf16 v[40:43], v[88:91], v[128:131], v[40:43]
    ds_read_b64_tr_b16 v[108:109], v9 offset:9216
    v_mfma_f32_16x16x32_bf16 v[44:47], v[88:91], v[132:135], v[44:47]
    ds_read_b64_tr_b16 v[110:111], v9 offset:13824
    s_waitcnt lgkmcnt(8)
    v_mfma_f32_16x16x32_bf16 v[48:51], v[92:95], v[128:131], v[48:51]
    ds_read_b64_tr_b16 v[88:89], v6 offset:18432
    v_mfma_f32_16x16x32_bf16 v[52:55], v[92:95], v[132:135], v[52:55]
    ds_read_b64_tr_b16 v[90:91], v6 offset:23040
    s_add_u32 s12, s70, 0
    buffer_load_dwordx4 v[200:203], v2, s[44:47], s12 offen sc1
    buffer_load_dwordx4 v[204:207], v2, s[44:47], s12 offen offset:1024 sc1
    s_waitcnt lgkmcnt(8)
    v_mfma_f32_16x16x32_bf16 v[56:59], v[96:99], v[128:131], v[56:59]
    ds_read_b64_tr_b16 v[92:93], v6 offset:18464
    v_mfma_f32_16x16x32_bf16 v[60:63], v[96:99], v[132:135], v[60:63]
    ds_read_b64_tr_b16 v[94:95], v6 offset:23072
    s_waitcnt lgkmcnt(8)
    v_mfma_f32_16x16x32_bf16 v[64:67], v[100:103], v[128:131], v[64:67]
    ds_read_b64_tr_b16 v[96:97], v6 offset:18496
    v_mfma_f32_16x16x32_bf16 v[68:71], v[100:103], v[132:135], v[68:71]
    ds_read_b64_tr_b16 v[98:99], v6 offset:23104
    s_waitcnt lgkmcnt(8)
    v_mfma_f32_16x16x32_bf16 v[72:75], v[104:107], v[128:131], v[72:75]
    ds_read_b64_tr_b16 v[100:101], v6 offset:18528
    v_mfma_f32_16x16x32_bf16 v[76:79], v[104:107], v[132:135], v[76:79]
    ds_read_b64_tr_b16 v[102:103], v6 offset:23136
    s_add_u32 s12, s70, 131072
    buffer_load_dwordx4 v[208:211], v2, s[44:47], s12 offen sc1
    buffer_load_dwordx4 v[212:215], v2, s[44:47], s12 offen offset:1024 sc1
    s_waitcnt lgkmcnt(8)
    v_mfma_f32_16x16x32_bf16 v[80:83], v[108:111], v[128:131], v[80:83]
    ds_read_b64_tr_b16 v[104:105], v6 offset:18560
    v_mfma_f32_16x16x32_bf16 v[84:87], v[108:111], v[132:135], v[84:87]
    ds_read_b64_tr_b16 v[106:107], v6 offset:23168
    s_waitcnt vmcnt(14)
    s_waitcnt lgkmcnt(8)
    v_mfma_f32_16x16x32_bf16 v[16:19], v[88:91], v[136:139], v[16:19]
    ds_read_b64_tr_b16 v[108:109], v6 offset:18592
    v_mfma_f32_16x16x32_bf16 v[20:23], v[88:91], v[140:143], v[20:23]
    ds_read_b64_tr_b16 v[110:111], v6 offset:23200
    s_waitcnt lgkmcnt(8)
    v_mfma_f32_16x16x32_bf16 v[24:27], v[92:95], v[136:139], v[24:27]
    ds_read_b64_tr_b16 v[88:89], v6 offset:18624
    v_mfma_f32_16x16x32_bf16 v[28:31], v[92:95], v[140:143], v[28:31]
    ds_read_b64_tr_b16 v[90:91], v6 offset:23232
    s_add_u32 s12, s70, 262144
    buffer_load_dwordx4 v[224:227], v2, s[44:47], s12 offen sc1
    buffer_load_dwordx4 v[228:231], v2, s[44:47], s12 offen offset:1024 sc1
    s_waitcnt lgkmcnt(8)
    v_mfma_f32_16x16x32_bf16 v[32:35], v[96:99], v[136:139], v[32:35]
    ds_read_b64_tr_b16 v[92:93], v6 offset:18656
    v_mfma_f32_16x16x32_bf16 v[36:39], v[96:99], v[140:143], v[36:39]
    ds_read_b64_tr_b16 v[94:95], v6 offset:23264
    s_waitcnt lgkmcnt(8)
    v_mfma_f32_16x16x32_bf16 v[40:43], v[100:103], v[136:139], v[40:43]
    ds_read_b64_tr_b16 v[96:97], v9 offset:18432
    v_mfma_f32_16x16x32_bf16 v[44:47], v[100:103], v[140:143], v[44:47]
    ds_read_b64_tr_b16 v[98:99], v9 offset:23040
    s_waitcnt lgkmcnt(8)
    v_mfma_f32_16x16x32_bf16 v[48:51], v[104:107], v[136:139], v[48:51]
    ds_read_b64_tr_b16 v[100:101], v6 offset:27648
    v_mfma_f32_16x16x32_bf16 v[52:55], v[104:107], v[140:143], v[52:55]
    ds_read_b64_tr_b16 v[102:103], v6 offset:32256
    s_add_u32 s12, s70, 393216
    buffer_load_dwordx4 v[232:235], v2, s[44:47], s12 offen sc1
    buffer_load_dwordx4 v[236:239], v2, s[44:47], s12 offen offset:1024 sc1
    s_waitcnt lgkmcnt(8)
    v_mfma_f32_16x16x32_bf16 v[56:59], v[108:111], v[136:139], v[56:59]
    ds_read_b64_tr_b16 v[104:105], v6 offset:27680
    v_mfma_f32_16x16x32_bf16 v[60:63], v[108:111], v[140:143], v[60:63]
    ds_read_b64_tr_b16 v[106:107], v6 offset:32288
    s_waitcnt lgkmcnt(8)
    v_mfma_f32_16x16x32_bf16 v[64:67], v[88:91], v[136:139], v[64:67]
    ds_read_b64_tr_b16 v[108:109], v6 offset:27712
    v_mfma_f32_16x16x32_bf16 v[68:71], v[88:91], v[140:143], v[68:71]
    ds_read_b64_tr_b16 v[110:111], v6 offset:32320
    s_waitcnt lgkmcnt(8)
    v_mfma_f32_16x16x32_bf16 v[72:75], v[92:95], v[136:139], v[72:75]
    ds_read_b64_tr_b16 v[88:89], v6 offset:27744
    v_mfma_f32_16x16x32_bf16 v[76:79], v[92:95], v[140:143], v[76:79]
    ds_read_b64_tr_b16 v[90:91], v6 offset:32352
    s_add_u32 s12, s63, 0
    s_add_u32 s13, s63, 65536
    buffer_load_dwordx2 v[240:241], v3, s[52:55], s12 offen offset:0 sc1
    buffer_load_dwordx2 v[242:243], v3, s[52:55], s13 offen offset:0 sc1
    buffer_load_dwordx2 v[244:245], v3, s[52:55], s12 offen offset:512 sc1
    buffer_load_dwordx2 v[246:247], v3, s[52:55], s13 offen offset:512 sc1
    s_waitcnt lgkmcnt(8)
    v_mfma_f32_16x16x32_bf16 v[80:83], v[96:99], v[136:139], v[80:83]
    ds_read_b64_tr_b16 v[92:93], v6 offset:27776
    v_mfma_f32_16x16x32_bf16 v[84:87], v[96:99], v[140:143], v[84:87]
    ds_read_b64_tr_b16 v[94:95], v6 offset:32384
    s_waitcnt vmcnt(20)
    s_waitcnt lgkmcnt(8)
    v_mfma_f32_16x16x32_bf16 v[16:19], v[100:103], v[144:147], v[16:19]
    ds_read_b64_tr_b16 v[96:97], v6 offset:27808
    v_mfma_f32_16x16x32_bf16 v[20:23], v[100:103], v[148:151], v[20:23]
    ds_read_b64_tr_b16 v[98:99], v6 offset:32416
    s_waitcnt lgkmcnt(8)
    v_mfma_f32_16x16x32_bf16 v[24:27], v[104:107], v[144:147], v[24:27]
    ds_read_b64_tr_b16 v[100:101], v6 offset:27840
    v_mfma_f32_16x16x32_bf16 v[28:31], v[104:107], v[148:151], v[28:31]
    ds_read_b64_tr_b16 v[102:103], v6 offset:32448
    s_add_u32 s12, s63, 131072
    s_add_u32 s13, s63, 196608
    buffer_load_dwordx2 v[248:249], v3, s[52:55], s12 offen offset:0 sc1
    buffer_load_dwordx2 v[250:251], v3, s[52:55], s13 offen offset:0 sc1
    buffer_load_dwordx2 v[252:253], v3, s[52:55], s12 offen offset:512 sc1
    buffer_load_dwordx2 v[254:255], v3, s[52:55], s13 offen offset:512 sc1
    s_waitcnt lgkmcnt(8)
    v_mfma_f32_16x16x32_bf16 v[32:35], v[108:111], v[144:147], v[32:35]
    ds_read_b64_tr_b16 v[104:105], v6 offset:27872
    v_mfma_f32_16x16x32_bf16 v[36:39], v[108:111], v[148:151], v[36:39]
    ds_read_b64_tr_b16 v[106:107], v6 offset:32480
    s_waitcnt lgkmcnt(8)
    v_mfma_f32_16x16x32_bf16 v[40:43], v[88:91], v[144:147], v[40:43]
    ds_read_b64_tr_b16 v[108:109], v9 offset:27648
    v_mfma_f32_16x16x32_bf16 v[44:47], v[88:91], v[148:151], v[44:47]
    ds_read_b64_tr_b16 v[110:111], v9 offset:32256
    s_waitcnt lgkmcnt(8)
    v_mfma_f32_16x16x32_bf16 v[48:51], v[92:95], v[144:147], v[48:51]
    ds_read_b64_tr_b16 v[88:89], v4 offset:0
    v_mfma_f32_16x16x32_bf16 v[52:55], v[92:95], v[148:151], v[52:55]
    ds_read_b64_tr_b16 v[90:91], v4 offset:4608
    s_waitcnt lgkmcnt(8)
    v_mfma_f32_16x16x32_bf16 v[56:59], v[96:99], v[144:147], v[56:59]
    ds_read_b64_tr_b16 v[92:93], v4 offset:32
    v_mfma_f32_16x16x32_bf16 v[60:63], v[96:99], v[148:151], v[60:63]
    ds_read_b64_tr_b16 v[94:95], v4 offset:4640
    s_waitcnt lgkmcnt(8)
    v_mfma_f32_16x16x32_bf16 v[64:67], v[100:103], v[144:147], v[64:67]
    ds_read_b64_tr_b16 v[96:97], v4 offset:64
    v_mfma_f32_16x16x32_bf16 v[68:71], v[100:103], v[148:151], v[68:71]
    ds_read_b64_tr_b16 v[98:99], v4 offset:4672
    s_waitcnt lgkmcnt(8)
    v_mfma_f32_16x16x32_bf16 v[72:75], v[104:107], v[144:147], v[72:75]
    ds_read_b64_tr_b16 v[100:101], v4 offset:96
    v_mfma_f32_16x16x32_bf16 v[76:79], v[104:107], v[148:151], v[76:79]
    ds_read_b64_tr_b16 v[102:103], v4 offset:4704
    s_waitcnt lgkmcnt(8)
    v_mfma_f32_16x16x32_bf16 v[80:83], v[108:111], v[144:147], v[80:83]
    ds_read_b64_tr_b16 v[104:105], v4 offset:128
    v_mfma_f32_16x16x32_bf16 v[84:87], v[108:111], v[148:151], v[84:87]
    ds_read_b64_tr_b16 v[106:107], v4 offset:4736
    s_waitcnt vmcnt(22)
    s_waitcnt lgkmcnt(8)
    v_mfma_f32_16x16x32_bf16 v[16:19], v[88:91], v[160:163], v[16:19]
    ds_read_b64_tr_b16 v[108:109], v4 offset:160
    v_mfma_f32_16x16x32_bf16 v[20:23], v[88:91], v[164:167], v[20:23]
    ds_read_b64_tr_b16 v[110:111], v4 offset:4768
    s_waitcnt lgkmcnt(8)
    v_mfma_f32_16x16x32_bf16 v[24:27], v[92:95], v[160:163], v[24:27]
    ds_read_b64_tr_b16 v[88:89], v4 offset:192
    v_mfma_f32_16x16x32_bf16 v[28:31], v[92:95], v[164:167], v[28:31]
    ds_read_b64_tr_b16 v[90:91], v4 offset:4800
    s_waitcnt lgkmcnt(8)
    v_mfma_f32_16x16x32_bf16 v[32:35], v[96:99], v[160:163], v[32:35]
    ds_read_b64_tr_b16 v[92:93], v4 offset:224
    v_mfma_f32_16x16x32_bf16 v[36:39], v[96:99], v[164:167], v[36:39]
    ds_read_b64_tr_b16 v[94:95], v4 offset:4832
    s_waitcnt lgkmcnt(8)
    v_mfma_f32_16x16x32_bf16 v[40:43], v[100:103], v[160:163], v[40:43]
    ds_read_b64_tr_b16 v[96:97], v7 offset:0
    v_mfma_f32_16x16x32_bf16 v[44:47], v[100:103], v[164:167], v[44:47]
    ds_read_b64_tr_b16 v[98:99], v7 offset:4608
    s_waitcnt lgkmcnt(8)
    v_mfma_f32_16x16x32_bf16 v[48:51], v[104:107], v[160:163], v[48:51]
    ds_read_b64_tr_b16 v[100:101], v4 offset:9216
    v_mfma_f32_16x16x32_bf16 v[52:55], v[104:107], v[164:167], v[52:55]
    ds_read_b64_tr_b16 v[102:103], v4 offset:13824
    s_waitcnt lgkmcnt(8)
    v_mfma_f32_16x16x32_bf16 v[56:59], v[108:111], v[160:163], v[56:59]
    ds_read_b64_tr_b16 v[104:105], v4 offset:9248
    v_mfma_f32_16x16x32_bf16 v[60:63], v[108:111], v[164:167], v[60:63]
    ds_read_b64_tr_b16 v[106:107], v4 offset:13856
    s_waitcnt lgkmcnt(8)
    v_mfma_f32_16x16x32_bf16 v[64:67], v[88:91], v[160:163], v[64:67]
    ds_read_b64_tr_b16 v[108:109], v4 offset:9280
    v_mfma_f32_16x16x32_bf16 v[68:71], v[88:91], v[164:167], v[68:71]
    ds_read_b64_tr_b16 v[110:111], v4 offset:13888
    s_waitcnt lgkmcnt(8)
    v_mfma_f32_16x16x32_bf16 v[72:75], v[92:95], v[160:163], v[72:75]
    ds_read_b64_tr_b16 v[88:89], v4 offset:9312
    v_mfma_f32_16x16x32_bf16 v[76:79], v[92:95], v[164:167], v[76:79]
    ds_read_b64_tr_b16 v[90:91], v4 offset:13920
    s_waitcnt lgkmcnt(8)
    v_mfma_f32_16x16x32_bf16 v[80:83], v[96:99], v[160:163], v[80:83]
    ds_read_b64_tr_b16 v[92:93], v4 offset:9344
    v_mfma_f32_16x16x32_bf16 v[84:87], v[96:99], v[164:167], v[84:87]
    ds_read_b64_tr_b16 v[94:95], v4 offset:13952
    s_waitcnt vmcnt(20)
    s_waitcnt lgkmcnt(8)
    v_mfma_f32_16x16x32_bf16 v[16:19], v[100:103], v[168:171], v[16:19]
    ds_read_b64_tr_b16 v[96:97], v4 offset:9376
    v_mfma_f32_16x16x32_bf16 v[20:23], v[100:103], v[172:175], v[20:23]
    ds_read_b64_tr_b16 v[98:99], v4 offset:13984
    s_waitcnt lgkmcnt(8)
    v_mfma_f32_16x16x32_bf16 v[24:27], v[104:107], v[168:171], v[24:27]
    ds_read_b64_tr_b16 v[100:101], v4 offset:9408
    v_mfma_f32_16x16x32_bf16 v[28:31], v[104:107], v[172:175], v[28:31]
    ds_read_b64_tr_b16 v[102:103], v4 offset:14016
    s_waitcnt lgkmcnt(8)
    v_mfma_f32_16x16x32_bf16 v[32:35], v[108:111], v[168:171], v[32:35]
    ds_read_b64_tr_b16 v[104:105], v4 offset:9440
    v_mfma_f32_16x16x32_bf16 v[36:39], v[108:111], v[172:175], v[36:39]
    ds_read_b64_tr_b16 v[106:107], v4 offset:14048
    s_waitcnt lgkmcnt(8)
    v_mfma_f32_16x16x32_bf16 v[40:43], v[88:91], v[168:171], v[40:43]
    ds_read_b64_tr_b16 v[108:109], v7 offset:9216
    v_mfma_f32_16x16x32_bf16 v[44:47], v[88:91], v[172:175], v[44:47]
    ds_read_b64_tr_b16 v[110:111], v7 offset:13824
    s_waitcnt lgkmcnt(8)
    v_mfma_f32_16x16x32_bf16 v[48:51], v[92:95], v[168:171], v[48:51]
    ds_read_b64_tr_b16 v[88:89], v4 offset:18432
    v_mfma_f32_16x16x32_bf16 v[52:55], v[92:95], v[172:175], v[52:55]
    ds_read_b64_tr_b16 v[90:91], v4 offset:23040
    s_waitcnt lgkmcnt(8)
    v_mfma_f32_16x16x32_bf16 v[56:59], v[96:99], v[168:171], v[56:59]
    ds_read_b64_tr_b16 v[92:93], v4 offset:18464
    v_mfma_f32_16x16x32_bf16 v[60:63], v[96:99], v[172:175], v[60:63]
    ds_read_b64_tr_b16 v[94:95], v4 offset:23072
    s_waitcnt lgkmcnt(8)
    v_mfma_f32_16x16x32_bf16 v[64:67], v[100:103], v[168:171], v[64:67]
    ds_read_b64_tr_b16 v[96:97], v4 offset:18496
    v_mfma_f32_16x16x32_bf16 v[68:71], v[100:103], v[172:175], v[68:71]
    ds_read_b64_tr_b16 v[98:99], v4 offset:23104
    s_waitcnt lgkmcnt(8)
    v_mfma_f32_16x16x32_bf16 v[72:75], v[104:107], v[168:171], v[72:75]
    ds_read_b64_tr_b16 v[100:101], v4 offset:18528
    v_mfma_f32_16x16x32_bf16 v[76:79], v[104:107], v[172:175], v[76:79]
    ds_read_b64_tr_b16 v[102:103], v4 offset:23136
    s_waitcnt lgkmcnt(8)
    v_mfma_f32_16x16x32_bf16 v[80:83], v[108:111], v[168:171], v[80:83]
    ds_read_b64_tr_b16 v[104:105], v4 offset:18560
    v_mfma_f32_16x16x32_bf16 v[84:87], v[108:111], v[172:175], v[84:87]
    ds_read_b64_tr_b16 v[106:107], v4 offset:23168
    s_waitcnt vmcnt(18)
    s_waitcnt lgkmcnt(8)
    v_mfma_f32_16x16x32_bf16 v[16:19], v[88:91], v[176:179], v[16:19]
    ds_read_b64_tr_b16 v[108:109], v4 offset:18592
    v_mfma_f32_16x16x32_bf16 v[20:23], v[88:91], v[180:183], v[20:23]
    ds_read_b64_tr_b16 v[110:111], v4 offset:23200
    s_waitcnt lgkmcnt(8)
    v_mfma_f32_16x16x32_bf16 v[24:27], v[92:95], v[176:179], v[24:27]
    ds_read_b64_tr_b16 v[88:89], v4 offset:18624
    v_mfma_f32_16x16x32_bf16 v[28:31], v[92:95], v[180:183], v[28:31]
    ds_read_b64_tr_b16 v[90:91], v4 offset:23232
    s_waitcnt lgkmcnt(8)
    v_mfma_f32_16x16x32_bf16 v[32:35], v[96:99], v[176:179], v[32:35]
    ds_read_b64_tr_b16 v[92:93], v4 offset:18656
    v_mfma_f32_16x16x32_bf16 v[36:39], v[96:99], v[180:183], v[36:39]
    ds_read_b64_tr_b16 v[94:95], v4 offset:23264
    s_waitcnt lgkmcnt(8)
    v_mfma_f32_16x16x32_bf16 v[40:43], v[100:103], v[176:179], v[40:43]
    ds_read_b64_tr_b16 v[96:97], v7 offset:18432
    v_mfma_f32_16x16x32_bf16 v[44:47], v[100:103], v[180:183], v[44:47]
    ds_read_b64_tr_b16 v[98:99], v7 offset:23040
    s_waitcnt lgkmcnt(8)
    v_mfma_f32_16x16x32_bf16 v[48:51], v[104:107], v[176:179], v[48:51]
    ds_read_b64_tr_b16 v[100:101], v4 offset:27648
    v_mfma_f32_16x16x32_bf16 v[52:55], v[104:107], v[180:183], v[52:55]
    ds_read_b64_tr_b16 v[102:103], v4 offset:32256
    s_waitcnt lgkmcnt(8)
    v_mfma_f32_16x16x32_bf16 v[56:59], v[108:111], v[176:179], v[56:59]
    ds_read_b64_tr_b16 v[104:105], v4 offset:27680
    v_mfma_f32_16x16x32_bf16 v[60:63], v[108:111], v[180:183], v[60:63]
    ds_read_b64_tr_b16 v[106:107], v4 offset:32288
    s_waitcnt lgkmcnt(8)
    v_mfma_f32_16x16x32_bf16 v[64:67], v[88:91], v[176:179], v[64:67]
    ds_read_b64_tr_b16 v[108:109], v4 offset:27712
    v_mfma_f32_16x16x32_bf16 v[68:71], v[88:91], v[180:183], v[68:71]
    ds_read_b64_tr_b16 v[110:111], v4 offset:32320
    s_waitcnt lgkmcnt(8)
    v_mfma_f32_16x16x32_bf16 v[72:75], v[92:95], v[176:179], v[72:75]
    ds_read_b64_tr_b16 v[88:89], v4 offset:27744
    v_mfma_f32_16x16x32_bf16 v[76:79], v[92:95], v[180:183], v[76:79]
    ds_read_b64_tr_b16 v[90:91], v4 offset:32352
    s_waitcnt lgkmcnt(8)
    v_mfma_f32_16x16x32_bf16 v[80:83], v[96:99], v[176:179], v[80:83]
    ds_read_b64_tr_b16 v[92:93], v4 offset:27776
    v_mfma_f32_16x16x32_bf16 v[84:87], v[96:99], v[180:183], v[84:87]
    ds_read_b64_tr_b16 v[94:95], v4 offset:32384
    s_waitcnt vmcnt(16)
    s_waitcnt lgkmcnt(8)
    v_mfma_f32_16x16x32_bf16 v[16:19], v[100:103], v[192:195], v[16:19]
    ds_read_b64_tr_b16 v[96:97], v4 offset:27808
    v_mfma_f32_16x16x32_bf16 v[20:23], v[100:103], v[196:199], v[20:23]
    ds_read_b64_tr_b16 v[98:99], v4 offset:32416
    s_waitcnt lgkmcnt(8)
    v_mfma_f32_16x16x32_bf16 v[24:27], v[104:107], v[192:195], v[24:27]
    ds_read_b64_tr_b16 v[100:101], v4 offset:27840
    v_mfma_f32_16x16x32_bf16 v[28:31], v[104:107], v[196:199], v[28:31]
    ds_read_b64_tr_b16 v[102:103], v4 offset:32448
    s_waitcnt lgkmcnt(8)
    v_mfma_f32_16x16x32_bf16 v[32:35], v[108:111], v[192:195], v[32:35]
    ds_read_b64_tr_b16 v[104:105], v4 offset:27872
    v_mfma_f32_16x16x32_bf16 v[36:39], v[108:111], v[196:199], v[36:39]
    ds_read_b64_tr_b16 v[106:107], v4 offset:32480
    s_waitcnt lgkmcnt(8)
    v_mfma_f32_16x16x32_bf16 v[40:43], v[88:91], v[192:195], v[40:43]
    ds_read_b64_tr_b16 v[108:109], v7 offset:27648
    v_mfma_f32_16x16x32_bf16 v[44:47], v[88:91], v[196:199], v[44:47]
    ds_read_b64_tr_b16 v[110:111], v7 offset:32256
    s_waitcnt lgkmcnt(8)
    v_mfma_f32_16x16x32_bf16 v[48:51], v[92:95], v[192:195], v[48:51]
    ds_read_b64_tr_b16 v[88:89], v4 offset:36864
    v_mfma_f32_16x16x32_bf16 v[52:55], v[92:95], v[196:199], v[52:55]
    ds_read_b64_tr_b16 v[90:91], v4 offset:41472
    s_waitcnt lgkmcnt(8)
    v_mfma_f32_16x16x32_bf16 v[56:59], v[96:99], v[192:195], v[56:59]
    ds_read_b64_tr_b16 v[92:93], v4 offset:36896
    v_mfma_f32_16x16x32_bf16 v[60:63], v[96:99], v[196:199], v[60:63]
    ds_read_b64_tr_b16 v[94:95], v4 offset:41504
    s_waitcnt lgkmcnt(8)
    v_mfma_f32_16x16x32_bf16 v[64:67], v[100:103], v[192:195], v[64:67]
    ds_read_b64_tr_b16 v[96:97], v4 offset:36928
    v_mfma_f32_16x16x32_bf16 v[68:71], v[100:103], v[196:199], v[68:71]
    ds_read_b64_tr_b16 v[98:99], v4 offset:41536
    s_waitcnt lgkmcnt(8)
    v_mfma_f32_16x16x32_bf16 v[72:75], v[104:107], v[192:195], v[72:75]
    ds_read_b64_tr_b16 v[100:101], v4 offset:36960
    v_mfma_f32_16x16x32_bf16 v[76:79], v[104:107], v[196:199], v[76:79]
    ds_read_b64_tr_b16 v[102:103], v4 offset:41568
    s_waitcnt lgkmcnt(8)
    v_mfma_f32_16x16x32_bf16 v[80:83], v[108:111], v[192:195], v[80:83]
    ds_read_b64_tr_b16 v[104:105], v4 offset:36992
    v_mfma_f32_16x16x32_bf16 v[84:87], v[108:111], v[196:199], v[84:87]
    ds_read_b64_tr_b16 v[106:107], v4 offset:41600
    s_waitcnt vmcnt(14)
    s_waitcnt lgkmcnt(8)
    v_mfma_f32_16x16x32_bf16 v[16:19], v[88:91], v[200:203], v[16:19]
    ds_read_b64_tr_b16 v[108:109], v4 offset:37024
    v_mfma_f32_16x16x32_bf16 v[20:23], v[88:91], v[204:207], v[20:23]
    ds_read_b64_tr_b16 v[110:111], v4 offset:41632
    s_waitcnt lgkmcnt(8)
    v_mfma_f32_16x16x32_bf16 v[24:27], v[92:95], v[200:203], v[24:27]
    ds_read_b64_tr_b16 v[88:89], v4 offset:37056
    v_mfma_f32_16x16x32_bf16 v[28:31], v[92:95], v[204:207], v[28:31]
    ds_read_b64_tr_b16 v[90:91], v4 offset:41664
    s_waitcnt lgkmcnt(8)
    v_mfma_f32_16x16x32_bf16 v[32:35], v[96:99], v[200:203], v[32:35]
    ds_read_b64_tr_b16 v[92:93], v4 offset:37088
    v_mfma_f32_16x16x32_bf16 v[36:39], v[96:99], v[204:207], v[36:39]
    ds_read_b64_tr_b16 v[94:95], v4 offset:41696
    s_waitcnt lgkmcnt(8)
    v_mfma_f32_16x16x32_bf16 v[40:43], v[100:103], v[200:203], v[40:43]
    ds_read_b64_tr_b16 v[96:97], v7 offset:36864
    v_mfma_f32_16x16x32_bf16 v[44:47], v[100:103], v[204:207], v[44:47]
    ds_read_b64_tr_b16 v[98:99], v7 offset:41472
    s_waitcnt lgkmcnt(8)
    v_mfma_f32_16x16x32_bf16 v[48:51], v[104:107], v[200:203], v[48:51]
    ds_read_b64_tr_b16 v[100:101], v4 offset:46080
    v_mfma_f32_16x16x32_bf16 v[52:55], v[104:107], v[204:207], v[52:55]
    ds_read_b64_tr_b16 v[102:103], v4 offset:50688
    s_waitcnt lgkmcnt(8)
    v_mfma_f32_16x16x32_bf16 v[56:59], v[108:111], v[200:203], v[56:59]
    ds_read_b64_tr_b16 v[104:105], v4 offset:46112
    v_mfma_f32_16x16x32_bf16 v[60:63], v[108:111], v[204:207], v[60:63]
    ds_read_b64_tr_b16 v[106:107], v4 offset:50720
    s_waitcnt lgkmcnt(8)
    v_mfma_f32_16x16x32_bf16 v[64:67], v[88:91], v[200:203], v[64:67]
    ds_read_b64_tr_b16 v[108:109], v4 offset:46144
    v_mfma_f32_16x16x32_bf16 v[68:71], v[88:91], v[204:207], v[68:71]
    ds_read_b64_tr_b16 v[110:111], v4 offset:50752
    s_waitcnt lgkmcnt(8)
    v_mfma_f32_16x16x32_bf16 v[72:75], v[92:95], v[200:203], v[72:75]
    ds_read_b64_tr_b16 v[88:89], v4 offset:46176
    v_mfma_f32_16x16x32_bf16 v[76:79], v[92:95], v[204:207], v[76:79]
    ds_read_b64_tr_b16 v[90:91], v4 offset:50784
    s_waitcnt lgkmcnt(8)
    v_mfma_f32_16x16x32_bf16 v[80:83], v[96:99], v[200:203], v[80:83]
    ds_read_b64_tr_b16 v[92:93], v4 offset:46208
    v_mfma_f32_16x16x32_bf16 v[84:87], v[96:99], v[204:207], v[84:87]
    ds_read_b64_tr_b16 v[94:95], v4 offset:50816
    s_waitcnt vmcnt(12)
    s_waitcnt lgkmcnt(8)
    v_mfma_f32_16x16x32_bf16 v[16:19], v[100:103], v[208:211], v[16:19]
    ds_read_b64_tr_b16 v[96:97], v4 offset:46240
    v_mfma_f32_16x16x32_bf16 v[20:23], v[100:103], v[212:215], v[20:23]
    ds_read_b64_tr_b16 v[98:99], v4 offset:50848
    s_waitcnt lgkmcnt(8)
    v_mfma_f32_16x16x32_bf16 v[24:27], v[104:107], v[208:211], v[24:27]
    ds_read_b64_tr_b16 v[100:101], v4 offset:46272
    v_mfma_f32_16x16x32_bf16 v[28:31], v[104:107], v[212:215], v[28:31]
    ds_read_b64_tr_b16 v[102:103], v4 offset:50880
    s_waitcnt lgkmcnt(8)
    v_mfma_f32_16x16x32_bf16 v[32:35], v[108:111], v[208:211], v[32:35]
    ds_read_b64_tr_b16 v[104:105], v4 offset:46304
    v_mfma_f32_16x16x32_bf16 v[36:39], v[108:111], v[212:215], v[36:39]
    ds_read_b64_tr_b16 v[106:107], v4 offset:50912
    s_waitcnt lgkmcnt(8)
    v_mfma_f32_16x16x32_bf16 v[40:43], v[88:91], v[208:211], v[40:43]
    ds_read_b64_tr_b16 v[108:109], v7 offset:46080
    v_mfma_f32_16x16x32_bf16 v[44:47], v[88:91], v[212:215], v[44:47]
    ds_read_b64_tr_b16 v[110:111], v7 offset:50688
    s_waitcnt lgkmcnt(8)
    v_mfma_f32_16x16x32_bf16 v[48:51], v[92:95], v[208:211], v[48:51]
    ds_read_b64_tr_b16 v[88:89], v5 offset:0
    v_mfma_f32_16x16x32_bf16 v[52:55], v[92:95], v[212:215], v[52:55]
    ds_read_b64_tr_b16 v[90:91], v5 offset:4608
    s_waitcnt lgkmcnt(8)
    v_mfma_f32_16x16x32_bf16 v[56:59], v[96:99], v[208:211], v[56:59]
    ds_read_b64_tr_b16 v[92:93], v5 offset:32
    v_mfma_f32_16x16x32_bf16 v[60:63], v[96:99], v[212:215], v[60:63]
    ds_read_b64_tr_b16 v[94:95], v5 offset:4640
    s_waitcnt lgkmcnt(8)
    v_mfma_f32_16x16x32_bf16 v[64:67], v[100:103], v[208:211], v[64:67]
    ds_read_b64_tr_b16 v[96:97], v5 offset:64
    v_mfma_f32_16x16x32_bf16 v[68:71], v[100:103], v[212:215], v[68:71]
    ds_read_b64_tr_b16 v[98:99], v5 offset:4672
    s_waitcnt lgkmcnt(8)
    v_mfma_f32_16x16x32_bf16 v[72:75], v[104:107], v[208:211], v[72:75]
    ds_read_b64_tr_b16 v[100:101], v5 offset:96
    v_mfma_f32_16x16x32_bf16 v[76:79], v[104:107], v[212:215], v[76:79]
    ds_read_b64_tr_b16 v[102:103], v5 offset:4704
    s_waitcnt lgkmcnt(8)
    v_mfma_f32_16x16x32_bf16 v[80:83], v[108:111], v[208:211], v[80:83]
    ds_read_b64_tr_b16 v[104:105], v5 offset:128
    v_mfma_f32_16x16x32_bf16 v[84:87], v[108:111], v[212:215], v[84:87]
    ds_read_b64_tr_b16 v[106:107], v5 offset:4736
    s_waitcnt vmcnt(10)
    s_waitcnt lgkmcnt(8)
    v_mfma_f32_16x16x32_bf16 v[16:19], v[88:91], v[224:227], v[16:19]
    ds_read_b64_tr_b16 v[108:109], v5 offset:160
    v_mfma_f32_16x16x32_bf16 v[20:23], v[88:91], v[228:231], v[20:23]
    ds_read_b64_tr_b16 v[110:111], v5 offset:4768
    s_waitcnt lgkmcnt(8)
    v_mfma_f32_16x16x32_bf16 v[24:27], v[92:95], v[224:227], v[24:27]
    ds_read_b64_tr_b16 v[88:89], v5 offset:192
    v_mfma_f32_16x16x32_bf16 v[28:31], v[92:95], v[228:231], v[28:31]
    ds_read_b64_tr_b16 v[90:91], v5 offset:4800
    s_waitcnt lgkmcnt(8)
    v_mfma_f32_16x16x32_bf16 v[32:35], v[96:99], v[224:227], v[32:35]
    ds_read_b64_tr_b16 v[92:93], v5 offset:224
    v_mfma_f32_16x16x32_bf16 v[36:39], v[96:99], v[228:231], v[36:39]
    ds_read_b64_tr_b16 v[94:95], v5 offset:4832
    s_waitcnt lgkmcnt(8)
    v_mfma_f32_16x16x32_bf16 v[40:43], v[100:103], v[224:227], v[40:43]
    ds_read_b64_tr_b16 v[96:97], v8 offset:0
    v_mfma_f32_16x16x32_bf16 v[44:47], v[100:103], v[228:231], v[44:47]
    ds_read_b64_tr_b16 v[98:99], v8 offset:4608
    s_waitcnt lgkmcnt(8)
    v_mfma_f32_16x16x32_bf16 v[48:51], v[104:107], v[224:227], v[48:51]
    ds_read_b64_tr_b16 v[100:101], v5 offset:9216
    v_mfma_f32_16x16x32_bf16 v[52:55], v[104:107], v[228:231], v[52:55]
    ds_read_b64_tr_b16 v[102:103], v5 offset:13824
    s_waitcnt lgkmcnt(8)
    v_mfma_f32_16x16x32_bf16 v[56:59], v[108:111], v[224:227], v[56:59]
    ds_read_b64_tr_b16 v[104:105], v5 offset:9248
    v_mfma_f32_16x16x32_bf16 v[60:63], v[108:111], v[228:231], v[60:63]
    ds_read_b64_tr_b16 v[106:107], v5 offset:13856
    s_waitcnt lgkmcnt(8)
    v_mfma_f32_16x16x32_bf16 v[64:67], v[88:91], v[224:227], v[64:67]
    ds_read_b64_tr_b16 v[108:109], v5 offset:9280
    v_mfma_f32_16x16x32_bf16 v[68:71], v[88:91], v[228:231], v[68:71]
    ds_read_b64_tr_b16 v[110:111], v5 offset:13888
    s_waitcnt lgkmcnt(8)
    v_mfma_f32_16x16x32_bf16 v[72:75], v[92:95], v[224:227], v[72:75]
    ds_read_b64_tr_b16 v[88:89], v5 offset:9312
    v_mfma_f32_16x16x32_bf16 v[76:79], v[92:95], v[228:231], v[76:79]
    ds_read_b64_tr_b16 v[90:91], v5 offset:13920
    s_waitcnt lgkmcnt(8)
    v_mfma_f32_16x16x32_bf16 v[80:83], v[96:99], v[224:227], v[80:83]
    ds_read_b64_tr_b16 v[92:93], v5 offset:9344
    v_mfma_f32_16x16x32_bf16 v[84:87], v[96:99], v[228:231], v[84:87]
    ds_read_b64_tr_b16 v[94:95], v5 offset:13952
    s_barrier
    s_waitcnt vmcnt(8)
    s_waitcnt lgkmcnt(8)
    v_mfma_f32_16x16x32_bf16 v[16:19], v[100:103], v[232:235], v[16:19]
    ds_read_b64_tr_b16 v[96:97], v5 offset:9376
    v_mfma_f32_16x16x32_bf16 v[20:23], v[100:103], v[236:239], v[20:23]
    ds_read_b64_tr_b16 v[98:99], v5 offset:13984
    s_waitcnt lgkmcnt(8)
    v_mfma_f32_16x16x32_bf16 v[24:27], v[104:107], v[232:235], v[24:27]
    ds_read_b64_tr_b16 v[100:101], v5 offset:9408
    v_mfma_f32_16x16x32_bf16 v[28:31], v[104:107], v[236:239], v[28:31]
    ds_read_b64_tr_b16 v[102:103], v5 offset:14016
    s_waitcnt lgkmcnt(8)
    v_mfma_f32_16x16x32_bf16 v[32:35], v[108:111], v[232:235], v[32:35]
    ds_read_b64_tr_b16 v[104:105], v5 offset:9440
    v_mfma_f32_16x16x32_bf16 v[36:39], v[108:111], v[236:239], v[36:39]
    ds_read_b64_tr_b16 v[106:107], v5 offset:14048
    s_waitcnt lgkmcnt(8)
    v_mfma_f32_16x16x32_bf16 v[40:43], v[88:91], v[232:235], v[40:43]
    ds_read_b64_tr_b16 v[108:109], v8 offset:9216
    v_mfma_f32_16x16x32_bf16 v[44:47], v[88:91], v[236:239], v[44:47]
    ds_read_b64_tr_b16 v[110:111], v8 offset:13824
    s_waitcnt lgkmcnt(8)
    v_mfma_f32_16x16x32_bf16 v[48:51], v[92:95], v[232:235], v[48:51]
    ds_read_b64_tr_b16 v[88:89], v5 offset:18432
    v_mfma_f32_16x16x32_bf16 v[52:55], v[92:95], v[236:239], v[52:55]
    ds_read_b64_tr_b16 v[90:91], v5 offset:23040
    s_waitcnt lgkmcnt(8)
    v_mfma_f32_16x16x32_bf16 v[56:59], v[96:99], v[232:235], v[56:59]
    ds_read_b64_tr_b16 v[92:93], v5 offset:18464
    v_mfma_f32_16x16x32_bf16 v[60:63], v[96:99], v[236:239], v[60:63]
    ds_read_b64_tr_b16 v[94:95], v5 offset:23072
    s_waitcnt lgkmcnt(8)
    v_mfma_f32_16x16x32_bf16 v[64:67], v[100:103], v[232:235], v[64:67]
    ds_read_b64_tr_b16 v[96:97], v5 offset:18496
    v_mfma_f32_16x16x32_bf16 v[68:71], v[100:103], v[236:239], v[68:71]
    ds_read_b64_tr_b16 v[98:99], v5 offset:23104
    s_waitcnt lgkmcnt(8)
    v_mfma_f32_16x16x32_bf16 v[72:75], v[104:107], v[232:235], v[72:75]
    ds_read_b64_tr_b16 v[100:101], v5 offset:18528
    v_mfma_f32_16x16x32_bf16 v[76:79], v[104:107], v[236:239], v[76:79]
    ds_read_b64_tr_b16 v[102:103], v5 offset:23136
    s_waitcnt lgkmcnt(8)
    v_mfma_f32_16x16x32_bf16 v[80:83], v[108:111], v[232:235], v[80:83]
    ds_read_b64_tr_b16 v[104:105], v5 offset:18560
    v_mfma_f32_16x16x32_bf16 v[84:87], v[108:111], v[236:239], v[84:87]
    ds_read_b64_tr_b16 v[106:107], v5 offset:23168
    s_waitcnt vmcnt(4)
    s_waitcnt lgkmcnt(8)
    v_mfma_f32_16x16x32_bf16 v[16:19], v[88:91], v[240:243], v[16:19]
    ds_read_b64_tr_b16 v[108:109], v5 offset:18592
    v_mfma_f32_16x16x32_bf16 v[20:23], v[88:91], v[244:247], v[20:23]
    ds_read_b64_tr_b16 v[110:111], v5 offset:23200
    s_waitcnt lgkmcnt(8)
    v_mfma_f32_16x16x32_bf16 v[24:27], v[92:95], v[240:243], v[24:27]
    ds_read_b64_tr_b16 v[88:89], v5 offset:18624
    v_mfma_f32_16x16x32_bf16 v[28:31], v[92:95], v[244:247], v[28:31]
    ds_read_b64_tr_b16 v[90:91], v5 offset:23232
    s_waitcnt lgkmcnt(8)
    v_mfma_f32_16x16x32_bf16 v[32:35], v[96:99], v[240:243], v[32:35]
    ds_read_b64_tr_b16 v[92:93], v5 offset:18656
    v_mfma_f32_16x16x32_bf16 v[36:39], v[96:99], v[244:247], v[36:39]
    ds_read_b64_tr_b16 v[94:95], v5 offset:23264
    s_waitcnt lgkmcnt(8)
    v_mfma_f32_16x16x32_bf16 v[40:43], v[100:103], v[240:243], v[40:43]
    ds_read_b64_tr_b16 v[96:97], v8 offset:18432
    v_mfma_f32_16x16x32_bf16 v[44:47], v[100:103], v[244:247], v[44:47]
    ds_read_b64_tr_b16 v[98:99], v8 offset:23040
    s_waitcnt lgkmcnt(8)
    v_mfma_f32_16x16x32_bf16 v[48:51], v[104:107], v[240:243], v[48:51]
    ds_read_b64_tr_b16 v[100:101], v5 offset:27648
    v_mfma_f32_16x16x32_bf16 v[52:55], v[104:107], v[244:247], v[52:55]
    ds_read_b64_tr_b16 v[102:103], v5 offset:32256
    s_waitcnt lgkmcnt(8)
    v_mfma_f32_16x16x32_bf16 v[56:59], v[108:111], v[240:243], v[56:59]
    ds_read_b64_tr_b16 v[104:105], v5 offset:27680
    v_mfma_f32_16x16x32_bf16 v[60:63], v[108:111], v[244:247], v[60:63]
    ds_read_b64_tr_b16 v[106:107], v5 offset:32288
    s_waitcnt lgkmcnt(8)
    v_mfma_f32_16x16x32_bf16 v[64:67], v[88:91], v[240:243], v[64:67]
    ds_read_b64_tr_b16 v[108:109], v5 offset:27712
    v_mfma_f32_16x16x32_bf16 v[68:71], v[88:91], v[244:247], v[68:71]
    ds_read_b64_tr_b16 v[110:111], v5 offset:32320
    s_waitcnt lgkmcnt(8)
    v_mfma_f32_16x16x32_bf16 v[72:75], v[92:95], v[240:243], v[72:75]
    ds_read_b64_tr_b16 v[88:89], v5 offset:27744
    v_mfma_f32_16x16x32_bf16 v[76:79], v[92:95], v[244:247], v[76:79]
    ds_read_b64_tr_b16 v[90:91], v5 offset:32352
    s_waitcnt lgkmcnt(8)
    v_mfma_f32_16x16x32_bf16 v[80:83], v[96:99], v[240:243], v[80:83]
    ds_read_b64_tr_b16 v[92:93], v5 offset:27776
    v_mfma_f32_16x16x32_bf16 v[84:87], v[96:99], v[244:247], v[84:87]
    ds_read_b64_tr_b16 v[94:95], v5 offset:32384
    s_waitcnt vmcnt(0)
    s_waitcnt lgkmcnt(8)
    v_mfma_f32_16x16x32_bf16 v[16:19], v[100:103], v[248:251], v[16:19]
    ds_read_b64_tr_b16 v[96:97], v5 offset:27808
    v_mfma_f32_16x16x32_bf16 v[20:23], v[100:103], v[252:255], v[20:23]
    ds_read_b64_tr_b16 v[98:99], v5 offset:32416
    s_waitcnt lgkmcnt(8)
    v_mfma_f32_16x16x32_bf16 v[24:27], v[104:107], v[248:251], v[24:27]
    ds_read_b64_tr_b16 v[100:101], v5 offset:27840
    v_mfma_f32_16x16x32_bf16 v[28:31], v[104:107], v[252:255], v[28:31]
    ds_read_b64_tr_b16 v[102:103], v5 offset:32448
    s_waitcnt lgkmcnt(8)
    v_mfma_f32_16x16x32_bf16 v[32:35], v[108:111], v[248:251], v[32:35]
    ds_read_b64_tr_b16 v[104:105], v5 offset:27872
    v_mfma_f32_16x16x32_bf16 v[36:39], v[108:111], v[252:255], v[36:39]
    ds_read_b64_tr_b16 v[106:107], v5 offset:32480
    s_waitcnt lgkmcnt(8)
    v_mfma_f32_16x16x32_bf16 v[40:43], v[88:91], v[248:251], v[40:43]
    ds_read_b64_tr_b16 v[108:109], v8 offset:27648
    v_mfma_f32_16x16x32_bf16 v[44:47], v[88:91], v[252:255], v[44:47]
    ds_read_b64_tr_b16 v[110:111], v8 offset:32256
    s_waitcnt lgkmcnt(8)
    v_mfma_f32_16x16x32_bf16 v[48:51], v[92:95], v[248:251], v[48:51]
    v_mfma_f32_16x16x32_bf16 v[52:55], v[92:95], v[252:255], v[52:55]
    s_waitcnt lgkmcnt(6)
    v_mfma_f32_16x16x32_bf16 v[56:59], v[96:99], v[248:251], v[56:59]
    v_mfma_f32_16x16x32_bf16 v[60:63], v[96:99], v[252:255], v[60:63]
    s_waitcnt lgkmcnt(4)
    v_mfma_f32_16x16x32_bf16 v[64:67], v[100:103], v[248:251], v[64:67]
    v_mfma_f32_16x16x32_bf16 v[68:71], v[100:103], v[252:255], v[68:71]
    s_waitcnt lgkmcnt(2)
    v_mfma_f32_16x16x32_bf16 v[72:75], v[104:107], v[248:251], v[72:75]
    v_mfma_f32_16x16x32_bf16 v[76:79], v[104:107], v[252:255], v[76:79]
    s_waitcnt lgkmcnt(0)
    v_mfma_f32_16x16x32_bf16 v[80:83], v[108:111], v[248:251], v[80:83]
    v_mfma_f32_16x16x32_bf16 v[84:87], v[108:111], v[252:255], v[84:87]
    s_nop 7
    s_mul_i32 s12, s5, 9
    s_add_u32 s13, s12, s10
    s_lshr_b32 s13, s13, 1
    s_mul_i32 s14, s4, 18
    s_add_u32 s13, s13, s14
    s_lshl_b32 s62, s13, 17
    s_lshl_b32 s61, s4, 2
    s_add_u32 s61, s61, s5
    s_lshl_b32 s61, s61, 16
    v_cvt_pk_bf16_f32 v112, v16, v17
    v_cvt_pk_bf16_f32 v113, v18, v19
    v_cvt_pk_bf16_f32 v114, v24, v25
    v_cvt_pk_bf16_f32 v115, v26, v27
    s_add_u32 s12, s62, 0
    buffer_store_dwordx4 v[112:115], v2, s[48:51], s12 offen offset:0 sc1
    v_cvt_pk_bf16_f32 v116, v32, v33
    v_cvt_pk_bf16_f32 v117, v34, v35
    v_cvt_pk_bf16_f32 v118, v40, v41
    v_cvt_pk_bf16_f32 v119, v42, v43
    s_add_u32 s12, s62, 131072
    buffer_store_dwordx4 v[116:119], v2, s[48:51], s12 offen offset:0 sc1
    v_cvt_pk_bf16_f32 v120, v48, v49
    v_cvt_pk_bf16_f32 v121, v50, v51
    v_cvt_pk_bf16_f32 v122, v56, v57
    v_cvt_pk_bf16_f32 v123, v58, v59
    s_add_u32 s12, s62, 262144
    buffer_store_dwordx4 v[120:123], v2, s[48:51], s12 offen offset:0 sc1
    v_cvt_pk_bf16_f32 v124, v64, v65
    v_cvt_pk_bf16_f32 v125, v66, v67
    v_cvt_pk_bf16_f32 v126, v72, v73
    v_cvt_pk_bf16_f32 v127, v74, v75
    s_add_u32 s12, s62, 393216
    buffer_store_dwordx4 v[124:127], v2, s[48:51], s12 offen offset:0 sc1
    v_cvt_pk_bf16_f32 v144, v80, v81
    v_cvt_pk_bf16_f32 v145, v82, v83
    buffer_store_dwordx2 v[144:145], v3, s[56:59], s61 offen offset:0 sc1
    v_cvt_pk_bf16_f32 v128, v20, v21
    v_cvt_pk_bf16_f32 v129, v22, v23
    v_cvt_pk_bf16_f32 v130, v28, v29
    v_cvt_pk_bf16_f32 v131, v30, v31
    s_add_u32 s12, s62, 0
    buffer_store_dwordx4 v[128:131], v2, s[48:51], s12 offen offset:1024 sc1
    v_cvt_pk_bf16_f32 v132, v36, v37
    v_cvt_pk_bf16_f32 v133, v38, v39
    v_cvt_pk_bf16_f32 v134, v44, v45
    v_cvt_pk_bf16_f32 v135, v46, v47
    s_add_u32 s12, s62, 131072
    buffer_store_dwordx4 v[132:135], v2, s[48:51], s12 offen offset:1024 sc1
    v_cvt_pk_bf16_f32 v136, v52, v53
    v_cvt_pk_bf16_f32 v137, v54, v55
    v_cvt_pk_bf16_f32 v138, v60, v61
    v_cvt_pk_bf16_f32 v139, v62, v63
    s_add_u32 s12, s62, 262144
    buffer_store_dwordx4 v[136:139], v2, s[48:51], s12 offen offset:1024 sc1
    v_cvt_pk_bf16_f32 v140, v68, v69
    v_cvt_pk_bf16_f32 v141, v70, v71
    v_cvt_pk_bf16_f32 v142, v76, v77
    v_cvt_pk_bf16_f32 v143, v78, v79
    s_add_u32 s12, s62, 393216
    buffer_store_dwordx4 v[140:143], v2, s[48:51], s12 offen offset:1024 sc1
    v_cvt_pk_bf16_f32 v146, v84, v85
    v_cvt_pk_bf16_f32 v147, v86, v87
    buffer_store_dwordx2 v[146:147], v3, s[56:59], s61 offen offset:512 sc1
    s_waitcnt vmcnt(0)
    s_barrier
    s_cmp_eq_u32 s3, 0
    s_cbranch_scc0 sequential_preLN__ssm_conv_s4d__glu_gated_reglu__prompt_kernel_sp32
    s_lshl_b32 s12, s6, 3
    s_add_u32 s13, s12, s4
    s_lshl_b32 s13, s13, 7
    s_add_u32 s13, s13, 24576
    s_mov_b64 exec, 1
    v_mov_b32 v250, s13
    v_mov_b32 v251, 1
    global_atomic_add v250, v251, s[42:43] sc1
    s_mov_b64 exec, -1
    s_lshl_b32 s12, s12, 7
    s_add_u32 s12, s12, 24576
    s_mov_b64 exec, 0xff
    v_lshl_add_u32 v250, v1, 7, s12
    s_mov_b32 s60, 0
sequential_preLN__ssm_conv_s4d__glu_gated_reglu__prompt_kernel_spl33:
    global_load_dword v251, v250, s[42:43] sc1
    s_add_u32 s60, s60, 1
    s_waitcnt vmcnt(0)
    v_cmp_gt_u32 vcc, 4, v251
    s_cmp_eq_u64 vcc, 0
    s_cbranch_scc1 sequential_preLN__ssm_conv_s4d__glu_gated_reglu__prompt_kernel_spd34
    s_cmp_ge_u32 s60, 0x200000
    s_cbranch_scc1 sequential_preLN__ssm_conv_s4d__glu_gated_reglu__prompt_kernel_spd34
    s_sleep 1
    s_branch sequential_preLN__ssm_conv_s4d__glu_gated_reglu__prompt_kernel_spl33
sequential_preLN__ssm_conv_s4d__glu_gated_reglu__prompt_kernel_spd34:
    s_mov_b64 exec, -1
sequential_preLN__ssm_conv_s4d__glu_gated_reglu__prompt_kernel_sp32:
    s_barrier
    s_add_u32 s44, s42, 23068672
    s_addc_u32 s45, s43, 0
    s_and_b32 s45, s45, 0xffff
    s_mov_b32 s46, 18874368
    s_mov_b32 s47, 0x20000
    s_mov_b32 s48, s38
    s_and_b32 s49, s39, 0xffff
    s_mov_b32 s50, 2359296
    s_mov_b32 s51, 0x20000
    s_add_u32 s52, s42, 50331648
    s_addc_u32 s53, s43, 0
    s_and_b32 s53, s53, 0xffff
    s_mov_b32 s54, 2097152
    s_mov_b32 s55, 0x20000
    v_lshrrev_b32 v3, 5, v0
    v_bfe_u32 v4, v0, 2, 3
    v_and_b32 v5, 3, v0
    v_cmp_le_u32 vcc, 4, v3
    v_cmp_le_u32 s[12:13], 12, v3
    s_nop 1
    v_addc_co_u32 v3, vcc, 0, v3, vcc
    v_addc_co_u32 v3, vcc, 0, v3, s[12:13]
    v_lshlrev_b32 v10, 17, v3
    v_add_u32 v12, s11, v4
    v_lshl_add_u32 v10, v12, 6, v10
    v_lshl_add_u32 v10, v5, 4, v10
    s_mov_b32 s14, 0
    buffer_load_dwordx4 v[32:35], v10, s[44:47], s14 offen sc1
    s_mov_b32 s14, 2359296
    buffer_load_dwordx4 v[36:39], v10, s[44:47], s14 offen sc1
    s_mov_b32 s14, 4718592
    buffer_load_dwordx4 v[40:43], v10, s[44:47], s14 offen sc1
    s_mov_b32 s14, 7077888
    buffer_load_dwordx4 v[44:47], v10, s[44:47], s14 offen sc1
    s_mov_b32 s14, 9437184
    buffer_load_dwordx4 v[48:51], v10, s[44:47], s14 offen sc1
    s_mov_b32 s14, 11796480
    buffer_load_dwordx4 v[52:55], v10, s[44:47], s14 offen sc1
    s_mov_b32 s14, 14155776
    buffer_load_dwordx4 v[56:59], v10, s[44:47], s14 offen sc1
    s_mov_b32 s14, 16515072
    buffer_load_dwordx4 v[60:63], v10, s[44:47], s14 offen sc1
    s_cmp_eq_u32 s3, 0
    s_cbranch_scc0 sequential_preLN__ssm_conv_s4d__glu_gated_reglu__prompt_kernel_sp135
    v_lshrrev_b32 v6, 5, v1
    v_bfe_u32 v7, v1, 2, 3
    v_and_b32 v8, 3, v1
    v_lshlrev_b32 v11, 17, v6
    v_add_u32 v12, s11, v7
    v_lshl_add_u32 v11, v12, 5, v11
    v_lshl_add_u32 v11, v8, 3, v11
    s_mov_b32 s14, 0
    s_mov_b32 s15, 65536
    buffer_load_dwordx2 v[64:65], v11, s[52:55], s14 offen sc1
    buffer_load_dwordx2 v[66:67], v11, s[52:55], s15 offen sc1
    s_mov_b32 s14, 262144
    s_mov_b32 s15, 327680
    buffer_load_dwordx2 v[68:69], v11, s[52:55], s14 offen sc1
    buffer_load_dwordx2 v[70:71], v11, s[52:55], s15 offen sc1
    s_mov_b32 s14, 524288
    s_mov_b32 s15, 589824
    buffer_load_dwordx2 v[72:73], v11, s[52:55], s14 offen sc1
    buffer_load_dwordx2 v[74:75], v11, s[52:55], s15 offen sc1
    s_mov_b32 s14, 786432
    s_mov_b32 s15, 851968
    buffer_load_dwordx2 v[76:77], v11, s[52:55], s14 offen sc1
    buffer_load_dwordx2 v[78:79], v11, s[52:55], s15 offen sc1
    s_mov_b32 s14, 1048576
    s_mov_b32 s15, 1114112
    buffer_load_dwordx2 v[80:81], v11, s[52:55], s14 offen sc1
    buffer_load_dwordx2 v[82:83], v11, s[52:55], s15 offen sc1
    s_mov_b32 s14, 1310720
    s_mov_b32 s15, 1376256
    buffer_load_dwordx2 v[84:85], v11, s[52:55], s14 offen sc1
    buffer_load_dwordx2 v[86:87], v11, s[52:55], s15 offen sc1
    s_mov_b32 s14, 1572864
    s_mov_b32 s15, 1638400
    buffer_load_dwordx2 v[88:89], v11, s[52:55], s14 offen sc1
    buffer_load_dwordx2 v[90:91], v11, s[52:55], s15 offen sc1
    s_mov_b32 s14, 1835008
    s_mov_b32 s15, 1900544
    buffer_load_dwordx2 v[92:93], v11, s[52:55], s14 offen sc1
    buffer_load_dwordx2 v[94:95], v11, s[52:55], s15 offen sc1
sequential_preLN__ssm_conv_s4d__glu_gated_reglu__prompt_kernel_sp135:
    s_mov_b32 s15, 0xffff0000
    s_mov_b32 s61, 0x00003f80
    s_mov_b32 s62, 0x3f800000
    v_mov_b32 v18, s61
    v_mov_b32 v19, s62
    v_lshlrev_b32 v13, 5, v3
    v_lshl_add_u32 v13, v5, 2, v13
    v_lshlrev_b32 v13, 4, v13
    v_lshl_add_u32 v13, v4, 1, v13
    v_add_u32 v13, 149632, v13
    ds_read_u16 v100, v13 offset:0
    ds_read_u16 v101, v13 offset:16
    ds_read_u16 v102, v13 offset:32
    ds_read_u16 v103, v13 offset:48
    ds_read_u16 v104, v13 offset:256
    ds_read_u16 v105, v13 offset:272
    ds_read_u16 v106, v13 offset:288
    ds_read_u16 v107, v13 offset:304
    v_lshlrev_b32 v14, 2, v4
    v_add_u32 v14, 159872, v14
    ds_read_b32 v116, v14
    s_cmp_eq_u32 s3, 0
    s_cbranch_scc1 sequential_preLN__ssm_conv_s4d__glu_gated_reglu__prompt_kernel_w036
    v_mov_b32 v120, 0
    v_mov_b32 v121, 0
    v_mov_b32 v122, 0
    v_mov_b32 v123, 0
    v_mov_b32 v124, 0
    v_mov_b32 v125, 0
    v_mov_b32 v126, 0
    v_mov_b32 v127, 0
    s_waitcnt vmcnt(7)
    v_dot2c_f32_bf16 v120, v32, v18
    v_dot2c_f32_bf16 v121, v32, v19
    v_dot2c_f32_bf16 v122, v33, v18
    v_dot2c_f32_bf16 v123, v33, v19
    v_dot2c_f32_bf16 v124, v34, v18
    v_dot2c_f32_bf16 v125, v34, v19
    v_dot2c_f32_bf16 v126, v35, v18
    v_dot2c_f32_bf16 v127, v35, v19
    s_waitcnt vmcnt(6)
    v_dot2c_f32_bf16 v120, v36, v18
    v_dot2c_f32_bf16 v121, v36, v19
    v_dot2c_f32_bf16 v122, v37, v18
    v_dot2c_f32_bf16 v123, v37, v19
    v_dot2c_f32_bf16 v124, v38, v18
    v_dot2c_f32_bf16 v125, v38, v19
    v_dot2c_f32_bf16 v126, v39, v18
    v_dot2c_f32_bf16 v127, v39, v19
    s_waitcnt vmcnt(5)
    v_dot2c_f32_bf16 v120, v40, v18
    v_dot2c_f32_bf16 v121, v40, v19
    v_dot2c_f32_bf16 v122, v41, v18
    v_dot2c_f32_bf16 v123, v41, v19
    v_dot2c_f32_bf16 v124, v42, v18
    v_dot2c_f32_bf16 v125, v42, v19
    v_dot2c_f32_bf16 v126, v43, v18
    v_dot2c_f32_bf16 v127, v43, v19
    s_waitcnt vmcnt(4)
    v_dot2c_f32_bf16 v120, v44, v18
    v_dot2c_f32_bf16 v121, v44, v19
    v_dot2c_f32_bf16 v122, v45, v18
    v_dot2c_f32_bf16 v123, v45, v19
    v_dot2c_f32_bf16 v124, v46, v18
    v_dot2c_f32_bf16 v125, v46, v19
    v_dot2c_f32_bf16 v126, v47, v18
    v_dot2c_f32_bf16 v127, v47, v19
    s_waitcnt vmcnt(3)
    v_dot2c_f32_bf16 v120, v48, v18
    v_dot2c_f32_bf16 v121, v48, v19
    v_dot2c_f32_bf16 v122, v49, v18
    v_dot2c_f32_bf16 v123, v49, v19
    v_dot2c_f32_bf16 v124, v50, v18
    v_dot2c_f32_bf16 v125, v50, v19
    v_dot2c_f32_bf16 v126, v51, v18
    v_dot2c_f32_bf16 v127, v51, v19
    s_waitcnt vmcnt(2)
    v_dot2c_f32_bf16 v120, v52, v18
    v_dot2c_f32_bf16 v121, v52, v19
    v_dot2c_f32_bf16 v122, v53, v18
    v_dot2c_f32_bf16 v123, v53, v19
    v_dot2c_f32_bf16 v124, v54, v18
    v_dot2c_f32_bf16 v125, v54, v19
    v_dot2c_f32_bf16 v126, v55, v18
    v_dot2c_f32_bf16 v127, v55, v19
    s_waitcnt vmcnt(1)
    v_dot2c_f32_bf16 v120, v56, v18
    v_dot2c_f32_bf16 v121, v56, v19
    v_dot2c_f32_bf16 v122, v57, v18
    v_dot2c_f32_bf16 v123, v57, v19
    v_dot2c_f32_bf16 v124, v58, v18
    v_dot2c_f32_bf16 v125, v58, v19
    v_dot2c_f32_bf16 v126, v59, v18
    v_dot2c_f32_bf16 v127, v59, v19
    s_waitcnt vmcnt(0)
    v_dot2c_f32_bf16 v120, v60, v18
    v_dot2c_f32_bf16 v121, v60, v19
    v_dot2c_f32_bf16 v122, v61, v18
    v_dot2c_f32_bf16 v123, v61, v19
    v_dot2c_f32_bf16 v124, v62, v18
    v_dot2c_f32_bf16 v125, v62, v19
    v_dot2c_f32_bf16 v126, v63, v18
    v_dot2c_f32_bf16 v127, v63, v19
    s_waitcnt lgkmcnt(0)
    s_nop 1
    v_mul_f32 v120, v120, v116
    v_mul_f32 v121, v121, v116
    v_mul_f32 v122, v122, v116
    v_mul_f32 v123, v123, v116
    v_mul_f32 v124, v124, v116
    v_mul_f32 v125, v125, v116
    v_mul_f32 v126, v126, v116
    v_mul_f32 v127, v127, v116
    v_cvt_pk_bf16_f32 v140, v120, v121
    v_cvt_pk_bf16_f32 v141, v122, v123
    v_cvt_pk_bf16_f32 v142, v124, v125
    v_cvt_pk_bf16_f32 v143, v126, v127
    v_lshlrev_b32 v120, 16, v140
    v_and_b32 v121, s15, v140
    v_lshlrev_b32 v122, 16, v141
    v_and_b32 v123, s15, v141
    v_lshlrev_b32 v124, 16, v142
    v_and_b32 v125, s15, v142
    v_lshlrev_b32 v126, 16, v143
    v_and_b32 v127, s15, v143
    v_lshlrev_b32 v100, 16, v100
    v_add_f32 v120, v120, v100
    v_lshlrev_b32 v101, 16, v101
    v_add_f32 v121, v121, v101
    v_lshlrev_b32 v102, 16, v102
    v_add_f32 v122, v122, v102
    v_lshlrev_b32 v103, 16, v103
    v_add_f32 v123, v123, v103
    v_lshlrev_b32 v104, 16, v104
    v_add_f32 v124, v124, v104
    v_lshlrev_b32 v105, 16, v105
    v_add_f32 v125, v125, v105
    v_lshlrev_b32 v106, 16, v106
    v_add_f32 v126, v126, v106
    v_lshlrev_b32 v107, 16, v107
    v_add_f32 v127, v127, v107
    v_cvt_pk_bf16_f32 v144, v120, v121
    v_cvt_pk_bf16_f32 v145, v122, v123
    v_cvt_pk_bf16_f32 v146, v124, v125
    v_cvt_pk_bf16_f32 v147, v126, v127
    v_add_u32 v12, s11, v4
    v_mul_u32_u24 v12, 1152, v12
    v_lshl_add_u32 v12, v3, 6, v12
    v_lshl_add_u32 v12, v5, 3, v12
    buffer_store_dwordx2 v[144:145], v12, s[48:51], 0 offen
    buffer_store_dwordx2 v[146:147], v12, s[48:51], 0 offen offset:32
    s_branch sequential_preLN__ssm_conv_s4d__glu_gated_reglu__prompt_kernel_w0e37
sequential_preLN__ssm_conv_s4d__glu_gated_reglu__prompt_kernel_w036:
    v_mov_b32 v120, 0
    v_mov_b32 v121, 0
    v_mov_b32 v122, 0
    v_mov_b32 v123, 0
    v_mov_b32 v124, 0
    v_mov_b32 v125, 0
    v_mov_b32 v126, 0
    v_mov_b32 v127, 0
    s_waitcnt vmcnt(23)
    v_dot2c_f32_bf16 v120, v32, v18
    v_dot2c_f32_bf16 v121, v32, v19
    v_dot2c_f32_bf16 v122, v33, v18
    v_dot2c_f32_bf16 v123, v33, v19
    v_dot2c_f32_bf16 v124, v34, v18
    v_dot2c_f32_bf16 v125, v34, v19
    v_dot2c_f32_bf16 v126, v35, v18
    v_dot2c_f32_bf16 v127, v35, v19
    s_waitcnt vmcnt(22)
    v_dot2c_f32_bf16 v120, v36, v18
    v_dot2c_f32_bf16 v121, v36, v19
    v_dot2c_f32_bf16 v122, v37, v18
    v_dot2c_f32_bf16 v123, v37, v19
    v_dot2c_f32_bf16 v124, v38, v18
    v_dot2c_f32_bf16 v125, v38, v19
    v_dot2c_f32_bf16 v126, v39, v18
    v_dot2c_f32_bf16 v127, v39, v19
    s_waitcnt vmcnt(21)
    v_dot2c_f32_bf16 v120, v40, v18
    v_dot2c_f32_bf16 v121, v40, v19
    v_dot2c_f32_bf16 v122, v41, v18
    v_dot2c_f32_bf16 v123, v41, v19
    v_dot2c_f32_bf16 v124, v42, v18
    v_dot2c_f32_bf16 v125, v42, v19
    v_dot2c_f32_bf16 v126, v43, v18
    v_dot2c_f32_bf16 v127, v43, v19
    s_waitcnt vmcnt(20)
    v_dot2c_f32_bf16 v120, v44, v18
    v_dot2c_f32_bf16 v121, v44, v19
    v_dot2c_f32_bf16 v122, v45, v18
    v_dot2c_f32_bf16 v123, v45, v19
    v_dot2c_f32_bf16 v124, v46, v18
    v_dot2c_f32_bf16 v125, v46, v19
    v_dot2c_f32_bf16 v126, v47, v18
    v_dot2c_f32_bf16 v127, v47, v19
    s_waitcnt vmcnt(19)
    v_dot2c_f32_bf16 v120, v48, v18
    v_dot2c_f32_bf16 v121, v48, v19
    v_dot2c_f32_bf16 v122, v49, v18
    v_dot2c_f32_bf16 v123, v49, v19
    v_dot2c_f32_bf16 v124, v50, v18
    v_dot2c_f32_bf16 v125, v50, v19
    v_dot2c_f32_bf16 v126, v51, v18
    v_dot2c_f32_bf16 v127, v51, v19
    s_waitcnt vmcnt(18)
    v_dot2c_f32_bf16 v120, v52, v18
    v_dot2c_f32_bf16 v121, v52, v19
    v_dot2c_f32_bf16 v122, v53, v18
    v_dot2c_f32_bf16 v123, v53, v19
    v_dot2c_f32_bf16 v124, v54, v18
    v_dot2c_f32_bf16 v125, v54, v19
    v_dot2c_f32_bf16 v126, v55, v18
    v_dot2c_f32_bf16 v127, v55, v19
    s_waitcnt vmcnt(17)
    v_dot2c_f32_bf16 v120, v56, v18
    v_dot2c_f32_bf16 v121, v56, v19
    v_dot2c_f32_bf16 v122, v57, v18
    v_dot2c_f32_bf16 v123, v57, v19
    v_dot2c_f32_bf16 v124, v58, v18
    v_dot2c_f32_bf16 v125, v58, v19
    v_dot2c_f32_bf16 v126, v59, v18
    v_dot2c_f32_bf16 v127, v59, v19
    s_waitcnt vmcnt(16)
    v_dot2c_f32_bf16 v120, v60, v18
    v_dot2c_f32_bf16 v121, v60, v19
    v_dot2c_f32_bf16 v122, v61, v18
    v_dot2c_f32_bf16 v123, v61, v19
    v_dot2c_f32_bf16 v124, v62, v18
    v_dot2c_f32_bf16 v125, v62, v19
    v_dot2c_f32_bf16 v126, v63, v18
    v_dot2c_f32_bf16 v127, v63, v19
    s_waitcnt lgkmcnt(0)
    s_nop 1
    v_mul_f32 v120, v120, v116
    v_mul_f32 v121, v121, v116
    v_mul_f32 v122, v122, v116
    v_mul_f32 v123, v123, v116
    v_mul_f32 v124, v124, v116
    v_mul_f32 v125, v125, v116
    v_mul_f32 v126, v126, v116
    v_mul_f32 v127, v127, v116
    v_cvt_pk_bf16_f32 v140, v120, v121
    v_cvt_pk_bf16_f32 v141, v122, v123
    v_cvt_pk_bf16_f32 v142, v124, v125
    v_cvt_pk_bf16_f32 v143, v126, v127
    v_lshlrev_b32 v120, 16, v140
    v_and_b32 v121, s15, v140
    v_lshlrev_b32 v122, 16, v141
    v_and_b32 v123, s15, v141
    v_lshlrev_b32 v124, 16, v142
    v_and_b32 v125, s15, v142
    v_lshlrev_b32 v126, 16, v143
    v_and_b32 v127, s15, v143
    v_lshlrev_b32 v100, 16, v100
    v_add_f32 v120, v120, v100
    v_lshlrev_b32 v101, 16, v101
    v_add_f32 v121, v121, v101
    v_lshlrev_b32 v102, 16, v102
    v_add_f32 v122, v122, v102
    v_lshlrev_b32 v103, 16, v103
    v_add_f32 v123, v123, v103
    v_lshlrev_b32 v104, 16, v104
    v_add_f32 v124, v124, v104
    v_lshlrev_b32 v105, 16, v105
    v_add_f32 v125, v125, v105
    v_lshlrev_b32 v106, 16, v106
    v_add_f32 v126, v126, v106
    v_lshlrev_b32 v107, 16, v107
    v_add_f32 v127, v127, v107
    v_cvt_pk_bf16_f32 v144, v120, v121
    v_cvt_pk_bf16_f32 v145, v122, v123
    v_cvt_pk_bf16_f32 v146, v124, v125
    v_cvt_pk_bf16_f32 v147, v126, v127
    v_add_u32 v12, s11, v4
    v_mul_u32_u24 v12, 1152, v12
    v_lshl_add_u32 v12, v3, 6, v12
    v_lshl_add_u32 v12, v5, 3, v12
    buffer_store_dwordx2 v[144:145], v12, s[48:51], 0 offen
    buffer_store_dwordx2 v[146:147], v12, s[48:51], 0 offen offset:32
    v_mul_u32_u24 v6, 9, v6
    v_add_u32 v6, 4, v6
    v_lshlrev_b32 v13, 5, v6
    v_lshl_add_u32 v13, v8, 2, v13
    v_lshlrev_b32 v13, 4, v13
    v_lshl_add_u32 v13, v7, 1, v13
    v_add_u32 v13, 149632, v13
    ds_read_u16 v100, v13 offset:0
    ds_read_u16 v101, v13 offset:16
    ds_read_u16 v102, v13 offset:32
    ds_read_u16 v103, v13 offset:48
    ds_read_u16 v104, v13 offset:256
    ds_read_u16 v105, v13 offset:272
    ds_read_u16 v106, v13 offset:288
    ds_read_u16 v107, v13 offset:304
    v_lshlrev_b32 v14, 2, v7
    v_add_u32 v14, 159872, v14
    ds_read_b32 v116, v14
    s_waitcnt vmcnt(2)
    v_mov_b32 v120, 0
    v_mov_b32 v121, 0
    v_mov_b32 v122, 0
    v_mov_b32 v123, 0
    v_mov_b32 v124, 0
    v_mov_b32 v125, 0
    v_mov_b32 v126, 0
    v_mov_b32 v127, 0
    v_dot2c_f32_bf16 v120, v64, v18
    v_dot2c_f32_bf16 v121, v64, v19
    v_dot2c_f32_bf16 v122, v65, v18
    v_dot2c_f32_bf16 v123, v65, v19
    v_dot2c_f32_bf16 v124, v66, v18
    v_dot2c_f32_bf16 v125, v66, v19
    v_dot2c_f32_bf16 v126, v67, v18
    v_dot2c_f32_bf16 v127, v67, v19
    v_dot2c_f32_bf16 v120, v68, v18
    v_dot2c_f32_bf16 v121, v68, v19
    v_dot2c_f32_bf16 v122, v69, v18
    v_dot2c_f32_bf16 v123, v69, v19
    v_dot2c_f32_bf16 v124, v70, v18
    v_dot2c_f32_bf16 v125, v70, v19
    v_dot2c_f32_bf16 v126, v71, v18
    v_dot2c_f32_bf16 v127, v71, v19
    v_dot2c_f32_bf16 v120, v72, v18
    v_dot2c_f32_bf16 v121, v72, v19
    v_dot2c_f32_bf16 v122, v73, v18
    v_dot2c_f32_bf16 v123, v73, v19
    v_dot2c_f32_bf16 v124, v74, v18
    v_dot2c_f32_bf16 v125, v74, v19
    v_dot2c_f32_bf16 v126, v75, v18
    v_dot2c_f32_bf16 v127, v75, v19
    v_dot2c_f32_bf16 v120, v76, v18
    v_dot2c_f32_bf16 v121, v76, v19
    v_dot2c_f32_bf16 v122, v77, v18
    v_dot2c_f32_bf16 v123, v77, v19
    v_dot2c_f32_bf16 v124, v78, v18
    v_dot2c_f32_bf16 v125, v78, v19
    v_dot2c_f32_bf16 v126, v79, v18
    v_dot2c_f32_bf16 v127, v79, v19
    v_dot2c_f32_bf16 v120, v80, v18
    v_dot2c_f32_bf16 v121, v80, v19
    v_dot2c_f32_bf16 v122, v81, v18
    v_dot2c_f32_bf16 v123, v81, v19
    v_dot2c_f32_bf16 v124, v82, v18
    v_dot2c_f32_bf16 v125, v82, v19
    v_dot2c_f32_bf16 v126, v83, v18
    v_dot2c_f32_bf16 v127, v83, v19
    v_dot2c_f32_bf16 v120, v84, v18
    v_dot2c_f32_bf16 v121, v84, v19
    v_dot2c_f32_bf16 v122, v85, v18
    v_dot2c_f32_bf16 v123, v85, v19
    v_dot2c_f32_bf16 v124, v86, v18
    v_dot2c_f32_bf16 v125, v86, v19
    v_dot2c_f32_bf16 v126, v87, v18
    v_dot2c_f32_bf16 v127, v87, v19
    v_dot2c_f32_bf16 v120, v88, v18
    v_dot2c_f32_bf16 v121, v88, v19
    v_dot2c_f32_bf16 v122, v89, v18
    v_dot2c_f32_bf16 v123, v89, v19
    v_dot2c_f32_bf16 v124, v90, v18
    v_dot2c_f32_bf16 v125, v90, v19
    v_dot2c_f32_bf16 v126, v91, v18
    v_dot2c_f32_bf16 v127, v91, v19
    v_dot2c_f32_bf16 v120, v92, v18
    v_dot2c_f32_bf16 v121, v92, v19
    v_dot2c_f32_bf16 v122, v93, v18
    v_dot2c_f32_bf16 v123, v93, v19
    v_dot2c_f32_bf16 v124, v94, v18
    v_dot2c_f32_bf16 v125, v94, v19
    v_dot2c_f32_bf16 v126, v95, v18
    v_dot2c_f32_bf16 v127, v95, v19
    s_waitcnt lgkmcnt(0)
    s_nop 1
    v_mul_f32 v120, v120, v116
    v_mul_f32 v121, v121, v116
    v_mul_f32 v122, v122, v116
    v_mul_f32 v123, v123, v116
    v_mul_f32 v124, v124, v116
    v_mul_f32 v125, v125, v116
    v_mul_f32 v126, v126, v116
    v_mul_f32 v127, v127, v116
    v_cvt_pk_bf16_f32 v140, v120, v121
    v_cvt_pk_bf16_f32 v141, v122, v123
    v_cvt_pk_bf16_f32 v142, v124, v125
    v_cvt_pk_bf16_f32 v143, v126, v127
    v_lshlrev_b32 v120, 16, v140
    v_and_b32 v121, s15, v140
    v_lshlrev_b32 v122, 16, v141
    v_and_b32 v123, s15, v141
    v_lshlrev_b32 v124, 16, v142
    v_and_b32 v125, s15, v142
    v_lshlrev_b32 v126, 16, v143
    v_and_b32 v127, s15, v143
    v_lshlrev_b32 v100, 16, v100
    v_add_f32 v120, v120, v100
    v_lshlrev_b32 v101, 16, v101
    v_add_f32 v121, v121, v101
    v_lshlrev_b32 v102, 16, v102
    v_add_f32 v122, v122, v102
    v_lshlrev_b32 v103, 16, v103
    v_add_f32 v123, v123, v103
    v_lshlrev_b32 v104, 16, v104
    v_add_f32 v124, v124, v104
    v_lshlrev_b32 v105, 16, v105
    v_add_f32 v125, v125, v105
    v_lshlrev_b32 v106, 16, v106
    v_add_f32 v126, v126, v106
    v_lshlrev_b32 v107, 16, v107
    v_add_f32 v127, v127, v107
    v_cvt_pk_bf16_f32 v144, v120, v121
    v_cvt_pk_bf16_f32 v145, v122, v123
    v_cvt_pk_bf16_f32 v146, v124, v125
    v_cvt_pk_bf16_f32 v147, v126, v127
    v_add_u32 v12, s11, v7
    v_mul_u32_u24 v12, 1152, v12
    v_lshl_add_u32 v12, v6, 6, v12
    v_lshl_add_u32 v12, v8, 3, v12
    buffer_store_dwordx2 v[144:145], v12, s[48:51], 0 offen
    buffer_store_dwordx2 v[146:147], v12, s[48:51], 0 offen offset:32
sequential_preLN__ssm_conv_s4d__glu_gated_reglu__prompt_kernel_w0e37:
sequential_preLN__ssm_conv_s4d__glu_gated_reglu__prompt_kernel_end:
    s_endpgm
.section .rodata,"a"
.p2align 6
.amdhsa_kernel sequential_preLN__ssm_conv_s4d__glu_gated_reglu__prompt_kernel
  .amdhsa_next_free_vgpr 256
  .amdhsa_next_free_sgpr 102
  .amdhsa_accum_offset 256
  .amdhsa_group_segment_fixed_size 0
  .amdhsa_kernarg_size 112
  .amdhsa_user_sgpr_count 2
  .amdhsa_user_sgpr_kernarg_segment_ptr 1
  .amdhsa_system_sgpr_workgroup_id_x 1
  .amdhsa_float_denorm_mode_32 3
  .amdhsa_float_denorm_mode_16_64 3
.end_amdhsa_kernel
```
